```python
import torch

def _softmax(x, axis=-1):
    return torch.softmax(x, dim=axis)
def _gelu(x):
    return torch.nn.functional.gelu(x, approximate="tanh")
def _silu(x):
    return torch.nn.functional.silu(x)
def _sigmoid(x):
    return torch.sigmoid(x)
def _layernorm(x, axis=-1, eps=1e-5):
    m = x.mean(dim=axis, keepdim=True)
    v = x.var(dim=axis, keepdim=True, unbiased=False)
    return (x - m) / torch.sqrt(v + eps)
def _scatter_add(tgt, idx, src, axis=0):
    return tgt.clone().index_add_(axis, idx, src)
def _segment_sum(src, seg, n):
    out = torch.zeros((n,) + src.shape[1:], dtype=src.dtype)
    return out.index_add_(0, seg, src)
def _pad(x, pw):
    flat = tuple(v for pair in reversed(pw) for v in pair)
    return torch.nn.functional.pad(x, flat)

kernel_name = 'interleave_layers__sliding_local_dilated__glu_gated_geglu__prompt'

def setup_inputs():

    _w = (lambda a: (lambda t: t.to(torch.bfloat16) if t.is_floating_point() else t)(torch.as_tensor(a)))
    def _A_setup():
        B, S, D = 1, 2048, 512
        return {
            "x": _w((lambda *s: torch.randn(*s, dtype=torch.bfloat16) * 0.05)(B, S, D)),
            "wqkv": _w((lambda *s: torch.randn(*s, dtype=torch.bfloat16) * 0.05)(D, 3 * D)),
            "wo": _w((lambda *s: torch.randn(*s, dtype=torch.bfloat16) * 0.05)(D, D)),
        }
    _A_in = _A_setup()

    def _B_setup():
        B, S, Dm, Df = 1, 2048, 512, 1792
        return {
            "x": _w((lambda *s: torch.randn(*s, dtype=torch.bfloat16) * 0.05)(B, S, Dm)),
            "w_gate": _w((lambda *s: torch.randn(*s, dtype=torch.bfloat16) * 0.8)(Dm, Df) * (Dm ** -0.5)),
            "w_up": _w((lambda *s: torch.randn(*s, dtype=torch.bfloat16) * 0.8)(Dm, Df) * (Dm ** -0.5)),
            "w_down": _w((lambda *s: torch.randn(*s, dtype=torch.bfloat16) * 0.8)(Df, Dm) * (Df ** -0.5)),
        }
    _B_in = _B_setup()

    return {
        "A_x": _A_in["x"],
        "A_wqkv": _A_in["wqkv"],
        "A_wo": _A_in["wo"],
        "B_x": _B_in["x"],
        "B_w_gate": _B_in["w_gate"],
        "B_w_up": _B_in["w_up"],
        "B_w_down": _B_in["w_down"],
    }

def reference(A_x, A_wqkv, A_wo, B_x, B_w_gate, B_w_up, B_w_down):
    def _A_ref(x, wqkv, wo):
        B, S, D = x.shape
        H = 32; Dh = D // H
        W, dil = 8, 2
        qkv = (lambda x, *d: x.permute(*d))((x @ wqkv).reshape(B, S, 3, H, Dh), 2, 0, 3, 1, 4)
        q, k, v = qkv[0], qkv[1], qkv[2]
        scale = Dh ** -0.5
        pos = torch.arange(S)
        off = torch.arange(W) * dil
        idx = pos[:, None] - off[None, :]
        mask = idx >= 0
        idx_c = torch.where(mask, idx, 0).reshape(-1)
        kg = k[:, :, idx_c, :].reshape(B, H, S, W, Dh)
        vg = v[:, :, idx_c, :].reshape(B, H, S, W, Dh)
        logits = torch.einsum("bhsd,bhswd->bhsw", q, kg) * scale
        logits = torch.where(mask[None, None, :, :], logits, -1e9)
        attn = _softmax(logits, axis=-1)
        o = torch.einsum("bhsw,bhswd->bhsd", attn, vg)
        return (lambda x, *d: x.permute(*d))(o, 0, 2, 1, 3).reshape(B, S, D) @ wo

    def _B_ref(x, w_gate, w_up, w_down):
        g = torch.einsum("bsd,df->bsf", x, w_gate)
        u = torch.einsum("bsd,df->bsf", x, w_up)
        h = _gelu(g) * u
        return torch.einsum("bsf,fd->bsd", h, w_down)

    x = A_x
    x = x + _A_ref(_layernorm(x, axis=-1), A_wqkv, A_wo)
    x = x + _B_ref(_layernorm(x, axis=-1), B_w_gate, B_w_up, B_w_down)
    x = x + _A_ref(_layernorm(x, axis=-1), A_wqkv, A_wo)
    x = x + _B_ref(_layernorm(x, axis=-1), B_w_gate, B_w_up, B_w_down)
    return x
```

```asm
; @launch grid=(256,1,1) block=(256,1,1) lds=163840
.amdgcn_target "amdgcn-amd-amdhsa--gfx950"
.text
.globl interleave_layers__sliding_local_dilated__glu_gated_geglu__prompt_kernel
.p2align 8
.type interleave_layers__sliding_local_dilated__glu_gated_geglu__prompt_kernel,@function
interleave_layers__sliding_local_dilated__glu_gated_geglu__prompt_kernel:
    s_cmp_ge_u32 s2, 256
    s_cbranch_scc1 L_end
    s_load_dwordx16 s[4:19], s[0:1], 0
    s_load_dwordx4 s[20:23], s[0:1], 64
    v_and_b32 v1, 63, v0
    v_lshrrev_b32 v230, 6, v0
    v_lshlrev_b32 v2, 4, v1
    v_readfirstlane_b32 s66, v230
    s_bfe_u32 s62, s2, 0x20001
    s_lshl_b32 s62, s62, 1
    s_lshr_b32 s63, s2, 7
    s_or_b32 s62, s62, s63
    s_bfe_u32 s63, s2, 0x20003
    s_lshl3_add_u32 s62, s63, s62
    s_bfe_u32 s63, s2, 0x10000
    s_lshl_b32 s63, s63, 5
    s_or_b32 s62, s62, s63
    s_bfe_u32 s63, s2, 0x20005
    s_lshl_b32 s63, s63, 6
    s_or_b32 s64, s62, s63
    s_and_b32 s62, s64, 7
    s_lshr_b32 s63, s64, 3
    s_and_b32 s68, s63, 7
    s_and_b32 s70, s63, 15
    s_lshr_b32 s64, s63, 3
    s_lshl_b32 s67, s62, 2
    s_add_u32 s67, s67, s64
    s_lshr_b32 s69, s67, 1
    s_mov_b32 s71, 0
    s_mov_b32 s96, 12
    s_mov_b32 s3, 4
    s_mov_b32 s91, 0
    s_and_b32 s72, s66, 1
    s_lshr_b32 s73, s66, 1
    v_mov_b32 v54, 1
    v_mov_b32 v55, 0
    v_mov_b32 v50, 0
    v_mov_b32 v51, 0
    v_and_b32 v230, 15, v1
    v_lshrrev_b32 v231, 4, v1
    v_and_b32 v232, 31, v1
    v_lshrrev_b32 v233, 5, v1
    v_lshrrev_b32 v234, 3, v1
    v_and_b32 v235, 7, v1
    v_bfe_u32 v236, v1, 2, 2
    v_and_b32 v237, 3, v1
    v_and_b32 v238, 3, v234
    v_lshl_add_u32 v238, v233, 3, v238
    v_mul_u32_u24 v238, 3072, v238
    v_lshrrev_b32 v239, 1, v235
    v_xor_b32 v239, v239, v231
    v_lshl_add_u32 v238, v239, 5, v238
    v_and_b32 v239, 1, v1
    v_lshl_add_u32 v238, v239, 4, v238
    s_lshl_b32 s62, s68, 7
    v_add_u32 v5, s62, v238
    s_lshl_b32 s63, s72, 2
    v_xor_b32 v239, v235, v231
    v_xor_b32 v239, s63, v239
    v_lshlrev_b32 v238, 10, v234
    v_lshl_add_u32 v8, v239, 4, v238
    s_mul_i32 s81, s66, 49152
    s_mul_i32 s80, s66, 6144
    s_add_u32 s80, s80, 81920
    s_lshl_b32 s62, s67, 16
    s_add_u32 s62, s62, 0xffffc000
    s_mul_i32 s63, s72, 8192
    s_add_u32 s62, s62, s63
    s_lshl_b32 s63, s73, 14
    s_add_u32 s74, s62, s63
    s_add_u32 s75, s74, 32768
    s_add_u32 s76, s62, 65536
    s_or_b32 s63, s67, s73
    s_cmp_eq_u32 s63, 0
    s_cselect_b32 s74, 0x80000000, s74
    s_lshl_b32 s77, s66, 10
    s_add_u32 s78, s77, 4096
    s_mul_i32 s63, s73, 10240
    s_lshl_b32 s79, s72, 10
    s_add_u32 s79, s79, s63
    s_add_u32 s79, s79, 8192
    s_lshl_b32 s85, s68, 7
    s_add_u32 s86, s68, s73
    s_lshl_b32 s86, s86, 7
    s_waitcnt lgkmcnt(0)
    s_mov_b32 s36, s4
    s_and_b32 s37, s5, 0xffff
    s_mov_b32 s38, 0x200000
    s_mov_b32 s39, 0x20000
    s_mov_b32 s28, s6
    s_and_b32 s29, s7, 0xffff
    s_mov_b32 s30, 0x180000
    s_mov_b32 s31, 0x20000
    s_mov_b32 s24, s22
    s_and_b32 s25, s23, 0xffff
    s_mov_b32 s26, 0x10000000
    s_mov_b32 s27, 0x20000
    s_mov_b32 s48, s20
    s_and_b32 s49, s21, 0xffff
    s_mov_b32 s50, 0x100
    s_mov_b32 s51, 0x20000
    s_sub_u32 s62, s2, 24
    s_or_b32 s62, s62, s66
    s_cbranch_scc1 L_zero_1
    v_lshlrev_b32 v240, 7, v1
    s_mov_b32 s62, 0
    v_mov_b32 v56, 0
    v_mov_b32 v57, 0
    v_mov_b32 v58, 0
    buffer_store_dwordx3 v[56:58], v240, s[24:27], s62 offen sc1
    s_add_u32 s62, s62, 8192
    buffer_store_dwordx3 v[56:58], v240, s[24:27], s62 offen sc1
    s_add_u32 s62, s62, 8192
    buffer_store_dwordx3 v[56:58], v240, s[24:27], s62 offen sc1
    s_add_u32 s62, s62, 8192
    buffer_store_dwordx3 v[56:58], v240, s[24:27], s62 offen sc1
    s_add_u32 s62, s62, 8192
    buffer_store_dwordx3 v[56:58], v240, s[24:27], s62 offen sc1
    s_add_u32 s62, s62, 8192
    buffer_store_dwordx3 v[56:58], v240, s[24:27], s62 offen sc1
    s_add_u32 s62, s62, 8192
L_zero_1:
    s_add_u32 m0, s77, 0
    s_add_u32 s63, s85, 0
    s_and_b32 s63, s63, 0x380
    s_add_u32 s63, s63, s74
    buffer_load_dwordx4 v8, s[36:39], s63 offen lds
    s_add_u32 m0, s78, 0
    s_add_u32 s63, s85, 0
    s_and_b32 s63, s63, 0x380
    s_add_u32 s63, s63, s75
    buffer_load_dwordx4 v8, s[36:39], s63 offen lds
    s_add_u32 m0, s79, 0
    s_add_u32 s63, s86, 0
    s_and_b32 s63, s63, 0x380
    s_add_u32 s63, s63, s76
    buffer_load_dwordx4 v8, s[36:39], s63 offen lds
    s_add_u32 m0, s80, 0
    s_add_u32 s63, s68, 0
    s_and_b32 s63, s63, 7
    s_mul_i32 s63, s63, 196608
    s_add_u32 s63, s63, s81
    buffer_load_dwordx4 v5, s[28:31], s63 offen offset:0 lds
    buffer_load_dwordx4 v5, s[28:31], s63 offen offset:1024 lds
    buffer_load_dwordx4 v5, s[28:31], s63 offen offset:2048 lds
    s_add_u32 m0, s80, 3072
    s_add_u32 s63, s63, 0x3000
    buffer_load_dwordx4 v5, s[28:31], s63 offen offset:0 lds
    buffer_load_dwordx4 v5, s[28:31], s63 offen offset:1024 lds
    buffer_load_dwordx4 v5, s[28:31], s63 offen offset:2048 lds
    s_getpc_b64 s[44:45]
L_pc_2:
    s_sub_u32 s44, s44, L_pc_2-interleave_layers__sliding_local_dilated__glu_gated_geglu__prompt_kernel
    s_subb_u32 s45, s45, 0
    s_and_b32 s45, s45, 0xffff
    s_mov_b32 s47, 0x20000
    s_mov_b32 s46, L_codeend-interleave_layers__sliding_local_dilated__glu_gated_geglu__prompt_kernel
    s_lshr_b32 s62, s2, 3
    s_lshl_b32 s62, s62, 2
    s_add_u32 s62, s62, s66
    s_lshl_b32 s62, s62, 7
    s_add_u32 s62, s62, (interleave_layers__sliding_local_dilated__glu_gated_geglu__prompt_kernel-interleave_layers__sliding_local_dilated__glu_gated_geglu__prompt_kernel)&0xffffff80
    v_min_u32 v229, 7, v1
    v_lshl_add_u32 v229, v229, 14, s62
    buffer_load_dword v255, v229, s[44:47], 0 offen
    s_mul_i32 s64, s2, 6144
    s_add_u32 s64, s64, 0
    s_lshl_b32 s65, s66, 7
    s_add_u32 s64, s64, s65
    v_min_u32 v229, 11, v1
    v_lshlrev_b32 v229, 9, v229
    buffer_load_dword v255, v229, s[28:31], s64 offen
    s_mov_b32 s32, s8
    s_and_b32 s33, s9, 0xffff
    s_mov_b32 s34, 0x80000
    s_mov_b32 s35, 0x20000
    v_and_b32 v239, 1, v231
    v_lshl_add_u32 v240, v239, 2, v236
    v_lshrrev_b32 v238, 1, v240
    v_xor_b32 v238, s66, v238
    v_lshlrev_b32 v238, 5, v238
    v_lshl_add_u32 v238, v240, 7, v238
    v_lshl_add_u32 v238, v237, 3, v238
    v_mul_u32_u24 v240, 6144, v233
    v_add_u32 v238, v240, v238
    v_add_u32 v6, 0x14000, v238
    v_add_u32 v7, 0x20000, v238
    v_lshrrev_b32 v238, 1, v230
    v_xor_b32 v238, v238, v231
    v_lshlrev_b32 v238, 4, v238
    v_lshl_add_u32 v9, v230, 7, v238
    v_xor_b32 v10, 64, v9
    v_mov_b32 v46, 0x3f803f80
    v_mov_b32 v47, 0x3f803f80
    v_mov_b32 v48, 0x3f803f80
    v_mov_b32 v49, 0x3f803f80
    v_lshrrev_b32 v238, 1, v230
    v_lshl_add_u32 v239, s73, 2, v233
    v_xor_b32 v238, v238, v239
    v_lshl_add_u32 v239, s72, 5, v232
    v_add_u32 v239, 16, v239
    v_lshlrev_b32 v238, 4, v238
    v_lshl_add_u32 v26, v239, 7, v238
    v_xor_b32 v30, 32, v26
    s_lshl_b32 s62, s68, 2
    s_add_u32 s62, s62, s66
    s_mul_i32 s95, s62, 49152
    s_add_u32 s62, s66, 1
    s_lshl_b32 s62, s62, 11
    v_add_u32 v204, s62, v9
    v_add_u32 v205, s62, v10
    v_add_u32 v206, 40960, v204
    v_add_u32 v207, 40960, v205
    s_lshl_b32 s62, s72, 6
    v_xor_b32 v208, s62, v9
    s_mul_i32 s62, s73, 10240
    v_add_u32 v208, s62, v208
    s_and_b32 s62, s67, 3
    s_mul_i32 s62, s62, 7
    s_add_u32 s62, s62, s68
    s_cmp_gt_u32 s68, 3
    s_subb_u32 s62, s62, 0
    s_cmp_eq_u32 s68, 3
    s_cselect_b32 s62, 28, s62
    s_lshl_b32 s62, s62, 3
    s_lshr_b32 s97, s67, 2
    s_add_u32 s97, s97, s62
    s_cmp_ge_u32 s97, 112
    s_cselect_b32 s44, s14, s12
    s_cselect_b32 s45, s15, s13
    s_cselect_b32 s62, 112, 0
    s_and_b32 s45, s45, 0xffff
    s_mov_b32 s46, 0x1c0000
    s_mov_b32 s47, 0x20000
    s_mov_b32 s4, s16
    s_and_b32 s5, s17, 0xffff
    s_mov_b32 s6, 0x1c0000
    s_mov_b32 s7, 0x20000
    s_sub_u32 s62, s97, s62
    s_and_b32 s64, s62, 3
    s_lshl_b32 s64, s64, 2
    s_add_u32 s64, s64, s66
    s_mul_i32 s64, s64, 114688
    s_lshr_b32 s62, s62, 2
    s_lshl_b32 s62, s62, 7
    s_add_u32 s87, s64, s62
    s_cmp_ge_u32 s97, 224
    s_cselect_b32 s87, 0x80000000, s87
    s_lshr_b32 s64, s97, 3
    s_lshl_b32 s64, s64, 2
    s_add_u32 s64, s64, s66
    s_lshl_b32 s64, s64, 14
    s_and_b32 s62, s97, 7
    s_lshl_b32 s62, s62, 7
    s_add_u32 s84, s64, s62
    v_lshrrev_b32 v227, 3, v1
    v_and_b32 v228, 7, v1
    v_lshlrev_b32 v228, 4, v228
    v_mul_u32_u24 v226, 3584, v227
    v_add_u32 v226, v226, v228
    v_lshl_add_u32 v227, v227, 10, v228
    s_lshr_b32 s62, s2, 3
    v_lshl_add_u32 v228, v1, 5, s62
    v_min_u32 v228, 0x100, v228
    v_lshlrev_b32 v228, 20, v228
    s_mov_b32 s40, s18
    s_and_b32 s41, s19, 0xffff
    s_mov_b32 s42, 0x200000
    s_mov_b32 s43, 0x20000
    v_lshlrev_b32 v238, 4, v230
    v_lshl_add_u32 v238, v233, 8, v238
    v_and_b32 v239, 1, v231
    v_lshl_add_u32 v3, v239, 15, v238
    v_lshl_add_u32 v4, v239, 17, v238
    v_lshlrev_b32 v238, 10, v232
    v_lshl_add_u32 v17, v233, 4, v238
    v_and_b32 v238, 1, v231
    v_lshlrev_b32 v238, 1, v238
    v_lshrrev_b32 v239, 1, v235
    v_xor_b32 v238, v238, v239
    v_lshlrev_b32 v238, 5, v238
    v_lshl_add_u32 v238, v234, 10, v238
    v_and_b32 v239, 1, v1
    v_lshl_add_u32 v238, v239, 4, v238
    s_lshl_b32 s62, s68, 7
    v_add_u32 v11, s62, v238
    v_add_u32 v12, 7168, v11
    v_lshrrev_b32 v238, 1, v236
    v_xor_b32 v238, s73, v238
    v_and_b32 v239, 1, v231
    v_lshl_add_u32 v238, v238, 1, v239
    v_lshlrev_b32 v238, 5, v238
    v_lshl_add_u32 v239, v233, 3, v236
    v_lshl_add_u32 v238, v239, 7, v238
    v_and_b32 v239, 1, v237
    v_lshl_add_u32 v238, v239, 4, v238
    v_lshrrev_b32 v239, 1, v237
    v_lshl_add_u32 v238, v239, 3, v238
    s_lshl_b32 s62, s73, 14
    v_add_u32 v13, s62, v238
    v_xor_b32 v14, 64, v13
    s_lshl_b32 s82, s66, 13
    v_add_u32 v15, 0x10000, v2
    v_add_u32 v16, 0x1000, v2
    v_add_u32 v18, 0x24000, v2
    v_lshlrev_b32 v19, 3, v232
    v_lshl_add_u32 v20, v233, 17, v19
    v_lshlrev_b32 v238, 3, v230
    v_lshl_add_u32 v21, v231, 14, v238
    s_add_u32 m0, s77, 10240
    s_add_u32 s63, s85, 128
    s_and_b32 s63, s63, 0x380
    s_add_u32 s63, s63, s74
    buffer_load_dwordx4 v8, s[36:39], s63 offen lds
    s_add_u32 m0, s78, 10240
    s_add_u32 s63, s85, 128
    s_and_b32 s63, s63, 0x380
    s_add_u32 s63, s63, s75
    buffer_load_dwordx4 v8, s[36:39], s63 offen lds
    s_add_u32 m0, s80, 24576
    s_add_u32 s63, s68, 1
    s_and_b32 s63, s63, 7
    s_mul_i32 s63, s63, 196608
    s_add_u32 s63, s63, s81
    buffer_load_dwordx4 v5, s[28:31], s63 offen offset:0 lds
    buffer_load_dwordx4 v5, s[28:31], s63 offen offset:1024 lds
    buffer_load_dwordx4 v5, s[28:31], s63 offen offset:2048 lds
    s_add_u32 m0, s80, 27648
    s_add_u32 s63, s63, 0x3000
    buffer_load_dwordx4 v5, s[28:31], s63 offen offset:0 lds
    buffer_load_dwordx4 v5, s[28:31], s63 offen offset:1024 lds
    buffer_load_dwordx4 v5, s[28:31], s63 offen offset:2048 lds
    s_cmp_lg_u32 s2, 24
    s_cbranch_scc1 L_prb_3
    s_lshl_b32 s64, s72, 6
    s_add_u32 s64, s64, s66
    s_add_u32 s64, s64, 312
    s_lshl_b32 s64, s64, 7
    s_xor_b32 s65, s64, 0x2000
    s_memtime s[52:53]
    s_load_dword s62, s[22:23], s64 glc
    s_waitcnt lgkmcnt(0)
    s_memtime s[54:55]
    s_load_dword s62, s[22:23], s65 glc
    s_waitcnt lgkmcnt(0)
    s_memtime s[56:57]
    s_sub_u32 s52, s54, s52
    s_add_u32 s64, s64, 512
    s_add_u32 s65, s65, 512
    s_waitcnt lgkmcnt(0)
    s_sub_u32 s56, s56, s54
    s_mov_b32 s60, s52
    s_mov_b32 s61, s56
    s_memtime s[52:53]
    s_load_dword s62, s[22:23], s64 glc
    s_waitcnt lgkmcnt(0)
    s_memtime s[54:55]
    s_load_dword s62, s[22:23], s65 glc
    s_waitcnt lgkmcnt(0)
    s_memtime s[56:57]
    s_sub_u32 s52, s54, s52
    s_add_u32 s64, s64, 512
    s_add_u32 s65, s65, 512
    s_waitcnt lgkmcnt(0)
    s_sub_u32 s56, s56, s54
    s_min_u32 s60, s60, s52
    s_min_u32 s61, s61, s56
    s_sub_i32 s52, s60, s61
    s_min_i32 s52, s52, 400
    s_max_i32 s52, s52, -400
    s_lshl_b32 s62, s72, 1
    s_sub_i32 s62, 1, s62
    s_mul_i32 s52, s52, s62
    s_lshl_b32 s62, s66, 2
    s_add_u32 s62, s62, 0x27e00
    v_mov_b32 v51, s62
    v_mov_b32 v53, s52
    ds_write_b32 v51, v53
    s_waitcnt lgkmcnt(0)
L_prb_3:
    v_and_b32 v238, 1, v1
    v_cmp_eq_u32 s[52:53], 1, v238
    v_lshl_add_u32 v239, v231, 2, v238
    v_cmp_le_u32 s[54:55], v239, v230
    v_add_u32 v239, 2, v239
    v_cmp_le_u32 s[56:57], v239, v230
    v_mov_b32 v238, 0xffff
    v_mov_b32 v239, 0xffff0000
    v_cndmask_b32 v238, v238, v239, s[52:53]
    v_cndmask_b32 v22, v238, 0, s[54:55]
    v_cndmask_b32 v23, 0, v238, s[54:55]
    v_cndmask_b32 v24, v238, 0, s[56:57]
    v_cndmask_b32 v25, 0, v238, s[56:57]
    s_cmp_lg_u32 s67, 0
    s_cselect_b64 s[60:61], -1, 0
    s_lshl_b32 s63, s68, 2
    s_add_u32 s63, s63, s66
    s_and_b32 s62, s67, 15
    s_lshl_b32 s62, s62, 3
    s_lshr_b32 s64, s68, 2
    s_add_u32 s62, s62, s64
    s_lshl_b32 s62, s62, 14
    s_and_b32 s63, s63, 15
    s_lshl_b32 s64, s63, 9
    s_add_u32 s64, s64, s62
    s_add_u32 s92, s64, 0x600000
    s_lshr_b32 s63, s63, 1
    s_lshl_b32 s63, s63, 10
    s_add_u32 s62, s62, s63
    s_lshl_b32 s63, s72, 16
    s_add_u32 s62, s62, s63
    s_add_u32 s93, s62, 0x800000
    s_lshl_b32 s64, s68, 1
    s_add_u32 s64, s64, s73
    s_lshl_b32 s64, s64, 14
    s_and_b32 s65, s67, 15
    s_lshl_b32 s65, s65, 1
    s_add_u32 s65, s65, s72
    s_lshl_b32 s65, s65, 8
    s_add_u32 s65, s65, s64
    s_add_u32 s94, s65, 0x540000
    s_mul_i32 s83, s70, 229376
    s_add_u32 s83, s83, s82
    s_add_u32 s83, s83, 0x100000
    s_lshl_b32 s62, s66, 10
    s_add_u32 s62, s62, 0x26800
    v_add_u32 v210, s62, v2
    v_lshrrev_b32 v216, 4, v1
    v_bfe_u32 v211, v1, 2, 2
    v_lshl_add_u32 v211, v211, 2, v216
    v_lshlrev_b32 v211, 5, v211
    v_and_b32 v217, 1, v1
    v_lshl_add_u32 v211, v217, 4, v211
    v_bfe_u32 v217, v1, 1, 1
    v_lshl_add_u32 v211, v217, 3, v211
    v_add_u32 v211, s62, v211
    v_and_b32 v213, 0xf0, v2
    v_lshl_add_u32 v212, v216, 15, v213
    s_lshl_b32 s62, s66, 8
    s_add_u32 s62, s62, 0x27800
    v_add_u32 v214, s62, v213
    s_lshl_b32 s62, s66, 2
    s_add_u32 s62, s62, 0x27800
    v_add_u32 v215, s62, v213
    v_and_b32 v217, 1, v216
    v_lshl_add_u32 v254, v217, 8, v213
    v_lshrrev_b32 v217, 1, v216
    v_mul_u32_u24 v217, 0x1c000, v217
    v_add_u32 v254, v254, v217
    v_and_b32 v217, 15, v1
    v_cmp_eq_u32 vcc, v217, v216
    s_cmp_ge_u32 s97, 112
    s_cselect_b32 s64, 256, 0
    s_cselect_b32 s62, 112, 0
    s_sub_u32 s62, s97, s62
    s_and_b32 s65, s62, 3
    s_and_b32 s63, s62, 0xfc
    v_cndmask_b32 v216, 0, v46, vcc
    v_cndmask_b32 v217, 0, v46, vcc
    v_cndmask_b32 v218, 0, v46, vcc
    v_cndmask_b32 v219, 0, v46, vcc
    s_add_u32 s14, s63, s66
    s_lshl_b32 s14, s14, 10
    s_add_u32 s14, s14, s64
    s_lshr_b32 s62, s65, 1
    s_lshl_b32 s62, s62, 9
    s_add_u32 s14, s14, s62
    s_and_b32 s62, s65, 1
    s_lshl_b32 s62, s62, 3
    s_add_u32 s14, s14, s62
    s_add_u32 s14, s14, 0x500000
    s_lshl_b32 s63, s63, 15
    s_lshl_b32 s65, s65, 2
    s_add_u32 s65, s65, s66
    s_lshl_b32 s65, s65, 11
    s_add_u32 s12, s64, s63
    s_add_u32 s12, s12, s65
    s_add_u32 s12, s12, 0x100000
    s_and_b32 s13, s97, 7
    s_mul_i32 s13, s13, 229376
    s_lshr_b32 s65, s97, 3
    s_lshl_b32 s65, s65, 2
    s_add_u32 s65, s65, s66
    s_lshl_b32 s65, s65, 10
    s_add_u32 s13, s13, s65
    s_add_u32 s13, s13, 0x2200000
    s_cmp_ge_u32 s97, 224
    s_cselect_b32 s12, 0x80000000, s12
    s_cselect_b32 s13, 0x80000000, s13
    s_cselect_b32 s14, 0x80000000, s14
    s_add_u32 m0, s77, 20480
    s_add_u32 s63, s85, 256
    s_and_b32 s63, s63, 0x380
    s_add_u32 s63, s63, s74
    buffer_load_dwordx4 v8, s[36:39], s63 offen lds
    s_add_u32 m0, s78, 20480
    s_add_u32 s63, s85, 256
    s_and_b32 s63, s63, 0x380
    s_add_u32 s63, s63, s75
    buffer_load_dwordx4 v8, s[36:39], s63 offen lds
    s_add_u32 m0, s79, 20480
    s_add_u32 s63, s86, 256
    s_and_b32 s63, s63, 0x380
    s_add_u32 s63, s63, s76
    buffer_load_dwordx4 v8, s[36:39], s63 offen lds
    s_add_u32 m0, s77, 30720
    s_add_u32 s63, s85, 384
    s_and_b32 s63, s63, 0x380
    s_add_u32 s63, s63, s74
    buffer_load_dwordx4 v8, s[36:39], s63 offen lds
    s_add_u32 m0, s78, 30720
    s_add_u32 s63, s85, 384
    s_and_b32 s63, s63, 0x380
    s_add_u32 s63, s63, s75
    buffer_load_dwordx4 v8, s[36:39], s63 offen lds
    s_waitcnt vmcnt(15)
    s_barrier
    ds_read_b64_tr_b16 v[156:157], v6 offset:1024
    ds_read_b64_tr_b16 v[158:159], v6 offset:4096
    ds_read_b128 v[112:115], v9 offset:0
    ds_read_b64_tr_b16 v[160:161], v6 offset:2048
    ds_read_b64_tr_b16 v[162:163], v6 offset:5120
    ds_read_b128 v[116:119], v9 offset:2048
    ds_read_b64_tr_b16 v[152:153], v6 offset:0
    ds_read_b64_tr_b16 v[154:155], v6 offset:3072
    ds_read_b128 v[120:123], v9 offset:4096
    ds_read_b128 v[124:127], v9 offset:6144
    ds_read_b128 v[128:131], v9 offset:8192
    ds_read_b128 v[26:29], v26
    ds_read_b128 v[30:33], v30
    s_waitcnt lgkmcnt(5)
    v_mfma_f32_16x16x32_bf16 v[72:75], v[156:159], v[112:115], 0
    ds_read_b64_tr_b16 v[168:169], v6 offset:13312
    ds_read_b64_tr_b16 v[170:171], v6 offset:16384
    s_add_u32 m0, s80, 49152
    s_add_u32 s63, s68, 2
    s_and_b32 s63, s63, 7
    s_mul_i32 s63, s63, 196608
    s_add_u32 s63, s63, s81
    buffer_load_dwordx4 v5, s[28:31], s63 offen offset:0 lds
    v_mfma_f32_16x16x32_bf16 v[92:95], v[112:115], v[160:163], 0
    ds_read_b128 v[132:135], v10 offset:0
    ds_read_b64_tr_b16 v[172:173], v6 offset:14336
    buffer_load_dwordx4 v5, s[28:31], s63 offen offset:1024 lds
    v_mfma_f32_16x16x32_bf16 v[76:79], v[156:159], v[116:119], 0
    ds_read_b64_tr_b16 v[174:175], v6 offset:17408
    ds_read_b128 v[136:139], v10 offset:2048
    buffer_load_dwordx4 v5, s[28:31], s63 offen offset:2048 lds
    v_mfma_f32_16x16x32_bf16 v[96:99], v[116:119], v[160:163], 0
    ds_read_b64_tr_b16 v[164:165], v6 offset:12288
    ds_read_b64_tr_b16 v[166:167], v6 offset:15360
    s_add_u32 m0, s80, 52224
    s_add_u32 s63, s63, 0x3000
    buffer_load_dwordx4 v5, s[28:31], s63 offen offset:0 lds
    v_mfma_f32_16x16x32_bf16 v[56:59], v[152:155], v[116:119], 0
    ds_read_b128 v[140:143], v10 offset:4096
    ds_read_b128 v[144:147], v10 offset:6144
    buffer_load_dwordx4 v5, s[28:31], s63 offen offset:1024 lds
    s_waitcnt lgkmcnt(12)
    v_mfma_f32_16x16x32_bf16 v[80:83], v[156:159], v[120:123], 0
    ds_read_b128 v[148:151], v10 offset:8192
    buffer_load_dwordx4 v5, s[28:31], s63 offen offset:2048 lds
    v_mfma_f32_16x16x32_bf16 v[100:103], v[120:123], v[160:163], 0
    v_mfma_f32_16x16x32_bf16 v[60:63], v[152:155], v[120:123], 0
    v_mfma_f32_16x16x32_bf16 v[84:87], v[156:159], v[124:127], 0
    v_mfma_f32_16x16x32_bf16 v[104:107], v[124:127], v[160:163], 0
    v_mfma_f32_16x16x32_bf16 v[64:67], v[152:155], v[124:127], 0
    v_mfma_f32_16x16x32_bf16 v[88:91], v[156:159], v[128:131], 0
    v_mfma_f32_16x16x32_bf16 v[108:111], v[128:131], v[160:163], 0
    v_mfma_f32_16x16x32_bf16 v[68:71], v[152:155], v[128:131], 0
    v_mfma_f32_16x16x32_bf16 v[34:37], v[152:155], v[46:49], 0
    v_mfma_f32_16x16x32_bf16 v[38:41], v[156:159], v[46:49], 0
    v_mfma_f32_16x16x32_bf16 v[42:45], v[46:49], v[160:163], 0
    s_cmp_eq_u32 s67, 0
    s_cbranch_scc1 L_im_4
L_imb_5:
    s_waitcnt lgkmcnt(0)
    s_waitcnt vmcnt(11)
    s_barrier
    s_sub_u32 s62, s2, 24
    s_or_b32 s62, s62, s66
    s_cbranch_scc0 L_pub_6
L_pubb_7:
    ds_read_b128 v[176:179], v204 offset:0
    ds_read_b128 v[180:183], v205 offset:0
    v_mfma_f32_16x16x32_bf16 v[72:75], v[168:171], v[132:135], v[72:75]
    ds_read_b64_tr_b16 v[156:157], v6 offset:25600
    s_add_u32 m0, s80, 0
    s_add_u32 s63, s68, 3
    s_and_b32 s63, s63, 7
    s_mul_i32 s63, s63, 196608
    s_add_u32 s63, s63, s81
    buffer_load_dwordx4 v5, s[28:31], s63 offen offset:0 lds
    v_mfma_f32_16x16x32_bf16 v[92:95], v[132:135], v[172:175], v[92:95]
    ds_read_b64_tr_b16 v[158:159], v6 offset:28672
    buffer_load_dwordx4 v5, s[28:31], s63 offen offset:1024 lds
    v_mfma_f32_16x16x32_bf16 v[76:79], v[168:171], v[136:139], v[76:79]
    ds_read_b128 v[112:115], v9 offset:10240
    buffer_load_dwordx4 v5, s[28:31], s63 offen offset:2048 lds
    v_mfma_f32_16x16x32_bf16 v[96:99], v[136:139], v[172:175], v[96:99]
    ds_read_b64_tr_b16 v[160:161], v6 offset:26624
    s_add_u32 m0, s80, 3072
    s_add_u32 s63, s63, 0x3000
    buffer_load_dwordx4 v5, s[28:31], s63 offen offset:0 lds
    v_mfma_f32_16x16x32_bf16 v[56:59], v[164:167], v[136:139], v[56:59]
    ds_read_b64_tr_b16 v[162:163], v6 offset:29696
    buffer_load_dwordx4 v5, s[28:31], s63 offen offset:1024 lds
    v_mfma_f32_16x16x32_bf16 v[80:83], v[168:171], v[140:143], v[80:83]
    ds_read_b128 v[116:119], v9 offset:12288
    buffer_load_dwordx4 v5, s[28:31], s63 offen offset:2048 lds
    v_mfma_f32_16x16x32_bf16 v[100:103], v[140:143], v[172:175], v[100:103]
    ds_read_b64_tr_b16 v[152:153], v6 offset:24576
    s_add_u32 m0, s77, 40960
    s_add_u32 s63, s85, 512
    s_and_b32 s63, s63, 0x380
    s_add_u32 s63, s63, s74
    buffer_load_dwordx4 v8, s[36:39], s63 offen lds
    s_waitcnt lgkmcnt(8)
    v_mfma_f32_16x16x32_bf16 v[188:191], v[176:179], v[176:179], 0
    v_mfma_f32_16x16x32_bf16 v[60:63], v[164:167], v[140:143], v[60:63]
    ds_read_b64_tr_b16 v[154:155], v6 offset:27648
    s_add_u32 m0, s78, 40960
    s_add_u32 s63, s85, 512
    s_and_b32 s63, s63, 0x380
    s_add_u32 s63, s63, s75
    buffer_load_dwordx4 v8, s[36:39], s63 offen lds
    v_mfma_f32_16x16x32_bf16 v[192:195], v[46:49], v[176:179], 0
    v_mfma_f32_16x16x32_bf16 v[84:87], v[168:171], v[144:147], v[84:87]
    ds_read_b128 v[120:123], v9 offset:14336
    s_add_u32 m0, s79, 40960
    s_add_u32 s63, s86, 512
    s_and_b32 s63, s63, 0x380
    s_add_u32 s63, s63, s76
    buffer_load_dwordx4 v8, s[36:39], s63 offen lds
    s_waitcnt lgkmcnt(9)
    v_mfma_f32_16x16x32_bf16 v[188:191], v[180:183], v[180:183], v[188:191]
    v_mfma_f32_16x16x32_bf16 v[104:107], v[144:147], v[172:175], v[104:107]
    ds_read_b128 v[124:127], v9 offset:16384
    s_add_u32 m0, s77, 51200
    s_add_u32 s63, s85, 640
    s_and_b32 s63, s63, 0x380
    s_add_u32 s63, s63, s74
    buffer_load_dwordx4 v8, s[36:39], s63 offen lds
    v_mfma_f32_16x16x32_bf16 v[192:195], v[46:49], v[180:183], v[192:195]
    v_mfma_f32_16x16x32_bf16 v[64:67], v[164:167], v[144:147], v[64:67]
    ds_read_b128 v[128:131], v9 offset:18432
    s_add_u32 m0, s78, 51200
    s_add_u32 s63, s85, 640
    s_and_b32 s63, s63, 0x380
    s_add_u32 s63, s63, s75
    buffer_load_dwordx4 v8, s[36:39], s63 offen lds
    v_mfma_f32_16x16x32_bf16 v[88:91], v[168:171], v[148:151], v[88:91]
    s_add_u32 s65, s87, 0
    buffer_load_dwordx4 a[0:3], v226, s[44:47], s65 offen
    v_mfma_f32_16x16x32_bf16 v[108:111], v[148:151], v[172:175], v[108:111]
    s_add_u32 s65, s87, 28672
    buffer_load_dwordx4 a[4:7], v226, s[44:47], s65 offen
    v_mfma_f32_16x16x32_bf16 v[68:71], v[164:167], v[148:151], v[68:71]
    v_mfma_f32_16x16x32_bf16 v[34:37], v[164:167], v[46:49], v[34:37]
    v_mfma_f32_16x16x32_bf16 v[38:41], v[168:171], v[46:49], v[38:41]
    v_mfma_f32_16x16x32_bf16 v[42:45], v[46:49], v[172:175], v[42:45]
    s_cmp_eq_u32 s67, 2
    s_cbranch_scc1 L_im_8
L_imb_9:
    ds_read_b128 v[176:179], v204 offset:10240
    ds_read_b128 v[180:183], v205 offset:10240
    ds_read_b128 v[184:187], v208 offset:0
    s_waitcnt lgkmcnt(6)
    v_mfma_f32_16x16x32_bf16 v[72:75], v[156:159], v[112:115], v[72:75]
    ds_read_b64_tr_b16 v[168:169], v6 offset:37888
    ds_read_b64_tr_b16 v[170:171], v6 offset:40960
    s_add_u32 m0, s77, 61440
    s_add_u32 s63, s85, 768
    s_and_b32 s63, s63, 0x380
    s_add_u32 s63, s63, s74
    buffer_load_dwordx4 v8, s[36:39], s63 offen lds
    v_mfma_f32_16x16x32_bf16 v[92:95], v[112:115], v[160:163], v[92:95]
    ds_read_b128 v[132:135], v10 offset:10240
    ds_read_b64_tr_b16 v[172:173], v6 offset:38912
    s_add_u32 m0, s78, 61440
    s_add_u32 s63, s85, 768
    s_and_b32 s63, s63, 0x380
    s_add_u32 s63, s63, s75
    buffer_load_dwordx4 v8, s[36:39], s63 offen lds
    v_mfma_f32_16x16x32_bf16 v[76:79], v[156:159], v[116:119], v[76:79]
    ds_read_b64_tr_b16 v[174:175], v6 offset:41984
    ds_read_b128 v[136:139], v10 offset:12288
    s_add_u32 m0, s79, 61440
    s_add_u32 s63, s86, 768
    s_and_b32 s63, s63, 0x380
    s_add_u32 s63, s63, s76
    buffer_load_dwordx4 v8, s[36:39], s63 offen lds
    v_mfma_f32_16x16x32_bf16 v[96:99], v[116:119], v[160:163], v[96:99]
    ds_read_b64_tr_b16 v[164:165], v6 offset:36864
    ds_read_b64_tr_b16 v[166:167], v6 offset:39936
    s_add_u32 m0, s77, 71680
    s_add_u32 s63, s85, 896
    s_and_b32 s63, s63, 0x380
    s_add_u32 s63, s63, s74
    buffer_load_dwordx4 v8, s[36:39], s63 offen lds
    v_mfma_f32_16x16x32_bf16 v[56:59], v[152:155], v[116:119], v[56:59]
    ds_read_b128 v[140:143], v10 offset:14336
    ds_read_b128 v[144:147], v10 offset:16384
    s_add_u32 m0, s78, 71680
    s_add_u32 s63, s85, 896
    s_and_b32 s63, s63, 0x380
    s_add_u32 s63, s63, s75
    buffer_load_dwordx4 v8, s[36:39], s63 offen lds
    s_waitcnt lgkmcnt(13)
    v_mfma_f32_16x16x32_bf16 v[80:83], v[156:159], v[120:123], v[80:83]
    ds_read_b128 v[148:151], v10 offset:18432
    s_lshl_b32 s64, s2, 11
    s_lshl_b32 s65, s72, 10
    s_add_u32 s64, s64, s65
    s_lshr_b32 s65, s2, 3
    s_lshl_b32 s65, s65, 1
    s_add_u32 s65, s65, s72
    s_lshl_b32 s65, s65, 13
    s_add_u32 s65, s65, 384
    s_cmp_ge_u32 s68, 4
    s_cselect_b32 s65, 0x80000000, s65
    s_cmp_eq_u32 s73, 0
    s_cselect_b32 s64, s64, s65
    s_cselect_b32 s65, 7, 10
    v_min_u32 v229, 7, v1
    v_lshlrev_b32 v229, s65, v229
    buffer_load_dword v255, v229, s[32:35], s64 offen
    v_mfma_f32_16x16x32_bf16 v[100:103], v[120:123], v[160:163], v[100:103]
    s_add_u32 s65, s87, 57344
    buffer_load_dwordx4 a[8:11], v226, s[44:47], s65 offen
    s_waitcnt lgkmcnt(13)
    v_mfma_f32_16x16x32_bf16 v[188:191], v[176:179], v[176:179], v[188:191]
    v_mfma_f32_16x16x32_bf16 v[60:63], v[152:155], v[120:123], v[60:63]
    s_add_u32 s65, s87, 86016
    buffer_load_dwordx4 a[12:15], v226, s[44:47], s65 offen
    v_mfma_f32_16x16x32_bf16 v[192:195], v[46:49], v[176:179], v[192:195]
    v_mfma_f32_16x16x32_bf16 v[84:87], v[156:159], v[124:127], v[84:87]
    s_waitcnt lgkmcnt(12)
    v_mfma_f32_16x16x32_bf16 v[188:191], v[180:183], v[180:183], v[188:191]
    v_mfma_f32_16x16x32_bf16 v[104:107], v[124:127], v[160:163], v[104:107]
    v_mfma_f32_16x16x32_bf16 v[192:195], v[46:49], v[180:183], v[192:195]
    v_mfma_f32_16x16x32_bf16 v[64:67], v[152:155], v[124:127], v[64:67]
    s_waitcnt lgkmcnt(11)
    v_mfma_f32_16x16x32_bf16 v[196:199], v[184:187], v[184:187], 0
    v_mfma_f32_16x16x32_bf16 v[88:91], v[156:159], v[128:131], v[88:91]
    v_mfma_f32_16x16x32_bf16 v[200:203], v[46:49], v[184:187], 0
    v_mfma_f32_16x16x32_bf16 v[108:111], v[128:131], v[160:163], v[108:111]
    v_mfma_f32_16x16x32_bf16 v[68:71], v[152:155], v[128:131], v[68:71]
    v_mfma_f32_16x16x32_bf16 v[34:37], v[152:155], v[46:49], v[34:37]
    v_mfma_f32_16x16x32_bf16 v[38:41], v[156:159], v[46:49], v[38:41]
    v_mfma_f32_16x16x32_bf16 v[42:45], v[46:49], v[160:163], v[42:45]
    s_cmp_eq_u32 s67, 4
    s_cbranch_scc1 L_im_10
L_imb_11:
    s_waitcnt lgkmcnt(0)
    s_waitcnt vmcnt(21)
    s_barrier
    ds_read_b128 v[176:179], v204 offset:20480
    ds_read_b128 v[180:183], v205 offset:20480
    v_mfma_f32_16x16x32_bf16 v[72:75], v[168:171], v[132:135], v[72:75]
    ds_read_b64_tr_b16 v[156:157], v7 offset:1024
    v_mfma_f32_16x16x32_bf16 v[92:95], v[132:135], v[172:175], v[92:95]
    ds_read_b64_tr_b16 v[158:159], v7 offset:4096
    s_add_u32 m0, s80, 24576
    s_add_u32 s63, s68, 4
    s_and_b32 s63, s63, 7
    s_mul_i32 s63, s63, 196608
    s_add_u32 s63, s63, s81
    buffer_load_dwordx4 v5, s[28:31], s63 offen offset:0 lds
    v_mfma_f32_16x16x32_bf16 v[76:79], v[168:171], v[136:139], v[76:79]
    ds_read_b128 v[112:115], v9 offset:20480
    v_mfma_f32_16x16x32_bf16 v[96:99], v[136:139], v[172:175], v[96:99]
    ds_read_b64_tr_b16 v[160:161], v7 offset:2048
    buffer_load_dwordx4 v5, s[28:31], s63 offen offset:1024 lds
    v_mfma_f32_16x16x32_bf16 v[56:59], v[164:167], v[136:139], v[56:59]
    ds_read_b64_tr_b16 v[162:163], v7 offset:5120
    buffer_load_dwordx4 v5, s[28:31], s63 offen offset:2048 lds
    v_mfma_f32_16x16x32_bf16 v[80:83], v[168:171], v[140:143], v[80:83]
    ds_read_b128 v[116:119], v9 offset:22528
    s_add_u32 m0, s80, 27648
    s_add_u32 s63, s63, 0x3000
    buffer_load_dwordx4 v5, s[28:31], s63 offen offset:0 lds
    v_mfma_f32_16x16x32_bf16 v[100:103], v[140:143], v[172:175], v[100:103]
    ds_read_b64_tr_b16 v[152:153], v7 offset:0
    s_waitcnt lgkmcnt(8)
    v_mfma_f32_16x16x32_bf16 v[188:191], v[176:179], v[176:179], v[188:191]
    v_mfma_f32_16x16x32_bf16 v[60:63], v[164:167], v[140:143], v[60:63]
    ds_read_b64_tr_b16 v[154:155], v7 offset:3072
    buffer_load_dwordx4 v5, s[28:31], s63 offen offset:1024 lds
    v_mfma_f32_16x16x32_bf16 v[192:195], v[46:49], v[176:179], v[192:195]
    v_mfma_f32_16x16x32_bf16 v[84:87], v[168:171], v[144:147], v[84:87]
    ds_read_b128 v[120:123], v9 offset:24576
    s_waitcnt lgkmcnt(9)
    v_mfma_f32_16x16x32_bf16 v[188:191], v[180:183], v[180:183], v[188:191]
    v_mfma_f32_16x16x32_bf16 v[104:107], v[144:147], v[172:175], v[104:107]
    ds_read_b128 v[124:127], v9 offset:26624
    buffer_load_dwordx4 v5, s[28:31], s63 offen offset:2048 lds
    v_mfma_f32_16x16x32_bf16 v[192:195], v[46:49], v[180:183], v[192:195]
    v_mfma_f32_16x16x32_bf16 v[64:67], v[164:167], v[144:147], v[64:67]
    ds_read_b128 v[128:131], v9 offset:28672
    v_mfma_f32_16x16x32_bf16 v[88:91], v[168:171], v[148:151], v[88:91]
    v_mfma_f32_16x16x32_bf16 v[108:111], v[148:151], v[172:175], v[108:111]
    v_mfma_f32_16x16x32_bf16 v[68:71], v[164:167], v[148:151], v[68:71]
    v_mfma_f32_16x16x32_bf16 v[34:37], v[164:167], v[46:49], v[34:37]
    v_mfma_f32_16x16x32_bf16 v[38:41], v[168:171], v[46:49], v[38:41]
    v_mfma_f32_16x16x32_bf16 v[42:45], v[46:49], v[172:175], v[42:45]
    s_cmp_eq_u32 s67, 6
    s_cbranch_scc1 L_im_12
L_imb_13:
    ds_read_b128 v[176:179], v204 offset:30720
    ds_read_b128 v[180:183], v205 offset:30720
    ds_read_b128 v[184:187], v208 offset:20480
    s_waitcnt lgkmcnt(6)
    v_mfma_f32_16x16x32_bf16 v[72:75], v[156:159], v[112:115], v[72:75]
    ds_read_b64_tr_b16 v[168:169], v7 offset:13312
    ds_read_b64_tr_b16 v[170:171], v7 offset:16384
    v_mfma_f32_16x16x32_bf16 v[92:95], v[112:115], v[160:163], v[92:95]
    ds_read_b128 v[132:135], v10 offset:20480
    ds_read_b64_tr_b16 v[172:173], v7 offset:14336
    v_mfma_f32_16x16x32_bf16 v[76:79], v[156:159], v[116:119], v[76:79]
    ds_read_b64_tr_b16 v[174:175], v7 offset:17408
    ds_read_b128 v[136:139], v10 offset:22528
    v_mfma_f32_16x16x32_bf16 v[96:99], v[116:119], v[160:163], v[96:99]
    ds_read_b64_tr_b16 v[164:165], v7 offset:12288
    ds_read_b64_tr_b16 v[166:167], v7 offset:15360
    v_mfma_f32_16x16x32_bf16 v[56:59], v[152:155], v[116:119], v[56:59]
    ds_read_b128 v[140:143], v10 offset:24576
    ds_read_b128 v[144:147], v10 offset:26624
    s_waitcnt lgkmcnt(13)
    v_mfma_f32_16x16x32_bf16 v[80:83], v[156:159], v[120:123], v[80:83]
    ds_read_b128 v[148:151], v10 offset:28672
    v_mfma_f32_16x16x32_bf16 v[100:103], v[120:123], v[160:163], v[100:103]
    s_waitcnt lgkmcnt(13)
    v_mfma_f32_16x16x32_bf16 v[188:191], v[176:179], v[176:179], v[188:191]
    v_mfma_f32_16x16x32_bf16 v[60:63], v[152:155], v[120:123], v[60:63]
    v_mfma_f32_16x16x32_bf16 v[192:195], v[46:49], v[176:179], v[192:195]
    v_mfma_f32_16x16x32_bf16 v[84:87], v[156:159], v[124:127], v[84:87]
    s_waitcnt lgkmcnt(12)
    v_mfma_f32_16x16x32_bf16 v[188:191], v[180:183], v[180:183], v[188:191]
    v_mfma_f32_16x16x32_bf16 v[104:107], v[124:127], v[160:163], v[104:107]
    v_mfma_f32_16x16x32_bf16 v[192:195], v[46:49], v[180:183], v[192:195]
    v_mfma_f32_16x16x32_bf16 v[64:67], v[152:155], v[124:127], v[64:67]
    s_waitcnt lgkmcnt(11)
    v_mfma_f32_16x16x32_bf16 v[196:199], v[184:187], v[184:187], v[196:199]
    v_mfma_f32_16x16x32_bf16 v[88:91], v[156:159], v[128:131], v[88:91]
    v_mfma_f32_16x16x32_bf16 v[200:203], v[46:49], v[184:187], v[200:203]
    v_mfma_f32_16x16x32_bf16 v[108:111], v[128:131], v[160:163], v[108:111]
    v_mfma_f32_16x16x32_bf16 v[68:71], v[152:155], v[128:131], v[68:71]
    v_mfma_f32_16x16x32_bf16 v[34:37], v[152:155], v[46:49], v[34:37]
    v_mfma_f32_16x16x32_bf16 v[38:41], v[156:159], v[46:49], v[38:41]
    v_mfma_f32_16x16x32_bf16 v[42:45], v[46:49], v[160:163], v[42:45]
    s_cmp_eq_u32 s67, 8
    s_cbranch_scc1 L_im_14
L_imb_15:
    s_waitcnt lgkmcnt(0)
    s_waitcnt vmcnt(16)
    s_barrier
    ds_read_b128 v[176:179], v206 offset:0
    ds_read_b128 v[180:183], v207 offset:0
    v_mfma_f32_16x16x32_bf16 v[72:75], v[168:171], v[132:135], v[72:75]
    ds_read_b64_tr_b16 v[156:157], v6 offset:1024
    v_mfma_f32_16x16x32_bf16 v[92:95], v[132:135], v[172:175], v[92:95]
    ds_read_b64_tr_b16 v[158:159], v6 offset:4096
    s_add_u32 m0, s80, 49152
    s_add_u32 s63, s68, 5
    s_and_b32 s63, s63, 7
    s_mul_i32 s63, s63, 196608
    s_add_u32 s63, s63, s81
    buffer_load_dwordx4 v5, s[28:31], s63 offen offset:0 lds
    v_mfma_f32_16x16x32_bf16 v[76:79], v[168:171], v[136:139], v[76:79]
    ds_read_b128 v[112:115], v9 offset:30720
    v_mfma_f32_16x16x32_bf16 v[96:99], v[136:139], v[172:175], v[96:99]
    ds_read_b64_tr_b16 v[160:161], v6 offset:2048
    buffer_load_dwordx4 v5, s[28:31], s63 offen offset:1024 lds
    v_mfma_f32_16x16x32_bf16 v[56:59], v[164:167], v[136:139], v[56:59]
    ds_read_b64_tr_b16 v[162:163], v6 offset:5120
    buffer_load_dwordx4 v5, s[28:31], s63 offen offset:2048 lds
    v_mfma_f32_16x16x32_bf16 v[80:83], v[168:171], v[140:143], v[80:83]
    ds_read_b128 v[116:119], v9 offset:32768
    s_add_u32 m0, s80, 52224
    s_add_u32 s63, s63, 0x3000
    buffer_load_dwordx4 v5, s[28:31], s63 offen offset:0 lds
    v_mfma_f32_16x16x32_bf16 v[100:103], v[140:143], v[172:175], v[100:103]
    ds_read_b64_tr_b16 v[152:153], v6 offset:0
    s_waitcnt lgkmcnt(8)
    v_mfma_f32_16x16x32_bf16 v[188:191], v[176:179], v[176:179], v[188:191]
    v_mfma_f32_16x16x32_bf16 v[60:63], v[164:167], v[140:143], v[60:63]
    ds_read_b64_tr_b16 v[154:155], v6 offset:3072
    buffer_load_dwordx4 v5, s[28:31], s63 offen offset:1024 lds
    v_mfma_f32_16x16x32_bf16 v[192:195], v[46:49], v[176:179], v[192:195]
    v_mfma_f32_16x16x32_bf16 v[84:87], v[168:171], v[144:147], v[84:87]
    ds_read_b128 v[120:123], v9 offset:34816
    s_waitcnt lgkmcnt(9)
    v_mfma_f32_16x16x32_bf16 v[188:191], v[180:183], v[180:183], v[188:191]
    v_mfma_f32_16x16x32_bf16 v[104:107], v[144:147], v[172:175], v[104:107]
    ds_read_b128 v[124:127], v9 offset:36864
    buffer_load_dwordx4 v5, s[28:31], s63 offen offset:2048 lds
    v_mfma_f32_16x16x32_bf16 v[192:195], v[46:49], v[180:183], v[192:195]
    v_mfma_f32_16x16x32_bf16 v[64:67], v[164:167], v[144:147], v[64:67]
    ds_read_b128 v[128:131], v9 offset:38912
    s_add_u32 s65, s84, 0
    buffer_load_dwordx4 a[16:19], v227, s[4:7], s65 offen
    v_mfma_f32_16x16x32_bf16 v[88:91], v[168:171], v[148:151], v[88:91]
    v_mfma_f32_16x16x32_bf16 v[108:111], v[148:151], v[172:175], v[108:111]
    v_mfma_f32_16x16x32_bf16 v[68:71], v[164:167], v[148:151], v[68:71]
    v_mfma_f32_16x16x32_bf16 v[34:37], v[164:167], v[46:49], v[34:37]
    v_mfma_f32_16x16x32_bf16 v[38:41], v[168:171], v[46:49], v[38:41]
    v_mfma_f32_16x16x32_bf16 v[42:45], v[46:49], v[172:175], v[42:45]
    s_cmp_eq_u32 s67, 10
    s_cbranch_scc1 L_im_16
L_imb_17:
    ds_read_b128 v[176:179], v206 offset:10240
    ds_read_b128 v[180:183], v207 offset:10240
    ds_read_b128 v[184:187], v208 offset:40960
    s_waitcnt lgkmcnt(6)
    v_mfma_f32_16x16x32_bf16 v[72:75], v[156:159], v[112:115], v[72:75]
    ds_read_b64_tr_b16 v[168:169], v6 offset:13312
    ds_read_b64_tr_b16 v[170:171], v6 offset:16384
    v_mfma_f32_16x16x32_bf16 v[92:95], v[112:115], v[160:163], v[92:95]
    ds_read_b128 v[132:135], v10 offset:30720
    ds_read_b64_tr_b16 v[172:173], v6 offset:14336
    s_add_u32 s65, s84, 8192
    buffer_load_dwordx4 a[20:23], v227, s[4:7], s65 offen
    v_mfma_f32_16x16x32_bf16 v[76:79], v[156:159], v[116:119], v[76:79]
    ds_read_b64_tr_b16 v[174:175], v6 offset:17408
    ds_read_b128 v[136:139], v10 offset:32768
    v_mfma_f32_16x16x32_bf16 v[96:99], v[116:119], v[160:163], v[96:99]
    ds_read_b64_tr_b16 v[164:165], v6 offset:12288
    ds_read_b64_tr_b16 v[166:167], v6 offset:15360
    v_mfma_f32_16x16x32_bf16 v[56:59], v[152:155], v[116:119], v[56:59]
    ds_read_b128 v[140:143], v10 offset:34816
    ds_read_b128 v[144:147], v10 offset:36864
    s_waitcnt lgkmcnt(13)
    v_mfma_f32_16x16x32_bf16 v[80:83], v[156:159], v[120:123], v[80:83]
    ds_read_b128 v[148:151], v10 offset:38912
    v_mfma_f32_16x16x32_bf16 v[100:103], v[120:123], v[160:163], v[100:103]
    s_waitcnt lgkmcnt(13)
    v_mfma_f32_16x16x32_bf16 v[188:191], v[176:179], v[176:179], v[188:191]
    v_mfma_f32_16x16x32_bf16 v[60:63], v[152:155], v[120:123], v[60:63]
    v_mfma_f32_16x16x32_bf16 v[192:195], v[46:49], v[176:179], v[192:195]
    v_mfma_f32_16x16x32_bf16 v[84:87], v[156:159], v[124:127], v[84:87]
    s_waitcnt lgkmcnt(12)
    v_mfma_f32_16x16x32_bf16 v[188:191], v[180:183], v[180:183], v[188:191]
    v_mfma_f32_16x16x32_bf16 v[104:107], v[124:127], v[160:163], v[104:107]
    v_mfma_f32_16x16x32_bf16 v[192:195], v[46:49], v[180:183], v[192:195]
    v_mfma_f32_16x16x32_bf16 v[64:67], v[152:155], v[124:127], v[64:67]
    s_waitcnt lgkmcnt(11)
    v_mfma_f32_16x16x32_bf16 v[196:199], v[184:187], v[184:187], v[196:199]
    v_mfma_f32_16x16x32_bf16 v[88:91], v[156:159], v[128:131], v[88:91]
    v_mfma_f32_16x16x32_bf16 v[200:203], v[46:49], v[184:187], v[200:203]
    v_mfma_f32_16x16x32_bf16 v[108:111], v[128:131], v[160:163], v[108:111]
    v_mfma_f32_16x16x32_bf16 v[68:71], v[152:155], v[128:131], v[68:71]
    v_mfma_f32_16x16x32_bf16 v[34:37], v[152:155], v[46:49], v[34:37]
    v_mfma_f32_16x16x32_bf16 v[38:41], v[156:159], v[46:49], v[38:41]
    v_mfma_f32_16x16x32_bf16 v[42:45], v[46:49], v[160:163], v[42:45]
    s_cmp_eq_u32 s67, 12
    s_cbranch_scc1 L_im_18
L_imb_19:
    s_waitcnt lgkmcnt(0)
    s_waitcnt vmcnt(8)
    s_barrier
    v_add_u32 v9, 40960, v9
    v_add_u32 v10, 40960, v10
    ds_read_b128 v[176:179], v206 offset:20480
    ds_read_b128 v[180:183], v207 offset:20480
    v_mfma_f32_16x16x32_bf16 v[72:75], v[168:171], v[132:135], v[72:75]
    ds_read_b64_tr_b16 v[156:157], v6 offset:25600
    v_mfma_f32_16x16x32_bf16 v[92:95], v[132:135], v[172:175], v[92:95]
    ds_read_b64_tr_b16 v[158:159], v6 offset:28672
    s_add_u32 m0, s80, 0
    s_add_u32 s63, s68, 6
    s_and_b32 s63, s63, 7
    s_mul_i32 s63, s63, 196608
    s_add_u32 s63, s63, s81
    buffer_load_dwordx4 v5, s[28:31], s63 offen offset:0 lds
    v_mfma_f32_16x16x32_bf16 v[76:79], v[168:171], v[136:139], v[76:79]
    ds_read_b128 v[112:115], v9 offset:0
    v_mfma_f32_16x16x32_bf16 v[96:99], v[136:139], v[172:175], v[96:99]
    ds_read_b64_tr_b16 v[160:161], v6 offset:26624
    buffer_load_dwordx4 v5, s[28:31], s63 offen offset:1024 lds
    v_mfma_f32_16x16x32_bf16 v[56:59], v[164:167], v[136:139], v[56:59]
    ds_read_b64_tr_b16 v[162:163], v6 offset:29696
    buffer_load_dwordx4 v5, s[28:31], s63 offen offset:2048 lds
    v_mfma_f32_16x16x32_bf16 v[80:83], v[168:171], v[140:143], v[80:83]
    ds_read_b128 v[116:119], v9 offset:2048
    s_add_u32 m0, s80, 3072
    s_add_u32 s63, s63, 0x3000
    buffer_load_dwordx4 v5, s[28:31], s63 offen offset:0 lds
    v_mfma_f32_16x16x32_bf16 v[100:103], v[140:143], v[172:175], v[100:103]
    ds_read_b64_tr_b16 v[152:153], v6 offset:24576
    s_waitcnt lgkmcnt(8)
    v_mfma_f32_16x16x32_bf16 v[188:191], v[176:179], v[176:179], v[188:191]
    v_mfma_f32_16x16x32_bf16 v[60:63], v[164:167], v[140:143], v[60:63]
    ds_read_b64_tr_b16 v[154:155], v6 offset:27648
    buffer_load_dwordx4 v5, s[28:31], s63 offen offset:1024 lds
    v_mfma_f32_16x16x32_bf16 v[192:195], v[46:49], v[176:179], v[192:195]
    v_mfma_f32_16x16x32_bf16 v[84:87], v[168:171], v[144:147], v[84:87]
    ds_read_b128 v[120:123], v9 offset:4096
    s_waitcnt lgkmcnt(9)
    v_mfma_f32_16x16x32_bf16 v[188:191], v[180:183], v[180:183], v[188:191]
    v_mfma_f32_16x16x32_bf16 v[104:107], v[144:147], v[172:175], v[104:107]
    ds_read_b128 v[124:127], v9 offset:6144
    buffer_load_dwordx4 v5, s[28:31], s63 offen offset:2048 lds
    v_mfma_f32_16x16x32_bf16 v[192:195], v[46:49], v[180:183], v[192:195]
    v_mfma_f32_16x16x32_bf16 v[64:67], v[164:167], v[144:147], v[64:67]
    ds_read_b128 v[128:131], v9 offset:8192
    v_mfma_f32_16x16x32_bf16 v[88:91], v[168:171], v[148:151], v[88:91]
    v_mfma_f32_16x16x32_bf16 v[108:111], v[148:151], v[172:175], v[108:111]
    v_mfma_f32_16x16x32_bf16 v[68:71], v[164:167], v[148:151], v[68:71]
    v_mfma_f32_16x16x32_bf16 v[34:37], v[164:167], v[46:49], v[34:37]
    v_mfma_f32_16x16x32_bf16 v[38:41], v[168:171], v[46:49], v[38:41]
    v_mfma_f32_16x16x32_bf16 v[42:45], v[46:49], v[172:175], v[42:45]
    s_cmp_eq_u32 s67, 14
    s_cbranch_scc1 L_im_20
L_imb_21:
    ds_read_b128 v[176:179], v206 offset:30720
    ds_read_b128 v[180:183], v207 offset:30720
    ds_read_b128 v[184:187], v208 offset:61440
    s_waitcnt lgkmcnt(6)
    v_mfma_f32_16x16x32_bf16 v[72:75], v[156:159], v[112:115], v[72:75]
    ds_read_b64_tr_b16 v[168:169], v6 offset:37888
    ds_read_b64_tr_b16 v[170:171], v6 offset:40960
    v_mfma_f32_16x16x32_bf16 v[92:95], v[112:115], v[160:163], v[92:95]
    ds_read_b128 v[132:135], v10 offset:0
    ds_read_b64_tr_b16 v[172:173], v6 offset:38912
    v_mfma_f32_16x16x32_bf16 v[76:79], v[156:159], v[116:119], v[76:79]
    ds_read_b64_tr_b16 v[174:175], v6 offset:41984
    ds_read_b128 v[136:139], v10 offset:2048
    v_mfma_f32_16x16x32_bf16 v[96:99], v[116:119], v[160:163], v[96:99]
    ds_read_b64_tr_b16 v[164:165], v6 offset:36864
    ds_read_b64_tr_b16 v[166:167], v6 offset:39936
    v_mfma_f32_16x16x32_bf16 v[56:59], v[152:155], v[116:119], v[56:59]
    ds_read_b128 v[140:143], v10 offset:4096
    ds_read_b128 v[144:147], v10 offset:6144
    s_waitcnt lgkmcnt(13)
    v_mfma_f32_16x16x32_bf16 v[80:83], v[156:159], v[120:123], v[80:83]
    ds_read_b128 v[148:151], v10 offset:8192
    v_mfma_f32_16x16x32_bf16 v[100:103], v[120:123], v[160:163], v[100:103]
    s_waitcnt lgkmcnt(13)
    v_mfma_f32_16x16x32_bf16 v[188:191], v[176:179], v[176:179], v[188:191]
    v_mfma_f32_16x16x32_bf16 v[60:63], v[152:155], v[120:123], v[60:63]
    v_mfma_f32_16x16x32_bf16 v[192:195], v[46:49], v[176:179], v[192:195]
    v_mfma_f32_16x16x32_bf16 v[84:87], v[156:159], v[124:127], v[84:87]
    s_waitcnt lgkmcnt(12)
    v_mfma_f32_16x16x32_bf16 v[188:191], v[180:183], v[180:183], v[188:191]
    v_mfma_f32_16x16x32_bf16 v[104:107], v[124:127], v[160:163], v[104:107]
    v_mfma_f32_16x16x32_bf16 v[192:195], v[46:49], v[180:183], v[192:195]
    v_mfma_f32_16x16x32_bf16 v[64:67], v[152:155], v[124:127], v[64:67]
    s_waitcnt lgkmcnt(11)
    v_mfma_f32_16x16x32_bf16 v[196:199], v[184:187], v[184:187], v[196:199]
    v_mfma_f32_16x16x32_bf16 v[88:91], v[156:159], v[128:131], v[88:91]
    v_mfma_f32_16x16x32_bf16 v[200:203], v[46:49], v[184:187], v[200:203]
    v_mfma_f32_16x16x32_bf16 v[108:111], v[128:131], v[160:163], v[108:111]
    v_mfma_f32_16x16x32_bf16 v[68:71], v[152:155], v[128:131], v[68:71]
    v_mfma_f32_16x16x32_bf16 v[34:37], v[152:155], v[46:49], v[34:37]
    v_mfma_f32_16x16x32_bf16 v[38:41], v[156:159], v[46:49], v[38:41]
    v_mfma_f32_16x16x32_bf16 v[42:45], v[46:49], v[160:163], v[42:45]
    s_cmp_eq_u32 s67, 16
    s_cbranch_scc1 L_im_22
L_imb_23:
    s_waitcnt lgkmcnt(0)
    s_waitcnt vmcnt(8)
    s_barrier
    v_mfma_f32_16x16x32_bf16 v[72:75], v[168:171], v[132:135], v[72:75]
    ds_read_b64_tr_b16 v[156:157], v7 offset:1024
    s_add_u32 m0, s80, 24576
    s_add_u32 s63, s68, 7
    s_and_b32 s63, s63, 7
    s_mul_i32 s63, s63, 196608
    s_add_u32 s63, s63, s81
    buffer_load_dwordx4 v5, s[28:31], s63 offen offset:0 lds
    ds_write_b128 v210, a[0:3]
    v_mfma_f32_16x16x32_bf16 v[92:95], v[132:135], v[172:175], v[92:95]
    ds_read_b64_tr_b16 v[158:159], v7 offset:4096
    buffer_load_dwordx4 v5, s[28:31], s63 offen offset:1024 lds
    ds_read_b64_tr_b16 v[230:231], v211 offset:0
    v_mfma_f32_16x16x32_bf16 v[76:79], v[168:171], v[136:139], v[76:79]
    ds_read_b128 v[112:115], v9 offset:10240
    buffer_load_dwordx4 v5, s[28:31], s63 offen offset:2048 lds
    ds_read_b64_tr_b16 v[232:233], v211 offset:512
    v_and_b32 v176, 2, v1
    v_cmp_eq_u32 vcc, 2, v176
    v_mfma_f32_16x16x32_bf16 v[96:99], v[136:139], v[172:175], v[96:99]
    ds_read_b64_tr_b16 v[160:161], v7 offset:2048
    s_add_u32 m0, s80, 27648
    s_add_u32 s63, s63, 0x3000
    buffer_load_dwordx4 v5, s[28:31], s63 offen offset:0 lds
    v_cndmask_b32 v188, v188, v189, s[52:53]
    v_cndmask_b32 v190, v190, v191, s[52:53]
    v_mfma_f32_16x16x32_bf16 v[56:59], v[164:167], v[136:139], v[56:59]
    ds_read_b64_tr_b16 v[162:163], v7 offset:5120
    buffer_load_dwordx4 v5, s[28:31], s63 offen offset:1024 lds
    ds_write_b128 v210, a[4:7]
    v_cndmask_b32 v193, v188, v190, vcc
    v_cndmask_b32 v196, v196, v197, s[52:53]
    v_mfma_f32_16x16x32_bf16 v[80:83], v[168:171], v[140:143], v[80:83]
    ds_read_b128 v[116:119], v9 offset:12288
    buffer_load_dwordx4 v5, s[28:31], s63 offen offset:2048 lds
    ds_read_b64_tr_b16 v[234:235], v211 offset:0
    v_cndmask_b32 v198, v198, v199, s[52:53]
    v_cndmask_b32 v201, v196, v198, vcc
    v_mfma_f32_16x16x32_bf16 v[100:103], v[140:143], v[172:175], v[100:103]
    ds_read_b64_tr_b16 v[152:153], v7 offset:0
    ds_read_b64_tr_b16 v[236:237], v211 offset:512
    v_mul_f32 v180, 0x3b000000, v192
    v_mul_f32 v182, v180, v180
    v_mfma_f32_16x16x32_bf16 v[60:63], v[164:167], v[140:143], v[60:63]
    ds_read_b64_tr_b16 v[154:155], v7 offset:3072
    s_lshl_b32 s88, s66, 14
    s_lshl_b32 s89, s66, 11
    s_add_u32 m0, s89, 0
    s_add_u32 s63, s88, 0x0
    buffer_load_dwordx4 v11, s[32:35], s63 offen lds
    v_mov_b32 v181, 0x3b000000
    v_fma_f32 v182, v193, v181, -v182
    v_mfma_f32_16x16x32_bf16 v[84:87], v[168:171], v[144:147], v[84:87]
    ds_read_b128 v[120:123], v9 offset:14336
    s_waitcnt lgkmcnt(9)
    v_mfma_f32_16x16x32_bf16 v[220:223], v[216:219], v[230:233], 0
    v_max_f32 v182, 0, v182
    v_add_f32 v182, 0x3727c5ac, v182
    v_mfma_f32_16x16x32_bf16 v[104:107], v[144:147], v[172:175], v[104:107]
    ds_read_b128 v[124:127], v9 offset:16384
    buffer_load_dwordx4 v12, s[32:35], s63 offen offset:1024 lds
    ds_write_b128 v210, a[8:11]
    v_rsq_f32 v181, v182
    v_and_b32 v176, 15, v1
    v_mfma_f32_16x16x32_bf16 v[64:67], v[164:167], v[144:147], v[64:67]
    ds_read_b128 v[128:131], v9 offset:18432
    s_add_u32 m0, s89, 8192
    s_add_u32 s63, s88, 0x10000
    buffer_load_dwordx4 v11, s[32:35], s63 offen lds
    ds_read_b64_tr_b16 v[238:239], v211 offset:0
    s_add_u32 s85, s66, 1
    s_lshl_b32 s85, s85, 4
    v_mfma_f32_16x16x32_bf16 v[88:91], v[168:171], v[148:151], v[88:91]
    buffer_load_dwordx4 v12, s[32:35], s63 offen offset:1024 lds
    ds_read_b64_tr_b16 v[240:241], v211 offset:512
    v_add_u32 v177, s85, v176
    v_lshlrev_b32 v178, 3, v177
    v_mfma_f32_16x16x32_bf16 v[108:111], v[148:151], v[172:175], v[108:111]
    v_lshlrev_b32 v177, 2, v177
    v_add_u32 v178, 0x26000, v178
    v_mfma_f32_16x16x32_bf16 v[68:71], v[164:167], v[148:151], v[68:71]
    s_waitcnt lgkmcnt(7)
    v_mfma_f32_16x16x32_bf16 v[220:223], v[216:219], v[234:237], v[220:223]
    v_add_u32 v177, 0x26000, v177
    s_mov_b32 exec_lo, 0x00f0000f
    s_mov_b32 exec_hi, 0xf0000f00
    ds_write_b64 v178, v[180:181] offset:0
    ds_write_b64 v178, v[200:201] offset:7040
    ds_write_b32 v177, v180 offset:640
    ds_write_b32 v177, v181 offset:960
    s_mov_b64 exec, -1
    v_mfma_f32_16x16x32_bf16 v[34:37], v[164:167], v[46:49], v[34:37]
    v_mfma_f32_16x16x32_bf16 v[38:41], v[168:171], v[46:49], v[38:41]
    v_mfma_f32_16x16x32_bf16 v[42:45], v[46:49], v[172:175], v[42:45]
    s_cmp_eq_u32 s67, 18
    s_cbranch_scc1 L_im_24
L_imb_25:
    s_waitcnt lgkmcnt(10)
    v_mfma_f32_16x16x32_bf16 v[72:75], v[156:159], v[112:115], v[72:75]
    ds_read_b64_tr_b16 v[168:169], v7 offset:13312
    ds_read_b64_tr_b16 v[170:171], v7 offset:16384
    ds_write_b128 v210, a[12:15]
    v_mfma_f32_16x16x32_bf16 v[92:95], v[112:115], v[160:163], v[92:95]
    ds_read_b128 v[132:135], v10 offset:10240
    ds_read_b64_tr_b16 v[172:173], v7 offset:14336
    buffer_load_dword v52, v55, s[48:51], 0 offen sc1
    ds_read_b64_tr_b16 v[242:243], v211 offset:0
    v_mfma_f32_16x16x32_bf16 v[76:79], v[156:159], v[116:119], v[76:79]
    ds_read_b64_tr_b16 v[174:175], v7 offset:17408
    ds_read_b128 v[136:139], v10 offset:12288
    buffer_store_dwordx4 v[230:233], v212, s[24:27], s12 offen offset:0 sc1
    ds_read_b64_tr_b16 v[244:245], v211 offset:512
    v_mfma_f32_16x16x32_bf16 v[96:99], v[116:119], v[160:163], v[96:99]
    ds_read_b64_tr_b16 v[164:165], v7 offset:12288
    ds_read_b64_tr_b16 v[166:167], v7 offset:15360
    s_add_u32 m0, s89, 16384
    s_add_u32 s63, s88, 0x40000
    buffer_load_dwordx4 v11, s[32:35], s63 offen lds
    v_mfma_f32_16x16x32_bf16 v[56:59], v[152:155], v[116:119], v[56:59]
    ds_read_b128 v[140:143], v10 offset:14336
    ds_read_b128 v[144:147], v10 offset:16384
    buffer_load_dwordx4 v12, s[32:35], s63 offen offset:1024 lds
    s_waitcnt lgkmcnt(15)
    v_mfma_f32_16x16x32_bf16 v[220:223], v[216:219], v[238:241], v[220:223]
    v_mfma_f32_16x16x32_bf16 v[80:83], v[156:159], v[120:123], v[80:83]
    ds_read_b128 v[148:151], v10 offset:18432
    s_add_u32 m0, s89, 24576
    s_add_u32 s63, s88, 0x50000
    buffer_load_dwordx4 v11, s[32:35], s63 offen lds
    v_mfma_f32_16x16x32_bf16 v[100:103], v[120:123], v[160:163], v[100:103]
    buffer_store_dwordx4 v[234:237], v212, s[24:27], s12 offen offset:512 sc1
    v_mfma_f32_16x16x32_bf16 v[60:63], v[152:155], v[120:123], v[60:63]
    buffer_load_dwordx4 v12, s[32:35], s63 offen offset:1024 lds
    v_mfma_f32_16x16x32_bf16 v[84:87], v[156:159], v[124:127], v[84:87]
    s_waitcnt lgkmcnt(5)
    v_mfma_f32_16x16x32_bf16 v[220:223], v[216:219], v[242:245], v[220:223]
    v_mfma_f32_16x16x32_bf16 v[104:107], v[124:127], v[160:163], v[104:107]
    v_mfma_f32_16x16x32_bf16 v[64:67], v[152:155], v[124:127], v[64:67]
    buffer_store_dwordx4 v[238:241], v212, s[24:27], s12 offen offset:1024 sc1
    v_mfma_f32_16x16x32_bf16 v[88:91], v[156:159], v[128:131], v[88:91]
    s_mov_b64 exec, 0xffff
    s_nop 3
    ds_write_b128 v214, v[220:223]
    s_mov_b64 exec, -1
    v_mfma_f32_16x16x32_bf16 v[108:111], v[128:131], v[160:163], v[108:111]
    v_mfma_f32_16x16x32_bf16 v[68:71], v[152:155], v[128:131], v[68:71]
    v_mfma_f32_16x16x32_bf16 v[34:37], v[152:155], v[46:49], v[34:37]
    v_mfma_f32_16x16x32_bf16 v[38:41], v[156:159], v[46:49], v[38:41]
    v_mfma_f32_16x16x32_bf16 v[42:45], v[46:49], v[160:163], v[42:45]
    s_cmp_eq_u32 s67, 20
    s_cbranch_scc1 L_im_26
L_imb_27:
    s_waitcnt lgkmcnt(0)
    s_waitcnt vmcnt(18)
    s_barrier
    v_mfma_f32_16x16x32_bf16 v[72:75], v[168:171], v[132:135], v[72:75]
    ds_read_b64_tr_b16 v[156:157], v6 offset:1024
    ds_write_b128 v210, a[16:19]
    ds_read_b32 v220, v215 offset:0
    ds_read_b32 v221, v215 offset:256
    v_mfma_f32_16x16x32_bf16 v[92:95], v[132:135], v[172:175], v[92:95]
    ds_read_b64_tr_b16 v[158:159], v6 offset:4096
    s_lshl_b32 s88, s66, 14
    s_lshl_b32 s89, s66, 11
    s_add_u32 m0, s89, 32768
    s_add_u32 s63, s88, 0x20000
    buffer_load_dwordx4 v11, s[32:35], s63 offen lds
    ds_read_b64_tr_b16 v[246:247], v211 offset:0
    ds_read_b32 v222, v215 offset:512
    ds_read_b32 v223, v215 offset:768
    v_mfma_f32_16x16x32_bf16 v[76:79], v[168:171], v[136:139], v[76:79]
    ds_read_b128 v[112:115], v9 offset:20480
    buffer_store_dwordx4 v[242:245], v212, s[24:27], s12 offen offset:1536 sc1
    ds_read_b64_tr_b16 v[248:249], v211 offset:512
    v_mfma_f32_16x16x32_bf16 v[96:99], v[136:139], v[172:175], v[96:99]
    ds_read_b64_tr_b16 v[160:161], v6 offset:2048
    ds_write_b128 v210, a[20:23]
    v_mfma_f32_16x16x32_bf16 v[56:59], v[164:167], v[136:139], v[56:59]
    ds_read_b64_tr_b16 v[162:163], v6 offset:5120
    buffer_load_dwordx4 v12, s[32:35], s63 offen offset:1024 lds
    ds_read_b64_tr_b16 v[250:251], v211 offset:0
    v_mfma_f32_16x16x32_bf16 v[80:83], v[168:171], v[140:143], v[80:83]
    ds_read_b128 v[116:119], v9 offset:22528
    ds_read_b64_tr_b16 v[252:253], v211 offset:512
    s_waitcnt lgkmcnt(8)
    v_add_f32 v220, v220, v221
    v_mfma_f32_16x16x32_bf16 v[100:103], v[140:143], v[172:175], v[100:103]
    ds_read_b64_tr_b16 v[152:153], v6 offset:0
    v_add_f32 v222, v222, v223
    v_add_f32 v220, v220, v222
    v_mfma_f32_16x16x32_bf16 v[60:63], v[164:167], v[140:143], v[60:63]
    ds_read_b64_tr_b16 v[154:155], v6 offset:3072
    s_add_u32 m0, s89, 40960
    s_add_u32 s63, s88, 0x30000
    buffer_load_dwordx4 v11, s[32:35], s63 offen lds
    v_cvt_pk_bf16_f32 v223, v220, v55
    v_lshlrev_b32 v216, 16, v223
    v_mfma_f32_16x16x32_bf16 v[84:87], v[168:171], v[144:147], v[84:87]
    ds_read_b128 v[120:123], v9 offset:24576
    v_sub_f32 v216, v220, v216
    v_cvt_pk_bf16_f32 v222, v220, v216
    v_mfma_f32_16x16x32_bf16 v[104:107], v[144:147], v[172:175], v[104:107]
    ds_read_b128 v[124:127], v9 offset:26624
    s_mov_b64 exec, 0xffff
    buffer_store_dwordx2 v[222:223], v213, s[24:27], s14 offen sc1
    s_mov_b64 exec, -1
    v_lshlrev_b32 v178, 3, v176
    v_mfma_f32_16x16x32_bf16 v[64:67], v[164:167], v[144:147], v[64:67]
    ds_read_b128 v[128:131], v9 offset:28672
    buffer_load_dwordx4 v12, s[32:35], s63 offen offset:1024 lds
    v_lshlrev_b32 v177, 2, v176
    v_add_u32 v178, 0x26000, v178
    v_mfma_f32_16x16x32_bf16 v[88:91], v[168:171], v[148:151], v[88:91]
    v_add_u32 v177, 0x26000, v177
    ds_read_b64 v[188:189], v178 offset:7168
    v_mfma_f32_16x16x32_bf16 v[108:111], v[148:151], v[172:175], v[108:111]
    ds_read_b64 v[190:191], v178 offset:7296
    ds_read_b64 v[192:193], v178 offset:7424
    v_mfma_f32_16x16x32_bf16 v[68:71], v[164:167], v[148:151], v[68:71]
    ds_read_b64 v[194:195], v178 offset:7552
    v_mfma_f32_16x16x32_bf16 v[34:37], v[164:167], v[46:49], v[34:37]
    v_mfma_f32_16x16x32_bf16 v[38:41], v[168:171], v[46:49], v[38:41]
    v_mfma_f32_16x16x32_bf16 v[42:45], v[46:49], v[172:175], v[42:45]
    s_cmp_eq_u32 s67, 22
    s_cbranch_scc1 L_im_28
L_imb_29:
    s_waitcnt lgkmcnt(7)
    v_mfma_f32_16x16x32_bf16 v[72:75], v[156:159], v[112:115], v[72:75]
    ds_read_b64_tr_b16 v[168:169], v6 offset:13312
    ds_read_b64_tr_b16 v[170:171], v6 offset:16384
    v_mfma_f32_16x16x32_bf16 v[92:95], v[112:115], v[160:163], v[92:95]
    ds_read_b128 v[132:135], v10 offset:20480
    ds_read_b64_tr_b16 v[172:173], v6 offset:14336
    v_mfma_f32_16x16x32_bf16 v[76:79], v[156:159], v[116:119], v[76:79]
    ds_read_b64_tr_b16 v[174:175], v6 offset:17408
    ds_read_b128 v[136:139], v10 offset:22528
    v_mfma_f32_16x16x32_bf16 v[96:99], v[116:119], v[160:163], v[96:99]
    ds_read_b64_tr_b16 v[164:165], v6 offset:12288
    ds_read_b64_tr_b16 v[166:167], v6 offset:15360
    s_waitcnt lgkmcnt(8)
    v_mfma_f32_16x16x32_bf16 v[56:59], v[152:155], v[116:119], v[56:59]
    ds_read_b128 v[140:143], v10 offset:24576
    ds_read_b128 v[144:147], v10 offset:26624
    v_add_f32 v188, v188, v190
    v_add_f32 v192, v192, v194
    v_mfma_f32_16x16x32_bf16 v[80:83], v[156:159], v[120:123], v[80:83]
    ds_read_b128 v[148:151], v10 offset:28672
    v_add_f32 v189, v189, v191
    v_add_f32 v193, v193, v195
    v_mfma_f32_16x16x32_bf16 v[100:103], v[120:123], v[160:163], v[100:103]
    v_add_f32 v188, v188, v192
    v_add_f32 v189, v189, v193
    v_mfma_f32_16x16x32_bf16 v[60:63], v[152:155], v[120:123], v[60:63]
    v_mul_f32 v180, 0x3b000000, v188
    v_mul_f32 v182, v180, v180
    v_mfma_f32_16x16x32_bf16 v[84:87], v[156:159], v[124:127], v[84:87]
    v_mov_b32 v181, 0x3b000000
    v_fma_f32 v182, v189, v181, -v182
    v_mfma_f32_16x16x32_bf16 v[104:107], v[124:127], v[160:163], v[104:107]
    v_max_f32 v182, 0, v182
    v_add_f32 v182, 0x3727c5ac, v182
    v_mfma_f32_16x16x32_bf16 v[64:67], v[152:155], v[124:127], v[64:67]
    v_rsq_f32 v181, v182
    s_nop 0
    v_mfma_f32_16x16x32_bf16 v[88:91], v[156:159], v[128:131], v[88:91]
    v_cndmask_b32 v180, 0, v180, s[60:61]
    v_cndmask_b32 v181, 0, v181, s[60:61]
    v_mfma_f32_16x16x32_bf16 v[108:111], v[128:131], v[160:163], v[108:111]
    ds_write_b64 v178, v[180:181]
    ds_write_b32 v177, v180 offset:640
    v_mfma_f32_16x16x32_bf16 v[68:71], v[152:155], v[128:131], v[68:71]
    ds_write_b32 v177, v181 offset:960
    v_mfma_f32_16x16x32_bf16 v[34:37], v[152:155], v[46:49], v[34:37]
    v_mfma_f32_16x16x32_bf16 v[38:41], v[156:159], v[46:49], v[38:41]
    v_mfma_f32_16x16x32_bf16 v[42:45], v[46:49], v[160:163], v[42:45]
    s_cmp_eq_u32 s67, 24
    s_cbranch_scc1 L_im_30
L_imb_31:
    s_waitcnt lgkmcnt(0)
    s_waitcnt vmcnt(18)
    s_barrier
    v_mfma_f32_16x16x32_bf16 v[72:75], v[168:171], v[132:135], v[72:75]
    ds_read_b64_tr_b16 v[156:157], v6 offset:25600
    v_mfma_f32_16x16x32_bf16 v[92:95], v[132:135], v[172:175], v[92:95]
    ds_read_b64_tr_b16 v[158:159], v6 offset:28672
    s_add_u32 m0, s89, 49152
    s_add_u32 s63, s88, 0x60000
    buffer_load_dwordx4 v11, s[32:35], s63 offen lds
    v_mfma_f32_16x16x32_bf16 v[76:79], v[168:171], v[136:139], v[76:79]
    ds_read_b128 v[112:115], v9 offset:30720
    v_mfma_f32_16x16x32_bf16 v[96:99], v[136:139], v[172:175], v[96:99]
    ds_read_b64_tr_b16 v[160:161], v6 offset:26624
    v_mfma_f32_16x16x32_bf16 v[56:59], v[164:167], v[136:139], v[56:59]
    ds_read_b64_tr_b16 v[162:163], v6 offset:29696
    buffer_load_dwordx4 v12, s[32:35], s63 offen offset:1024 lds
    v_mfma_f32_16x16x32_bf16 v[80:83], v[168:171], v[140:143], v[80:83]
    ds_read_b128 v[116:119], v9 offset:32768
    v_mfma_f32_16x16x32_bf16 v[100:103], v[140:143], v[172:175], v[100:103]
    ds_read_b64_tr_b16 v[152:153], v6 offset:24576
    v_mfma_f32_16x16x32_bf16 v[60:63], v[164:167], v[140:143], v[60:63]
    ds_read_b64_tr_b16 v[154:155], v6 offset:27648
    s_add_u32 m0, s89, 57344
    s_add_u32 s63, s88, 0x70000
    buffer_load_dwordx4 v11, s[32:35], s63 offen lds
    v_mfma_f32_16x16x32_bf16 v[84:87], v[168:171], v[144:147], v[84:87]
    ds_read_b128 v[120:123], v9 offset:34816
    v_mfma_f32_16x16x32_bf16 v[104:107], v[144:147], v[172:175], v[104:107]
    ds_read_b128 v[124:127], v9 offset:36864
    v_mfma_f32_16x16x32_bf16 v[64:67], v[164:167], v[144:147], v[64:67]
    ds_read_b128 v[128:131], v9 offset:38912
    buffer_load_dwordx4 v12, s[32:35], s63 offen offset:1024 lds
    v_mfma_f32_16x16x32_bf16 v[88:91], v[168:171], v[148:151], v[88:91]
    v_mfma_f32_16x16x32_bf16 v[108:111], v[148:151], v[172:175], v[108:111]
    v_mfma_f32_16x16x32_bf16 v[68:71], v[164:167], v[148:151], v[68:71]
    v_mfma_f32_16x16x32_bf16 v[34:37], v[164:167], v[46:49], v[34:37]
    v_mfma_f32_16x16x32_bf16 v[38:41], v[168:171], v[46:49], v[38:41]
    v_mfma_f32_16x16x32_bf16 v[42:45], v[46:49], v[172:175], v[42:45]
    s_cmp_eq_u32 s67, 26
    s_cbranch_scc1 L_im_32
L_imb_33:
    s_waitcnt lgkmcnt(3)
    v_mfma_f32_16x16x32_bf16 v[72:75], v[156:159], v[112:115], v[72:75]
    ds_read_b64_tr_b16 v[168:169], v6 offset:37888
    ds_read_b64_tr_b16 v[170:171], v6 offset:40960
    v_mfma_f32_16x16x32_bf16 v[92:95], v[112:115], v[160:163], v[92:95]
    ds_read_b128 v[132:135], v10 offset:30720
    ds_read_b64_tr_b16 v[172:173], v6 offset:38912
    v_mfma_f32_16x16x32_bf16 v[76:79], v[156:159], v[116:119], v[76:79]
    ds_read_b64_tr_b16 v[174:175], v6 offset:41984
    ds_read_b128 v[136:139], v10 offset:32768
    v_mfma_f32_16x16x32_bf16 v[96:99], v[116:119], v[160:163], v[96:99]
    ds_read_b64_tr_b16 v[164:165], v6 offset:36864
    ds_read_b64_tr_b16 v[166:167], v6 offset:39936
    v_mfma_f32_16x16x32_bf16 v[56:59], v[152:155], v[116:119], v[56:59]
    ds_read_b128 v[140:143], v10 offset:34816
    ds_read_b128 v[144:147], v10 offset:36864
    s_waitcnt lgkmcnt(10)
    v_mfma_f32_16x16x32_bf16 v[80:83], v[156:159], v[120:123], v[80:83]
    ds_read_b128 v[148:151], v10 offset:38912
    v_mfma_f32_16x16x32_bf16 v[100:103], v[120:123], v[160:163], v[100:103]
    v_mfma_f32_16x16x32_bf16 v[60:63], v[152:155], v[120:123], v[60:63]
    v_mfma_f32_16x16x32_bf16 v[84:87], v[156:159], v[124:127], v[84:87]
    v_mfma_f32_16x16x32_bf16 v[104:107], v[124:127], v[160:163], v[104:107]
    v_mfma_f32_16x16x32_bf16 v[64:67], v[152:155], v[124:127], v[64:67]
    v_mfma_f32_16x16x32_bf16 v[88:91], v[156:159], v[128:131], v[88:91]
    v_mfma_f32_16x16x32_bf16 v[108:111], v[128:131], v[160:163], v[108:111]
    v_mfma_f32_16x16x32_bf16 v[68:71], v[152:155], v[128:131], v[68:71]
    v_mfma_f32_16x16x32_bf16 v[34:37], v[152:155], v[46:49], v[34:37]
    v_mfma_f32_16x16x32_bf16 v[38:41], v[156:159], v[46:49], v[38:41]
    v_mfma_f32_16x16x32_bf16 v[42:45], v[46:49], v[160:163], v[42:45]
    s_cmp_eq_u32 s67, 28
    s_cbranch_scc1 L_im_34
L_imb_35:
    s_waitcnt lgkmcnt(0)
    s_waitcnt vmcnt(5)
    s_barrier
    v_readfirstlane_b32 s62, v52
    s_cmp_eq_u32 s62, 0
    s_cbranch_scc1 L_crl_37
L_crg_38:
    s_lshr_b32 s62, s62, 1
    s_lshr_b32 s98, s67, 4
    s_xor_b32 s98, s98, s62
    s_and_b32 s98, s98, 1
    s_lshl_b32 s98, s98, 13
    s_xor_b32 s62, s98, 0x2000
    s_add_u32 s92, s92, s62
    s_add_u32 s93, s93, s98
    s_add_u32 s94, s94, s98
    s_cmp_lg_u32 s66, 0
    s_cbranch_scc1 L_crs_36
    s_mov_b64 exec, 1
    s_cmp_ge_u32 s97, 224
    s_cbranch_scc1 L_crx_39
    s_cmp_ge_u32 s97, 112
    s_cselect_b32 s62, 112, 0
    s_sub_u32 s62, s97, s62
    s_lshr_b32 s65, s62, 2
    s_add_u32 s62, s65, 256
    s_lshl_b32 s62, s62, 7
    buffer_atomic_add v54, v55, s[24:27], s62 offen sc1
L_crx_39:
    s_mov_b64 exec, -1
L_crs_36:
    v_and_b32 v112, 15, v1
    v_lshlrev_b32 v112, 3, v112
    v_add_u32 v112, 0x26000, v112
    v_and_b32 v113, 48, v1
    v_add_u32 v113, 0x26280, v113
    v_mfma_f32_16x16x32_bf16 v[72:75], v[168:171], v[132:135], v[72:75]
    ds_read_b64 v[176:177], v112 offset:0
    ds_read_b64 v[178:179], v112 offset:128
    v_mfma_f32_16x16x32_bf16 v[92:95], v[132:135], v[172:175], v[92:95]
    ds_read_b64 v[180:181], v112 offset:256
    ds_read_b64 v[182:183], v112 offset:384
    v_mfma_f32_16x16x32_bf16 v[76:79], v[168:171], v[136:139], v[76:79]
    ds_read_b64 v[184:185], v112 offset:512
    ds_read_b128 v[186:189], v113 offset:0
    v_mfma_f32_16x16x32_bf16 v[96:99], v[136:139], v[172:175], v[96:99]
    ds_read_b128 v[206:209], v113 offset:320
    ds_read_b128 v[190:193], v113 offset:64
    v_mfma_f32_16x16x32_bf16 v[56:59], v[164:167], v[136:139], v[56:59]
    ds_read_b128 v[210:213], v113 offset:384
    ds_read_b128 v[194:197], v113 offset:128
    v_mfma_f32_16x16x32_bf16 v[80:83], v[168:171], v[140:143], v[80:83]
    ds_read_b128 v[214:217], v113 offset:448
    ds_read_b128 v[198:201], v113 offset:192
    v_mfma_f32_16x16x32_bf16 v[100:103], v[140:143], v[172:175], v[100:103]
    ds_read_b128 v[218:221], v113 offset:512
    v_mfma_f32_16x16x32_bf16 v[60:63], v[164:167], v[140:143], v[60:63]
    ds_read_b128 v[202:205], v113 offset:256
    v_mfma_f32_16x16x32_bf16 v[84:87], v[168:171], v[144:147], v[84:87]
    ds_read_b128 v[222:225], v113 offset:576
    v_mfma_f32_16x16x32_bf16 v[104:107], v[144:147], v[172:175], v[104:107]
    v_mfma_f32_16x16x32_bf16 v[64:67], v[164:167], v[144:147], v[64:67]
    v_mfma_f32_16x16x32_bf16 v[88:91], v[168:171], v[148:151], v[88:91]
    v_mfma_f32_16x16x32_bf16 v[108:111], v[148:151], v[172:175], v[108:111]
    v_mfma_f32_16x16x32_bf16 v[68:71], v[164:167], v[148:151], v[68:71]
    v_mfma_f32_16x16x32_bf16 v[34:37], v[164:167], v[46:49], v[34:37]
    v_mfma_f32_16x16x32_bf16 v[38:41], v[168:171], v[46:49], v[38:41]
    v_mfma_f32_16x16x32_bf16 v[42:45], v[46:49], v[172:175], v[42:45]
    s_cmp_eq_u32 s67, 30
    s_cbranch_scc1 L_im_40
L_imb_41:
    s_nop 7
    s_waitcnt lgkmcnt(10)
    s_nop 3
    v_pk_fma_f32 v[72:73], v[38:39], v[176:177], v[72:73] op_sel_hi:[1,0,1] neg_lo:[0,1,0] neg_hi:[0,1,0]
    v_pk_fma_f32 v[74:75], v[40:41], v[176:177], v[74:75] op_sel_hi:[1,0,1] neg_lo:[0,1,0] neg_hi:[0,1,0]
    v_pk_mul_f32 v[72:73], v[72:73], v[176:177] op_sel:[0,1] op_sel_hi:[1,1]
    v_pk_mul_f32 v[74:75], v[74:75], v[176:177] op_sel:[0,1] op_sel_hi:[1,1]
    v_cvt_pk_bf16_f32 v116, v72, v73
    v_cvt_pk_bf16_f32 v117, v74, v75
    v_pk_fma_f32 v[76:77], v[38:39], v[178:179], v[76:77] op_sel_hi:[1,0,1] neg_lo:[0,1,0] neg_hi:[0,1,0]
    v_pk_fma_f32 v[78:79], v[40:41], v[178:179], v[78:79] op_sel_hi:[1,0,1] neg_lo:[0,1,0] neg_hi:[0,1,0]
    v_pk_mul_f32 v[76:77], v[76:77], v[178:179] op_sel:[0,1] op_sel_hi:[1,1]
    v_pk_mul_f32 v[78:79], v[78:79], v[178:179] op_sel:[0,1] op_sel_hi:[1,1]
    v_cvt_pk_bf16_f32 v118, v76, v77
    v_cvt_pk_bf16_f32 v119, v78, v79
    v_pk_fma_f32 v[80:81], v[38:39], v[180:181], v[80:81] op_sel_hi:[1,0,1] neg_lo:[0,1,0] neg_hi:[0,1,0]
    v_pk_fma_f32 v[82:83], v[40:41], v[180:181], v[82:83] op_sel_hi:[1,0,1] neg_lo:[0,1,0] neg_hi:[0,1,0]
    v_pk_mul_f32 v[80:81], v[80:81], v[180:181] op_sel:[0,1] op_sel_hi:[1,1]
    v_pk_mul_f32 v[82:83], v[82:83], v[180:181] op_sel:[0,1] op_sel_hi:[1,1]
    v_cvt_pk_bf16_f32 v120, v80, v81
    v_cvt_pk_bf16_f32 v121, v82, v83
    v_pk_fma_f32 v[84:85], v[38:39], v[182:183], v[84:85] op_sel_hi:[1,0,1] neg_lo:[0,1,0] neg_hi:[0,1,0]
    v_pk_fma_f32 v[86:87], v[40:41], v[182:183], v[86:87] op_sel_hi:[1,0,1] neg_lo:[0,1,0] neg_hi:[0,1,0]
    v_pk_mul_f32 v[84:85], v[84:85], v[182:183] op_sel:[0,1] op_sel_hi:[1,1]
    v_pk_mul_f32 v[86:87], v[86:87], v[182:183] op_sel:[0,1] op_sel_hi:[1,1]
    v_cvt_pk_bf16_f32 v122, v84, v85
    v_cvt_pk_bf16_f32 v123, v86, v87
    v_pk_fma_f32 v[88:89], v[38:39], v[184:185], v[88:89] op_sel_hi:[1,0,1] neg_lo:[0,1,0] neg_hi:[0,1,0]
    v_pk_fma_f32 v[90:91], v[40:41], v[184:185], v[90:91] op_sel_hi:[1,0,1] neg_lo:[0,1,0] neg_hi:[0,1,0]
    v_pk_mul_f32 v[88:89], v[88:89], v[184:185] op_sel:[0,1] op_sel_hi:[1,1]
    v_pk_mul_f32 v[90:91], v[90:91], v[184:185] op_sel:[0,1] op_sel_hi:[1,1]
    v_cvt_pk_bf16_f32 v124, v88, v89
    v_cvt_pk_bf16_f32 v125, v90, v91
    v_pk_fma_f32 v[56:57], v[34:35], v[178:179], v[56:57] op_sel_hi:[1,0,1] neg_lo:[0,1,0] neg_hi:[0,1,0]
    v_pk_fma_f32 v[58:59], v[36:37], v[178:179], v[58:59] op_sel_hi:[1,0,1] neg_lo:[0,1,0] neg_hi:[0,1,0]
    v_cvt_pk_bf16_f32 v126, v56, v57
    v_cvt_pk_bf16_f32 v127, v58, v59
    v_pk_fma_f32 v[60:61], v[34:35], v[180:181], v[60:61] op_sel_hi:[1,0,1] neg_lo:[0,1,0] neg_hi:[0,1,0]
    v_pk_fma_f32 v[62:63], v[36:37], v[180:181], v[62:63] op_sel_hi:[1,0,1] neg_lo:[0,1,0] neg_hi:[0,1,0]
    v_cvt_pk_bf16_f32 v128, v60, v61
    v_cvt_pk_bf16_f32 v129, v62, v63
    v_pk_fma_f32 v[64:65], v[34:35], v[182:183], v[64:65] op_sel_hi:[1,0,1] neg_lo:[0,1,0] neg_hi:[0,1,0]
    v_pk_fma_f32 v[66:67], v[36:37], v[182:183], v[66:67] op_sel_hi:[1,0,1] neg_lo:[0,1,0] neg_hi:[0,1,0]
    v_cvt_pk_bf16_f32 v130, v64, v65
    v_cvt_pk_bf16_f32 v131, v66, v67
    v_pk_fma_f32 v[68:69], v[34:35], v[184:185], v[68:69] op_sel_hi:[1,0,1] neg_lo:[0,1,0] neg_hi:[0,1,0]
    v_pk_fma_f32 v[70:71], v[36:37], v[184:185], v[70:71] op_sel_hi:[1,0,1] neg_lo:[0,1,0] neg_hi:[0,1,0]
    v_cvt_pk_bf16_f32 v132, v68, v69
    v_cvt_pk_bf16_f32 v133, v70, v71
    v_mov_b32 v112, 0xf149f2ca
    s_nop 0
    buffer_store_dwordx4 v[246:249], v254, s[24:27], s13 offen offset:0 sc1
    v_mfma_f32_16x16x16_bf16 v[144:147], v[116:117], v[126:127], 0
    v_mfma_f32_16x16x16_bf16 v[148:151], v[118:119], v[126:127], 0
    v_mfma_f32_16x16x16_bf16 v[152:155], v[118:119], v[128:129], 0
    v_mfma_f32_16x16x16_bf16 v[156:159], v[120:121], v[128:129], 0
    v_mfma_f32_16x16x16_bf16 v[160:163], v[120:121], v[130:131], 0
    v_mfma_f32_16x16x16_bf16 v[164:167], v[122:123], v[130:131], 0
    v_mfma_f32_16x16x16_bf16 v[168:171], v[122:123], v[132:133], 0
    v_mfma_f32_16x16x16_bf16 v[172:175], v[124:125], v[132:133], 0
    s_waitcnt lgkmcnt(0)
    v_pk_fma_f32 v[92:93], v[186:187], v[42:43], v[92:93] op_sel_hi:[1,0,1] neg_lo:[0,1,0] neg_hi:[0,1,0]
    v_pk_fma_f32 v[94:95], v[188:189], v[42:43], v[94:95] op_sel_hi:[1,0,1] neg_lo:[0,1,0] neg_hi:[0,1,0]
    v_pk_mul_f32 v[92:93], v[92:93], v[206:207]
    v_pk_mul_f32 v[94:95], v[94:95], v[208:209]
    v_cvt_pk_bf16_f32 v134, v92, v93
    v_cvt_pk_bf16_f32 v135, v94, v95
    v_pk_fma_f32 v[96:97], v[190:191], v[42:43], v[96:97] op_sel_hi:[1,0,1] neg_lo:[0,1,0] neg_hi:[0,1,0]
    v_pk_fma_f32 v[98:99], v[192:193], v[42:43], v[98:99] op_sel_hi:[1,0,1] neg_lo:[0,1,0] neg_hi:[0,1,0]
    v_pk_mul_f32 v[96:97], v[96:97], v[210:211]
    v_pk_mul_f32 v[98:99], v[98:99], v[212:213]
    v_cvt_pk_bf16_f32 v136, v96, v97
    v_cvt_pk_bf16_f32 v137, v98, v99
    v_pk_fma_f32 v[100:101], v[194:195], v[42:43], v[100:101] op_sel_hi:[1,0,1] neg_lo:[0,1,0] neg_hi:[0,1,0]
    v_pk_fma_f32 v[102:103], v[196:197], v[42:43], v[102:103] op_sel_hi:[1,0,1] neg_lo:[0,1,0] neg_hi:[0,1,0]
    v_pk_mul_f32 v[100:101], v[100:101], v[214:215]
    v_pk_mul_f32 v[102:103], v[102:103], v[216:217]
    v_cvt_pk_bf16_f32 v138, v100, v101
    v_cvt_pk_bf16_f32 v139, v102, v103
    v_pk_fma_f32 v[104:105], v[198:199], v[42:43], v[104:105] op_sel_hi:[1,0,1] neg_lo:[0,1,0] neg_hi:[0,1,0]
    v_pk_fma_f32 v[106:107], v[200:201], v[42:43], v[106:107] op_sel_hi:[1,0,1] neg_lo:[0,1,0] neg_hi:[0,1,0]
    v_pk_mul_f32 v[104:105], v[104:105], v[218:219]
    v_pk_mul_f32 v[106:107], v[106:107], v[220:221]
    v_cvt_pk_bf16_f32 v140, v104, v105
    v_cvt_pk_bf16_f32 v141, v106, v107
    v_pk_fma_f32 v[108:109], v[202:203], v[42:43], v[108:109] op_sel_hi:[1,0,1] neg_lo:[0,1,0] neg_hi:[0,1,0]
    v_pk_fma_f32 v[110:111], v[204:205], v[42:43], v[110:111] op_sel_hi:[1,0,1] neg_lo:[0,1,0] neg_hi:[0,1,0]
    v_pk_mul_f32 v[108:109], v[108:109], v[222:223]
    v_pk_mul_f32 v[110:111], v[110:111], v[224:225]
    v_cvt_pk_bf16_f32 v142, v108, v109
    v_cvt_pk_bf16_f32 v143, v110, v111
    v_cndmask_b32 v144, v112, v144, s[60:61]
    v_cndmask_b32 v145, v112, v145, s[60:61]
    v_cndmask_b32 v146, v112, v146, s[60:61]
    v_cndmask_b32 v147, v112, v147, s[60:61]
    v_mul_f32 v56, 0x3eb8aa3b, v179
    v_mul_f32 v57, 0x3eb8aa3b, v181
    v_mul_f32 v58, 0x3eb8aa3b, v183
    v_mul_f32 v59, 0x3eb8aa3b, v185
    v_cndmask_b32 v144, v144, v145, s[52:53]
    v_cndmask_b32 v146, v146, v147, s[52:53]
    v_cndmask_b32 v148, v148, v149, s[52:53]
    buffer_store_dwordx4 v[250:253], v254, s[24:27], s13 offen offset:512 sc1
    v_cndmask_b32 v150, v150, v151, s[52:53]
    v_cndmask_b32 v60, v144, v148, s[54:55]
    v_cndmask_b32 v64, v146, v150, s[56:57]
    v_max_f32 v68, v60, v64
    v_cndmask_b32 v152, v152, v153, s[52:53]
    v_cndmask_b32 v154, v154, v155, s[52:53]
    v_cndmask_b32 v156, v156, v157, s[52:53]
    v_cndmask_b32 v158, v158, v159, s[52:53]
    v_cndmask_b32 v61, v152, v156, s[54:55]
    v_cndmask_b32 v65, v154, v158, s[56:57]
    v_max_f32 v69, v61, v65
    v_cndmask_b32 v160, v160, v161, s[52:53]
    v_cndmask_b32 v162, v162, v163, s[52:53]
    v_cndmask_b32 v164, v164, v165, s[52:53]
    v_cndmask_b32 v166, v166, v167, s[52:53]
    v_cndmask_b32 v62, v160, v164, s[54:55]
    v_cndmask_b32 v66, v162, v166, s[56:57]
    v_max_f32 v70, v62, v66
    v_cndmask_b32 v168, v168, v169, s[52:53]
    v_cndmask_b32 v170, v170, v171, s[52:53]
    v_cndmask_b32 v172, v172, v173, s[52:53]
    v_cndmask_b32 v174, v174, v175, s[52:53]
    v_cndmask_b32 v63, v168, v172, s[54:55]
    v_cndmask_b32 v67, v170, v174, s[56:57]
    v_max_f32 v71, v63, v67
    v_mov_b32 v72, v68
    v_mov_b32 v73, v69
    v_mov_b32 v74, v70
    v_mov_b32 v75, v71
    v_permlane16_swap_b32 v68, v72
    v_permlane16_swap_b32 v69, v73
    v_permlane16_swap_b32 v70, v74
    v_permlane16_swap_b32 v71, v75
    v_max_f32 v68, v68, v72
    v_max_f32 v69, v69, v73
    v_max_f32 v70, v70, v74
    v_max_f32 v71, v71, v75
    v_mov_b32 v72, v68
    v_mov_b32 v73, v69
    v_mov_b32 v74, v70
    v_mov_b32 v75, v71
    v_permlane32_swap_b32 v68, v72
    v_permlane32_swap_b32 v69, v73
    v_permlane32_swap_b32 v70, v74
    v_permlane32_swap_b32 v71, v75
    v_max_f32 v68, v68, v72
    v_max_f32 v69, v69, v73
    v_max_f32 v70, v70, v74
    v_max_f32 v71, v71, v75
    v_mul_f32 v68, v68, v56
    s_cmp_lg_u32 s66, 1
    s_cbranch_scc1 L_w1_42
    s_mul_i32 s62, s70, 7
    s_add_u32 s90, s62, 6
    s_lshr_b32 s62, s62, 2
    s_lshr_b32 s90, s90, 2
    v_add_u32 v51, s62, v1
    v_min_u32 v51, s90, v51
    v_add_u32 v51, 256, v51
    v_lshlrev_b32 v51, 7, v51
    s_mov_b64 exec, 7
    v_mov_b32 v52, 0
    buffer_atomic_add v52, v51, s[24:27], 0 offen sc0 sc1
    s_mov_b64 exec, -1
L_w1_42:
    v_mul_f32 v69, v69, v57
    v_mul_f32 v70, v70, v58
    v_mul_f32 v71, v71, v59
    v_fma_f32 v60, v60, v56, -v68
    v_fma_f32 v64, v64, v56, -v68
    v_fma_f32 v61, v61, v57, -v69
    v_fma_f32 v65, v65, v57, -v69
    v_fma_f32 v62, v62, v58, -v70
    v_fma_f32 v66, v66, v58, -v70
    v_fma_f32 v63, v63, v59, -v71
    v_fma_f32 v67, v67, v59, -v71
    v_exp_f32 v60, v60
    v_exp_f32 v64, v64
    v_exp_f32 v61, v61
    v_exp_f32 v65, v65
    v_exp_f32 v62, v62
    v_exp_f32 v66, v66
    v_exp_f32 v63, v63
    v_exp_f32 v67, v67
    v_add_f32 v68, v60, v64
    v_add_f32 v69, v61, v65
    v_add_f32 v70, v62, v66
    v_add_f32 v71, v63, v67
    v_mov_b32 v72, v68
    v_mov_b32 v73, v69
    v_mov_b32 v74, v70
    v_mov_b32 v75, v71
    v_permlane16_swap_b32 v68, v72
    v_permlane16_swap_b32 v69, v73
    v_permlane16_swap_b32 v70, v74
    v_permlane16_swap_b32 v71, v75
    v_add_f32 v68, v68, v72
    v_add_f32 v69, v69, v73
    v_add_f32 v70, v70, v74
    v_add_f32 v71, v71, v75
    v_mov_b32 v72, v68
    v_mov_b32 v73, v69
    v_mov_b32 v74, v70
    v_mov_b32 v75, v71
    v_permlane32_swap_b32 v68, v72
    v_permlane32_swap_b32 v69, v73
    v_permlane32_swap_b32 v70, v74
    v_permlane32_swap_b32 v71, v75
    v_add_f32 v68, v68, v72
    v_add_f32 v69, v69, v73
    v_add_f32 v70, v70, v74
    v_add_f32 v71, v71, v75
    v_rcp_f32 v68, v68
    v_rcp_f32 v69, v69
    v_rcp_f32 v70, v70
    v_rcp_f32 v71, v71
    v_mul_f32 v60, v60, v68
    v_mul_f32 v64, v64, v68
    v_mul_f32 v61, v61, v69
    v_mul_f32 v65, v65, v69
    v_mul_f32 v62, v62, v70
    v_mul_f32 v66, v66, v70
    v_mul_f32 v63, v63, v71
    v_mul_f32 v67, v67, v71
    v_cvt_pk_bf16_f32 v60, v60, v60
    v_cvt_pk_bf16_f32 v64, v64, v64
    v_and_b32 v144, v60, v22
    v_and_b32 v145, v64, v24
    v_and_b32 v146, v60, v23
    v_and_b32 v147, v64, v25
    v_cvt_pk_bf16_f32 v61, v61, v61
    v_cvt_pk_bf16_f32 v65, v65, v65
    v_and_b32 v152, v61, v22
    v_and_b32 v153, v65, v24
    v_and_b32 v154, v61, v23
    v_and_b32 v155, v65, v25
    v_cvt_pk_bf16_f32 v62, v62, v62
    v_cvt_pk_bf16_f32 v66, v66, v66
    v_and_b32 v160, v62, v22
    v_and_b32 v161, v66, v24
    v_and_b32 v162, v62, v23
    v_and_b32 v163, v66, v25
    v_cvt_pk_bf16_f32 v63, v63, v63
    v_cvt_pk_bf16_f32 v67, v67, v67
    v_and_b32 v168, v63, v22
    v_and_b32 v169, v67, v24
    v_and_b32 v170, v63, v23
    v_and_b32 v171, v67, v25
    s_nop 1
    v_mfma_f32_16x16x32_bf16 v[148:151], v[134:137], v[144:147], 0
    v_mfma_f32_16x16x32_bf16 v[156:159], v[136:139], v[152:155], 0
    v_mfma_f32_16x16x32_bf16 v[164:167], v[138:141], v[160:163], 0
    v_mfma_f32_16x16x32_bf16 v[172:175], v[140:143], v[168:171], 0
    s_nop 3
    s_add_u32 s63, s92, 0x10000
    v_cvt_pk_bf16_f32 v76, v148, v149
    v_cvt_pk_bf16_f32 v77, v150, v151
    v_cvt_pk_bf16_f32 v78, v156, v157
    v_cvt_pk_bf16_f32 v79, v158, v159
    v_cvt_pk_bf16_f32 v80, v164, v165
    v_cvt_pk_bf16_f32 v81, v166, v167
    v_cvt_pk_bf16_f32 v82, v172, v173
    v_cvt_pk_bf16_f32 v83, v174, v175
    s_nop 1
    v_permlane16_swap_b32 v76, v78
    v_permlane16_swap_b32 v77, v79
    v_permlane16_swap_b32 v80, v82
    v_permlane16_swap_b32 v81, v83
    buffer_store_dwordx4 v[76:79], v3, s[24:27], s92 offen sc1
    buffer_store_dwordx4 v[80:83], v3, s[24:27], s63 offen sc1
    s_and_b32 s65, s67, 15
    s_lshl_b32 s65, s65, 1
    s_add_u32 s65, s65, s72
    s_lshl_b32 s65, s65, 2
    s_add_u32 s65, s65, s73
    s_lshl_b32 s65, s65, 14
    s_xor_b32 s64, s98, 0x2000
    s_add_u32 s64, s64, s65
    s_add_u32 s64, s64, 0x600000
    s_add_u32 s65, s64, 4096
    s_lshr_b32 s62, s67, 4
    s_lshl_b32 s62, s62, 13
    s_xor_b32 s62, s62, s98
    s_lshl_b32 s63, s67, 3
    v_add_u32 v6, s63, v1
    s_lshl_b32 s63, s69, 4
    v_add_u32 v7, s63, v1
    v_bfe_u32 v9, v6, 6, 1
    v_lshlrev_b32 v9, 14, v9
    v_bfe_u32 v0, v6, 7, 1
    v_lshl_add_u32 v9, v0, 13, v9
    v_and_b32 v6, 63, v6
    v_lshl_add_u32 v6, v6, 7, v9
    v_xor_b32 v6, s62, v6
    v_bfe_u32 v9, v7, 6, 1
    v_lshlrev_b32 v9, 14, v9
    v_bfe_u32 v0, v7, 7, 1
    v_lshl_add_u32 v9, v0, 13, v9
    v_and_b32 v7, 63, v7
    v_lshl_add_u32 v7, v7, 7, v9
    v_xor_b32 v7, s62, v7
    s_nop 0
    v_readlane_b32 s86, v6, s68
    s_waitcnt vmcnt(4)
    s_waitcnt vmcnt(0)
    s_cmp_lg_u32 s66, 1
    s_cbranch_scc1 L_w1_43
    s_mov_b64 exec, 7
    s_mov_b32 s90, 0
    s_waitcnt vmcnt(0)
    s_branch L_pollc_46
L_poll_44:
    v_mov_b32 v52, 0
    buffer_atomic_add v52, v51, s[24:27], 0 offen sc0 sc1
    s_waitcnt vmcnt(0)
L_pollc_46:
    v_cmp_ne_u32 vcc, 8, v52
    s_cbranch_vccz L_polld_45
    s_add_u32 s90, s90, 1
    s_cmp_lt_u32 s90, 0x4000
    s_cbranch_scc1 L_poll_44
    v_mov_b32 v52, 258
    buffer_store_dword v52, v55, s[48:51], 0 offen offset:4
L_polld_45:
    s_mov_b64 exec, -1
L_w1_43:
    s_barrier
    s_cmp_lg_u32 s66, 0
    s_cbranch_scc1 L_sig_47
    s_mov_b64 exec, 0xff
    v_mov_b32 v52, 0x1
    buffer_atomic_add v52, v6, s[24:27], 0 offen offset:0 sc1
    s_mov_b64 exec, -1
L_sig_47:
    s_cmp_lg_u32 s66, 2
    s_cbranch_scc1 L_sd_48
    s_cmp_ge_u32 s97, 224
    s_cbranch_scc1 L_sd_48
    s_and_b32 s63, s97, 7
    s_add_u32 s62, s63, 288
    s_lshl_b32 s62, s62, 7
    s_mov_b64 exec, 1
    v_mov_b32 v52, 1
    buffer_atomic_add v52, v55, s[24:27], s62 offen sc1
    s_mov_b64 exec, -1
L_sd_48:
    s_getpc_b64 s[36:37]
L_pc_49:
    s_sub_u32 s36, s36, L_pc_49-interleave_layers__sliding_local_dilated__glu_gated_geglu__prompt_kernel
    s_subb_u32 s37, s37, 0
    s_and_b32 s37, s37, 0xffff
    s_mov_b32 s39, 0x20000
    s_mov_b32 s38, L_c1b-interleave_layers__sliding_local_dilated__glu_gated_geglu__prompt_kernel
    s_lshr_b32 s62, s2, 3
    s_lshl_b32 s62, s62, 2
    s_add_u32 s62, s62, s66
    s_lshl_b32 s62, s62, 7
    s_add_u32 s62, s62, (L_c34a-interleave_layers__sliding_local_dilated__glu_gated_geglu__prompt_kernel)&0xffffff80
    v_min_u32 v9, 7, v1
    v_lshl_add_u32 v9, v9, 14, s62
    buffer_load_dword v255, v9, s[36:39], 0 offen
    s_add_u32 m0, s82, 65536
    s_add_u32 s63, s83, 0
    buffer_load_dwordx4 v2, s[24:27], s63 offen offset:0 sc1 lds
    buffer_load_dwordx4 v2, s[24:27], s63 offen offset:1024 sc1 lds
    buffer_load_dwordx4 v2, s[24:27], s63 offen offset:2048 sc1 lds
    buffer_load_dwordx4 v2, s[24:27], s63 offen offset:3072 sc1 lds
    s_add_u32 m0, s82, 69632
    s_add_u32 s63, s83, 4096
    buffer_load_dwordx4 v2, s[24:27], s63 offen offset:0 sc1 lds
    buffer_load_dwordx4 v2, s[24:27], s63 offen offset:1024 sc1 lds
    buffer_load_dwordx4 v2, s[24:27], s63 offen offset:2048 sc1 lds
    buffer_load_dwordx4 v2, s[24:27], s63 offen offset:3072 sc1 lds
    s_mul_i32 s63, s70, 7
    s_add_u32 s63, s63, s66
    s_lshl_b32 s63, s63, 10
    s_lshl_b32 s62, s66, 10
    s_add_u32 m0, s62, 0x24000
    s_add_u32 s63, s63, 0x500000
    buffer_load_dwordx4 v2, s[24:27], s63 offen sc1 lds
    s_cmp_eq_u32 s66, 3
    s_cselect_b32 s63, 0x80000000, s63
    s_add_u32 m0, s62, 0x25000
    s_add_u32 s63, s63, 4096
    buffer_load_dwordx4 v2, s[24:27], s63 offen sc1 lds
    s_cmp_lg_u32 s66, 1
    s_cbranch_scc1 L_w1_50
    v_mov_b32 v51, s86
    s_mov_b64 exec, 1
    v_mov_b32 v52, 0
    buffer_atomic_add v52, v51, s[24:27], 0 offen sc0 sc1
    s_mov_b64 exec, -1
L_w1_50:
    ds_read_b64_tr_b16 v[120:121], v13 offset:0
    ds_read_b64_tr_b16 v[122:123], v13 offset:512
    ds_read_b64_tr_b16 v[124:125], v14 offset:0
    ds_read_b64_tr_b16 v[126:127], v14 offset:512
    ds_read_b64_tr_b16 v[128:129], v13 offset:2048
    ds_read_b64_tr_b16 v[130:131], v13 offset:2560
    ds_read_b64_tr_b16 v[132:133], v14 offset:2048
    ds_read_b64_tr_b16 v[134:135], v14 offset:2560
    ds_read_b64_tr_b16 v[136:137], v13 offset:4096
    ds_read_b64_tr_b16 v[138:139], v13 offset:4608
    ds_read_b64_tr_b16 v[140:141], v14 offset:4096
    ds_read_b64_tr_b16 v[142:143], v14 offset:4608
    v_lshlrev_b32 v88, 16, v26
    v_and_b32 v89, 0xffff0000, v26
    v_lshlrev_b32 v90, 16, v27
    v_and_b32 v91, 0xffff0000, v27
    v_lshlrev_b32 v92, 16, v28
    v_and_b32 v93, 0xffff0000, v28
    v_lshlrev_b32 v94, 16, v29
    v_and_b32 v95, 0xffff0000, v29
    v_lshlrev_b32 v96, 16, v30
    v_and_b32 v97, 0xffff0000, v30
    v_lshlrev_b32 v98, 16, v31
    v_and_b32 v99, 0xffff0000, v31
    v_lshlrev_b32 v100, 16, v32
    v_and_b32 v101, 0xffff0000, v32
    v_lshlrev_b32 v102, 16, v33
    v_and_b32 v103, 0xffff0000, v33
    s_cmp_lg_u32 s66, 1
    s_cbranch_scc1 L_w1_51
    s_mov_b64 exec, 1
    v_mov_b32 v5, 0
    buffer_atomic_add v5, v51, s[24:27], 0 offen sc0 sc1
    s_mov_b64 exec, -1
L_w1_51:
    s_lshl_b32 s62, s69, 2
    s_add_u32 s62, s62, s66
    s_and_b32 s62, s62, 31
    s_lshl_b32 s87, s62, 18
    s_lshr_b32 s63, s70, 1
    s_lshl_b32 s63, s63, 14
    s_add_u32 s87, s87, s63
    s_and_b32 s63, s70, 1
    s_lshl_b32 s63, s63, 12
    s_add_u32 s87, s87, s63
    s_lshl_b32 s63, s69, 12
    s_xor_b32 s63, s63, s98
    s_and_b32 s63, s63, 0x2000
    s_lshl_b32 s89, s71, 23
    s_add_u32 s89, s89, 0x1000000
    s_add_u32 s89, s89, s63
    s_add_u32 s87, s87, s89
    s_lshl_b32 s16, s62, 16
    s_lshl_b32 s63, s71, 22
    s_add_u32 s16, s16, s63
    s_add_u32 s16, s16, s98
    s_add_u32 s16, s16, 0x800000
    s_add_u32 s17, s16, 4096
    s_add_u32 s18, s16, 16384
    s_add_u32 s19, s16, 20480
    s_lshl_b32 s20, s62, 8
    s_lshl_b32 s63, s71, 18
    s_add_u32 s20, s20, s63
    s_add_u32 s20, s20, s98
    s_add_u32 s20, s20, 0x540000
    s_cmp_lg_u32 s66, 1
    s_cbranch_scc1 L_w1_52
    s_mov_b64 exec, 1
    v_mov_b32 v8, 0
    buffer_atomic_add v8, v51, s[24:27], 0 offen sc0 sc1
    s_mov_b64 exec, -1
L_w1_52:
    s_cmp_lg_u32 s66, 1
    s_cbranch_scc1 L_w1_53
    s_mov_b64 exec, 1
    s_mov_b32 s90, 0
    s_waitcnt vmcnt(2)
    v_bfe_u32 v52, v52, 0, 6
    v_cmp_ne_u32 vcc, 8, v52
    s_cbranch_vccz L_mpd_55
    s_waitcnt vmcnt(1)
    v_bfe_u32 v5, v5, 0, 6
    v_cmp_ne_u32 vcc, 8, v5
    s_cbranch_vccz L_mpd_55
L_mp_54:
    s_waitcnt vmcnt(0)
    v_bfe_u32 v8, v8, 0, 6
    v_cmp_ne_u32 vcc, 8, v8
    s_cbranch_vccz L_mpd_55
    v_mov_b32 v8, 0
    buffer_atomic_add v8, v51, s[24:27], 0 offen sc0 sc1
    s_add_u32 s90, s90, 1
    s_cmp_lt_u32 s90, 0x2000
    s_cbranch_scc1 L_mp_54
    v_mov_b32 v53, 257
    buffer_store_dword v53, v55, s[48:51], 0 offen offset:4
L_mpd_55:
    s_mov_b64 exec, -1
L_w1_53:
    s_barrier
    buffer_load_dwordx4 v[160:163], v3, s[24:27], s64 offen offset:0 sc1
    buffer_load_dwordx4 v[164:167], v3, s[24:27], s64 offen offset:512 sc1
    s_barrier
    buffer_load_dwordx4 v[168:171], v3, s[24:27], s64 offen offset:1024 sc1
    buffer_load_dwordx4 v[172:175], v3, s[24:27], s64 offen offset:1536 sc1
    buffer_load_dwordx4 v[176:179], v3, s[24:27], s64 offen offset:2048 sc1
    s_barrier
    buffer_load_dwordx4 v[180:183], v3, s[24:27], s64 offen offset:2560 sc1
    buffer_load_dwordx4 v[184:187], v3, s[24:27], s64 offen offset:3072 sc1
    buffer_load_dwordx4 v[188:191], v3, s[24:27], s64 offen offset:3584 sc1
    s_barrier
    buffer_load_dwordx4 v[192:195], v3, s[24:27], s65 offen offset:0 sc1
    buffer_load_dwordx4 v[196:199], v3, s[24:27], s65 offen offset:512 sc1
    s_mov_b32 s90, 0
    s_waitcnt vmcnt(9)
    s_waitcnt lgkmcnt(10)
    v_mfma_f32_32x32x16_bf16 v[88:103], v[120:123], v[160:163], v[88:103]
    ds_read_b64_tr_b16 v[144:145], v13 offset:6144
    ds_read_b64_tr_b16 v[146:147], v13 offset:6656
    buffer_load_dwordx4 v[200:203], v3, s[24:27], s65 offen offset:1024 sc1
    s_waitcnt lgkmcnt(10)
    v_mfma_f32_32x32x16_bf16 v[104:119], v[124:127], v[160:163], 0
    ds_read_b64_tr_b16 v[148:149], v14 offset:6144
    ds_read_b64_tr_b16 v[150:151], v14 offset:6656
    s_waitcnt vmcnt(9)
    s_waitcnt lgkmcnt(10)
    v_mfma_f32_32x32x16_bf16 v[88:103], v[128:131], v[164:167], v[88:103]
    ds_read_b64_tr_b16 v[120:121], v13 offset:8192
    ds_read_b64_tr_b16 v[122:123], v13 offset:8704
    buffer_load_dwordx4 v[204:207], v3, s[24:27], s65 offen offset:1536 sc1
    s_waitcnt lgkmcnt(10)
    v_mfma_f32_32x32x16_bf16 v[104:119], v[132:135], v[164:167], v[104:119]
    ds_read_b64_tr_b16 v[124:125], v14 offset:8192
    ds_read_b64_tr_b16 v[126:127], v14 offset:8704
    s_waitcnt vmcnt(9)
    s_waitcnt lgkmcnt(10)
    v_mfma_f32_32x32x16_bf16 v[88:103], v[136:139], v[168:171], v[88:103]
    ds_read_b64_tr_b16 v[128:129], v13 offset:10240
    ds_read_b64_tr_b16 v[130:131], v13 offset:10752
    buffer_load_dwordx4 v[208:211], v3, s[24:27], s65 offen offset:2048 sc1
    s_waitcnt lgkmcnt(10)
    v_mfma_f32_32x32x16_bf16 v[104:119], v[140:143], v[168:171], v[104:119]
    ds_read_b64_tr_b16 v[132:133], v14 offset:10240
    ds_read_b64_tr_b16 v[134:135], v14 offset:10752
    s_waitcnt vmcnt(9)
    s_waitcnt lgkmcnt(10)
    v_mfma_f32_32x32x16_bf16 v[88:103], v[144:147], v[172:175], v[88:103]
    ds_read_b64_tr_b16 v[136:137], v13 offset:12288
    ds_read_b64_tr_b16 v[138:139], v13 offset:12800
    buffer_load_dwordx4 v[212:215], v3, s[24:27], s65 offen offset:2560 sc1
    s_waitcnt lgkmcnt(10)
    v_mfma_f32_32x32x16_bf16 v[104:119], v[148:151], v[172:175], v[104:119]
    ds_read_b64_tr_b16 v[140:141], v14 offset:12288
    ds_read_b64_tr_b16 v[142:143], v14 offset:12800
    s_waitcnt vmcnt(9)
    s_waitcnt lgkmcnt(10)
    v_mfma_f32_32x32x16_bf16 v[88:103], v[120:123], v[176:179], v[88:103]
    ds_read_b64_tr_b16 v[144:145], v13 offset:14336
    ds_read_b64_tr_b16 v[146:147], v13 offset:14848
    buffer_load_dwordx4 v[216:219], v3, s[24:27], s65 offen offset:3072 sc1
    s_waitcnt lgkmcnt(10)
    v_mfma_f32_32x32x16_bf16 v[104:119], v[124:127], v[176:179], v[104:119]
    ds_read_b64_tr_b16 v[148:149], v14 offset:14336
    ds_read_b64_tr_b16 v[150:151], v14 offset:14848
    s_waitcnt vmcnt(9)
    s_waitcnt lgkmcnt(10)
    v_mfma_f32_32x32x16_bf16 v[88:103], v[128:131], v[180:183], v[88:103]
    ds_read_b64_tr_b16 v[120:121], v13 offset:32768
    ds_read_b64_tr_b16 v[122:123], v13 offset:33280
    buffer_load_dwordx4 v[220:223], v3, s[24:27], s65 offen offset:3584 sc1
    s_waitcnt lgkmcnt(10)
    v_mfma_f32_32x32x16_bf16 v[104:119], v[132:135], v[180:183], v[104:119]
    ds_read_b64_tr_b16 v[124:125], v14 offset:32768
    ds_read_b64_tr_b16 v[126:127], v14 offset:33280
    s_waitcnt vmcnt(9)
    s_waitcnt lgkmcnt(10)
    v_mfma_f32_32x32x16_bf16 v[88:103], v[136:139], v[184:187], v[88:103]
    ds_read_b64_tr_b16 v[128:129], v13 offset:34816
    ds_read_b64_tr_b16 v[130:131], v13 offset:35328
    s_add_u32 m0, s82, 98304
    s_add_u32 s63, s83, 32768
    buffer_load_dwordx4 v2, s[24:27], s63 offen offset:0 sc1 lds
    s_waitcnt lgkmcnt(10)
    v_mfma_f32_32x32x16_bf16 v[104:119], v[140:143], v[184:187], v[104:119]
    ds_read_b64_tr_b16 v[132:133], v14 offset:34816
    ds_read_b64_tr_b16 v[134:135], v14 offset:35328
    s_waitcnt vmcnt(9)
    buffer_load_dwordx4 v2, s[24:27], s63 offen offset:1024 sc1 lds
    s_waitcnt lgkmcnt(10)
    v_mfma_f32_32x32x16_bf16 v[88:103], v[144:147], v[188:191], v[88:103]
    ds_read_b64_tr_b16 v[136:137], v13 offset:36864
    ds_read_b64_tr_b16 v[138:139], v13 offset:37376
    buffer_load_dwordx4 v2, s[24:27], s63 offen offset:2048 sc1 lds
    s_waitcnt lgkmcnt(10)
    v_mfma_f32_32x32x16_bf16 v[104:119], v[148:151], v[188:191], v[104:119]
    ds_read_b64_tr_b16 v[140:141], v14 offset:36864
    ds_read_b64_tr_b16 v[142:143], v14 offset:37376
    s_waitcnt vmcnt(10)
    buffer_load_dwordx4 v2, s[24:27], s63 offen offset:3072 sc1 lds
    s_waitcnt lgkmcnt(10)
    v_mfma_f32_32x32x16_bf16 v[88:103], v[120:123], v[192:195], v[88:103]
    ds_read_b64_tr_b16 v[144:145], v13 offset:38912
    ds_read_b64_tr_b16 v[146:147], v13 offset:39424
    s_add_u32 m0, s82, 102400
    s_add_u32 s63, s83, 36864
    buffer_load_dwordx4 v2, s[24:27], s63 offen offset:0 sc1 lds
    s_waitcnt lgkmcnt(10)
    v_mfma_f32_32x32x16_bf16 v[104:119], v[124:127], v[192:195], v[104:119]
    ds_read_b64_tr_b16 v[148:149], v14 offset:38912
    ds_read_b64_tr_b16 v[150:151], v14 offset:39424
    s_waitcnt vmcnt(11)
    buffer_load_dwordx4 v2, s[24:27], s63 offen offset:1024 sc1 lds
    s_barrier
    s_waitcnt lgkmcnt(10)
    v_mfma_f32_32x32x16_bf16 v[88:103], v[128:131], v[196:199], v[88:103]
    ds_read_b64_tr_b16 v[120:121], v13 offset:40960
    ds_read_b64_tr_b16 v[122:123], v13 offset:41472
    buffer_load_dwordx4 v2, s[24:27], s63 offen offset:2048 sc1 lds
    s_waitcnt lgkmcnt(10)
    v_mfma_f32_32x32x16_bf16 v[104:119], v[132:135], v[196:199], v[104:119]
    ds_read_b64_tr_b16 v[124:125], v14 offset:40960
    ds_read_b64_tr_b16 v[126:127], v14 offset:41472
    s_waitcnt vmcnt(12)
    buffer_load_dwordx4 v2, s[24:27], s63 offen offset:3072 sc1 lds
    s_waitcnt lgkmcnt(10)
    v_mfma_f32_32x32x16_bf16 v[88:103], v[136:139], v[200:203], v[88:103]
    ds_read_b64_tr_b16 v[128:129], v13 offset:43008
    ds_read_b64_tr_b16 v[130:131], v13 offset:43520
    s_add_u32 m0, s82, 0
    s_add_u32 s63, s83, 65536
    buffer_load_dwordx4 v2, s[24:27], s63 offen offset:0 sc1 lds
    s_waitcnt lgkmcnt(10)
    v_mfma_f32_32x32x16_bf16 v[104:119], v[140:143], v[200:203], v[104:119]
    ds_read_b64_tr_b16 v[132:133], v14 offset:43008
    ds_read_b64_tr_b16 v[134:135], v14 offset:43520
    s_waitcnt vmcnt(13)
    buffer_load_dwordx4 v2, s[24:27], s63 offen offset:1024 sc1 lds
    s_waitcnt lgkmcnt(10)
    v_mfma_f32_32x32x16_bf16 v[88:103], v[144:147], v[204:207], v[88:103]
    ds_read_b64_tr_b16 v[136:137], v13 offset:45056
    ds_read_b64_tr_b16 v[138:139], v13 offset:45568
    buffer_load_dwordx4 v2, s[24:27], s63 offen offset:2048 sc1 lds
    s_waitcnt lgkmcnt(10)
    v_mfma_f32_32x32x16_bf16 v[104:119], v[148:151], v[204:207], v[104:119]
    ds_read_b64_tr_b16 v[140:141], v14 offset:45056
    ds_read_b64_tr_b16 v[142:143], v14 offset:45568
    s_waitcnt vmcnt(14)
    buffer_load_dwordx4 v2, s[24:27], s63 offen offset:3072 sc1 lds
    s_waitcnt lgkmcnt(10)
    v_mfma_f32_32x32x16_bf16 v[88:103], v[120:123], v[208:211], v[88:103]
    ds_read_b64_tr_b16 v[144:145], v13 offset:47104
    ds_read_b64_tr_b16 v[146:147], v13 offset:47616
    s_add_u32 m0, s82, 4096
    s_add_u32 s63, s83, 69632
    buffer_load_dwordx4 v2, s[24:27], s63 offen offset:0 sc1 lds
    s_waitcnt lgkmcnt(10)
    v_mfma_f32_32x32x16_bf16 v[104:119], v[124:127], v[208:211], v[104:119]
    ds_read_b64_tr_b16 v[148:149], v14 offset:47104
    ds_read_b64_tr_b16 v[150:151], v14 offset:47616
    s_waitcnt vmcnt(15)
    buffer_load_dwordx4 v2, s[24:27], s63 offen offset:1024 sc1 lds
    s_waitcnt lgkmcnt(10)
    v_mfma_f32_32x32x16_bf16 v[88:103], v[128:131], v[212:215], v[88:103]
    buffer_load_dwordx4 v2, s[24:27], s63 offen offset:2048 sc1 lds
    s_waitcnt lgkmcnt(8)
    v_mfma_f32_32x32x16_bf16 v[104:119], v[132:135], v[212:215], v[104:119]
    s_waitcnt vmcnt(16)
    buffer_load_dwordx4 v2, s[24:27], s63 offen offset:3072 sc1 lds
    s_waitcnt lgkmcnt(6)
    v_mfma_f32_32x32x16_bf16 v[88:103], v[136:139], v[216:219], v[88:103]
    s_waitcnt lgkmcnt(4)
    v_mfma_f32_32x32x16_bf16 v[104:119], v[140:143], v[216:219], v[104:119]
    s_waitcnt vmcnt(16)
    s_waitcnt lgkmcnt(2)
    v_mfma_f32_32x32x16_bf16 v[88:103], v[144:147], v[220:223], v[88:103]
    s_waitcnt lgkmcnt(0)
    v_mfma_f32_32x32x16_bf16 v[104:119], v[148:151], v[220:223], v[104:119]
    s_lshl_b32 s62, s66, 12
    s_add_u32 s62, s62, 0x20000
    v_add_u32 v152, s62, v2
    s_xor_b32 s62, s62, 0x2000
    v_add_u32 v153, s62, v2
    v_mov_b32 v154, 0
    v_mov_b32 v155, 0
    v_mov_b32 v156, 0
    v_mov_b32 v157, 0
    s_nop 3
    ds_write_b128 v152, v[104:107] offset:0
    ds_write_b128 v152, v[108:111] offset:1024
    ds_write_b128 v152, v[112:115] offset:2048
    ds_write_b128 v152, v[116:119] offset:3072
    s_waitcnt lgkmcnt(0)
    s_barrier
    ds_read_b128 v[104:107], v153 offset:0
    ds_read_b128 v[108:111], v153 offset:1024
    ds_read_b128 v[112:115], v153 offset:2048
    ds_read_b128 v[116:119], v153 offset:3072
    s_waitcnt lgkmcnt(3)
    v_pk_add_f32 v[88:89], v[88:89], v[104:105]
    v_pk_add_f32 v[90:91], v[90:91], v[106:107]
    v_cvt_pk_bf16_f32 v26, v88, v89
    v_cvt_pk_bf16_f32 v27, v90, v91
    s_waitcnt lgkmcnt(2)
    v_pk_add_f32 v[92:93], v[92:93], v[108:109]
    v_pk_add_f32 v[94:95], v[94:95], v[110:111]
    v_cvt_pk_bf16_f32 v28, v92, v93
    v_cvt_pk_bf16_f32 v29, v94, v95
    buffer_store_dwordx4 v[26:29], v3, s[24:27], s93 offen sc1
    s_waitcnt lgkmcnt(1)
    v_pk_add_f32 v[96:97], v[96:97], v[112:113]
    v_pk_add_f32 v[98:99], v[98:99], v[114:115]
    v_cvt_pk_bf16_f32 v30, v96, v97
    v_cvt_pk_bf16_f32 v31, v98, v99
    s_waitcnt lgkmcnt(0)
    v_pk_add_f32 v[100:101], v[100:101], v[116:117]
    v_pk_add_f32 v[102:103], v[102:103], v[118:119]
    v_cvt_pk_bf16_f32 v32, v100, v101
    v_cvt_pk_bf16_f32 v33, v102, v103
    buffer_store_dwordx4 v[30:33], v3, s[24:27], s93 offen offset:512 sc1
    v_dot2c_f32_bf16 v154, v26, v46
    v_dot2c_f32_bf16 v155, v26, v26
    v_dot2c_f32_bf16 v156, v27, v46
    v_dot2c_f32_bf16 v157, v27, v27
    v_dot2c_f32_bf16 v154, v28, v46
    v_dot2c_f32_bf16 v155, v28, v28
    v_dot2c_f32_bf16 v156, v29, v46
    v_dot2c_f32_bf16 v157, v29, v29
    v_dot2c_f32_bf16 v154, v30, v46
    v_dot2c_f32_bf16 v155, v30, v30
    v_dot2c_f32_bf16 v156, v31, v46
    v_dot2c_f32_bf16 v157, v31, v31
    v_dot2c_f32_bf16 v154, v32, v46
    v_dot2c_f32_bf16 v155, v32, v32
    v_dot2c_f32_bf16 v156, v33, v46
    v_dot2c_f32_bf16 v157, v33, v33
    s_nop 2
    v_add_f32 v154, v154, v156
    v_add_f32 v155, v155, v157
    v_mov_b32 v156, v154
    v_mov_b32 v157, v155
    s_nop 1
    v_permlane32_swap_b32 v154, v156
    v_permlane32_swap_b32 v155, v157
    s_nop 0
    v_add_f32 v154, v154, v156
    v_add_f32 v155, v155, v157
    buffer_store_dwordx2 v[154:155], v19, s[24:27], s94 offen sc1
    s_waitcnt vmcnt(0)
    s_barrier
    s_cmp_lg_u32 s66, 0
    s_cbranch_scc1 L_sig_56
    s_mov_b64 exec, 0xffff
    v_mov_b32 v52, 0x1000
    buffer_atomic_add v52, v7, s[24:27], 0 offen offset:0 sc1
    s_mov_b64 exec, -1
L_sig_56:
L_c34a:
    s_cmp_lg_u32 s66, 1
    s_cbranch_scc1 L_w1_57
    v_mov_b32 v51, s86
    s_mov_b64 exec, 1
    v_mov_b32 v52, 0
    buffer_atomic_add v52, v51, s[24:27], 0 offen sc0 sc1
    s_mov_b64 exec, -1
L_w1_57:
    ds_read_b128 v[104:107], v15 offset:0
    ds_read_b128 v[108:111], v15 offset:32768
    ds_read_b128 v[112:115], v15 offset:1024
    ds_read_b128 v[116:119], v15 offset:33792
    ds_read_b128 v[120:123], v15 offset:2048
    ds_read_b128 v[124:127], v15 offset:34816
    s_lshl_b32 s62, s67, 1
    s_add_u32 s62, s62, s73
    s_and_b32 s62, s62, 31
    s_lshl_b32 s62, s62, 2
    s_add_u32 s62, s62, s72
    s_lshl_b32 s62, s62, 16
    s_add_u32 s8, s62, s89
    s_add_u32 s9, s8, 4096
    s_add_u32 s10, s8, 16384
    s_add_u32 s11, s8, 20480
    s_add_u32 s12, s8, 32768
    s_add_u32 s13, s8, 36864
    s_add_u32 s14, s8, 49152
    s_add_u32 s15, s8, 53248
    s_lshl_b32 s62, s72, 14
    s_lshl_b32 s63, s73, 10
    s_add_u32 s85, s62, s63
    s_mul_i32 s62, s72, 17408
    v_add_u32 v250, s62, v2
    v_xor_b32 v251, 0x400, v250
    v_add_u32 v252, 0x10000, v250
    v_add_u32 v253, 0x10000, v251
    s_lshl_b32 s62, s68, 2
    s_lshl_b32 s63, s73, 1
    s_add_u32 s62, s62, s63
    s_add_u32 s62, s62, s72
    s_mul_i32 s62, s62, 57344
    s_add_u32 s84, s62, 0x2200000
    s_add_u32 s44, s24, 0x2400000
    s_addc_u32 s45, s25, 0
    s_cmp_eq_u32 s71, 0
    s_cselect_b32 s46, 0x180000, 0
    s_lshl_b32 s89, s67, 1
    s_add_u32 s89, s89, s72
    s_lshl_b32 s89, s89, 15
    s_lshl_b32 s63, s68, 1
    s_add_u32 s63, s63, s73
    s_lshl_b32 s63, s63, 6
    s_add_u32 s89, s89, s63
    s_xor_b32 s88, s93, 0x2000
    s_add_u32 s88, s88, 0x600000
    s_cmp_lg_u32 s66, 1
    s_cbranch_scc1 L_w1_58
    s_mov_b64 exec, 1
    v_mov_b32 v5, 0
    buffer_atomic_add v5, v51, s[24:27], 0 offen sc0 sc1
    s_mov_b64 exec, -1
L_w1_58:
    s_cmp_lg_u32 s66, 1
    s_cbranch_scc1 L_w1_59
    s_mov_b64 exec, 1
    s_mov_b32 s90, 0
    s_waitcnt vmcnt(1)
    v_bfe_u32 v52, v52, 12, 6
    v_cmp_ne_u32 vcc, 16, v52
    s_cbranch_vccz L_mpd_61
L_mp_60:
    s_waitcnt vmcnt(0)
    v_bfe_u32 v5, v5, 12, 6
    v_cmp_ne_u32 vcc, 16, v5
    s_cbranch_vccz L_mpd_61
    v_mov_b32 v5, 0
    buffer_atomic_add v5, v51, s[24:27], 0 offen sc0 sc1
    s_add_u32 s90, s90, 1
    s_cmp_lt_u32 s90, 0x2000
    s_cbranch_scc1 L_mp_60
    v_mov_b32 v53, 259
    buffer_store_dword v53, v55, s[48:51], 0 offen offset:4
L_mpd_61:
    s_mov_b64 exec, -1
L_w1_59:
    s_barrier
    s_mov_b32 s90, 0
    buffer_load_dwordx4 a[0:3], v3, s[24:27], s16 offen offset:0 sc1
    buffer_load_dwordx4 a[4:7], v3, s[24:27], s16 offen offset:512 sc1
    s_barrier
    buffer_load_dwordx4 a[8:11], v3, s[24:27], s16 offen offset:1024 sc1
    buffer_load_dwordx4 a[12:15], v3, s[24:27], s16 offen offset:1536 sc1
    buffer_load_dwordx4 a[16:19], v3, s[24:27], s16 offen offset:2048 sc1
    s_barrier
    buffer_load_dwordx4 a[20:23], v3, s[24:27], s16 offen offset:2560 sc1
    buffer_load_dwordx4 a[24:27], v3, s[24:27], s16 offen offset:3072 sc1
    buffer_load_dwordx4 a[28:31], v3, s[24:27], s16 offen offset:3584 sc1
    s_barrier
    buffer_load_dwordx4 a[32:35], v3, s[24:27], s17 offen offset:0 sc1
    buffer_load_dwordx4 a[36:39], v3, s[24:27], s17 offen offset:512 sc1
    s_waitcnt lgkmcnt(4)
    s_waitcnt vmcnt(9)
    v_mfma_f32_32x32x16_bf16 v[56:71], v[104:107], a[0:3], 0
    buffer_load_dwordx4 a[40:43], v3, s[24:27], s17 offen offset:1024 sc1
    ds_read_b128 v[128:131], v15 offset:3072
    v_mfma_f32_32x32x16_bf16 v[72:87], v[108:111], a[0:3], 0
    ds_read_b128 v[132:135], v15 offset:35840
    s_waitcnt vmcnt(9)
    s_waitcnt lgkmcnt(4)
    v_mfma_f32_32x32x16_bf16 v[56:71], v[112:115], a[4:7], v[56:71]
    buffer_load_dwordx4 a[44:47], v3, s[24:27], s17 offen offset:1536 sc1
    ds_read_b128 v[104:107], v15 offset:4096
    v_mfma_f32_32x32x16_bf16 v[72:87], v[116:119], a[4:7], v[72:87]
    s_add_u32 s65, s20, 0
    buffer_load_dwordx2 v[88:89], v20, s[24:27], s65 offen sc1
    ds_read_b128 v[108:111], v15 offset:36864
    s_waitcnt vmcnt(10)
    s_waitcnt lgkmcnt(4)
    v_mfma_f32_32x32x16_bf16 v[56:71], v[120:123], a[8:11], v[56:71]
    buffer_load_dwordx4 a[48:51], v3, s[24:27], s17 offen offset:2048 sc1
    ds_read_b128 v[112:115], v15 offset:5120
    v_mfma_f32_32x32x16_bf16 v[72:87], v[124:127], a[8:11], v[72:87]
    s_add_u32 s65, s20, 16384
    buffer_load_dwordx2 v[90:91], v20, s[24:27], s65 offen sc1
    ds_read_b128 v[116:119], v15 offset:37888
    s_waitcnt vmcnt(11)
    s_waitcnt lgkmcnt(4)
    v_mfma_f32_32x32x16_bf16 v[56:71], v[128:131], a[12:15], v[56:71]
    buffer_load_dwordx4 a[52:55], v3, s[24:27], s17 offen offset:2560 sc1
    ds_read_b128 v[120:123], v15 offset:6144
    v_mfma_f32_32x32x16_bf16 v[72:87], v[132:135], a[12:15], v[72:87]
    s_add_u32 s65, s20, 32768
    buffer_load_dwordx2 v[92:93], v20, s[24:27], s65 offen sc1
    ds_read_b128 v[124:127], v15 offset:38912
    s_waitcnt vmcnt(12)
    s_waitcnt lgkmcnt(4)
    v_mfma_f32_32x32x16_bf16 v[56:71], v[104:107], a[16:19], v[56:71]
    buffer_load_dwordx4 a[56:59], v3, s[24:27], s17 offen offset:3072 sc1
    ds_read_b128 v[128:131], v15 offset:7168
    v_mfma_f32_32x32x16_bf16 v[72:87], v[108:111], a[16:19], v[72:87]
    s_add_u32 s65, s20, 49152
    buffer_load_dwordx2 v[94:95], v20, s[24:27], s65 offen sc1
    ds_read_b128 v[132:135], v15 offset:39936
    s_waitcnt vmcnt(13)
    s_waitcnt lgkmcnt(4)
    v_mfma_f32_32x32x16_bf16 v[56:71], v[112:115], a[20:23], v[56:71]
    buffer_load_dwordx4 a[60:63], v3, s[24:27], s17 offen offset:3584 sc1
    ds_read_b128 v[104:107], v15 offset:8192
    v_mfma_f32_32x32x16_bf16 v[72:87], v[116:119], a[20:23], v[72:87]
    s_add_u32 s65, s20, 65536
    buffer_load_dwordx2 v[96:97], v20, s[24:27], s65 offen sc1
    ds_read_b128 v[108:111], v15 offset:40960
    s_waitcnt vmcnt(14)
    s_waitcnt lgkmcnt(4)
    v_mfma_f32_32x32x16_bf16 v[56:71], v[120:123], a[24:27], v[56:71]
    buffer_load_dwordx4 a[64:67], v3, s[24:27], s18 offen offset:0 sc1
    ds_read_b128 v[112:115], v15 offset:9216
    v_mfma_f32_32x32x16_bf16 v[72:87], v[124:127], a[24:27], v[72:87]
    s_add_u32 s65, s20, 81920
    buffer_load_dwordx2 v[98:99], v20, s[24:27], s65 offen sc1
    ds_read_b128 v[116:119], v15 offset:41984
    s_waitcnt vmcnt(15)
    s_waitcnt lgkmcnt(4)
    v_mfma_f32_32x32x16_bf16 v[56:71], v[128:131], a[28:31], v[56:71]
    buffer_load_dwordx4 a[68:71], v3, s[24:27], s18 offen offset:512 sc1
    ds_read_b128 v[120:123], v15 offset:10240
    v_mfma_f32_32x32x16_bf16 v[72:87], v[132:135], a[28:31], v[72:87]
    s_add_u32 s65, s20, 98304
    buffer_load_dwordx2 v[100:101], v20, s[24:27], s65 offen sc1
    ds_read_b128 v[124:127], v15 offset:43008
    s_waitcnt vmcnt(16)
    s_waitcnt lgkmcnt(4)
    v_mfma_f32_32x32x16_bf16 v[56:71], v[104:107], a[32:35], v[56:71]
    buffer_load_dwordx4 a[72:75], v3, s[24:27], s18 offen offset:1024 sc1
    ds_read_b128 v[128:131], v15 offset:11264
    v_mfma_f32_32x32x16_bf16 v[72:87], v[108:111], a[32:35], v[72:87]
    s_add_u32 s65, s20, 114688
    buffer_load_dwordx2 v[102:103], v20, s[24:27], s65 offen sc1
    ds_read_b128 v[132:135], v15 offset:44032
    s_waitcnt vmcnt(17)
    s_waitcnt lgkmcnt(4)
    v_mfma_f32_32x32x16_bf16 v[56:71], v[112:115], a[36:39], v[56:71]
    buffer_load_dwordx4 a[76:79], v3, s[24:27], s18 offen offset:1536 sc1
    ds_read_b128 v[104:107], v15 offset:12288
    v_mfma_f32_32x32x16_bf16 v[72:87], v[116:119], a[36:39], v[72:87]
    ds_read_b128 v[108:111], v15 offset:45056
    s_waitcnt vmcnt(17)
    s_waitcnt lgkmcnt(4)
    v_mfma_f32_32x32x16_bf16 v[56:71], v[120:123], a[40:43], v[56:71]
    buffer_load_dwordx4 a[80:83], v3, s[24:27], s18 offen offset:2048 sc1
    ds_read_b128 v[112:115], v15 offset:13312
    v_mfma_f32_32x32x16_bf16 v[72:87], v[124:127], a[40:43], v[72:87]
    ds_read_b128 v[116:119], v15 offset:46080
    s_waitcnt vmcnt(17)
    s_waitcnt lgkmcnt(4)
    v_mfma_f32_32x32x16_bf16 v[56:71], v[128:131], a[44:47], v[56:71]
    buffer_load_dwordx4 a[84:87], v3, s[24:27], s18 offen offset:2560 sc1
    ds_read_b128 v[120:123], v15 offset:14336
    v_mfma_f32_32x32x16_bf16 v[72:87], v[132:135], a[44:47], v[72:87]
    ds_read_b128 v[124:127], v15 offset:47104
    s_waitcnt vmcnt(16)
    s_waitcnt lgkmcnt(4)
    v_mfma_f32_32x32x16_bf16 v[56:71], v[104:107], a[48:51], v[56:71]
    buffer_load_dwordx4 a[88:91], v3, s[24:27], s18 offen offset:3072 sc1
    ds_read_b128 v[128:131], v15 offset:15360
    v_mfma_f32_32x32x16_bf16 v[72:87], v[108:111], a[48:51], v[72:87]
    ds_read_b128 v[132:135], v15 offset:48128
    s_waitcnt vmcnt(15)
    s_waitcnt lgkmcnt(4)
    v_mfma_f32_32x32x16_bf16 v[56:71], v[112:115], a[52:55], v[56:71]
    buffer_load_dwordx4 a[92:95], v3, s[24:27], s18 offen offset:3584 sc1
    ds_read_b128 v[104:107], v15 offset:16384
    v_mfma_f32_32x32x16_bf16 v[72:87], v[116:119], a[52:55], v[72:87]
    ds_read_b128 v[108:111], v15 offset:49152
    s_waitcnt vmcnt(14)
    s_waitcnt lgkmcnt(4)
    v_mfma_f32_32x32x16_bf16 v[56:71], v[120:123], a[56:59], v[56:71]
    buffer_load_dwordx4 a[96:99], v3, s[24:27], s19 offen offset:0 sc1
    ds_read_b128 v[112:115], v15 offset:17408
    v_mfma_f32_32x32x16_bf16 v[72:87], v[124:127], a[56:59], v[72:87]
    ds_read_b128 v[116:119], v15 offset:50176
    s_waitcnt vmcnt(13)
    s_waitcnt lgkmcnt(4)
    v_mfma_f32_32x32x16_bf16 v[56:71], v[128:131], a[60:63], v[56:71]
    buffer_load_dwordx4 a[100:103], v3, s[24:27], s19 offen offset:512 sc1
    ds_read_b128 v[120:123], v15 offset:18432
    v_mfma_f32_32x32x16_bf16 v[72:87], v[132:135], a[60:63], v[72:87]
    ds_read_b128 v[124:127], v15 offset:51200
    s_waitcnt vmcnt(12)
    s_waitcnt lgkmcnt(4)
    v_mfma_f32_32x32x16_bf16 v[56:71], v[104:107], a[64:67], v[56:71]
    buffer_load_dwordx4 a[104:107], v3, s[24:27], s19 offen offset:1024 sc1
    ds_read_b128 v[128:131], v15 offset:19456
    v_mfma_f32_32x32x16_bf16 v[72:87], v[108:111], a[64:67], v[72:87]
    ds_read_b128 v[132:135], v15 offset:52224
    s_waitcnt vmcnt(11)
    s_waitcnt lgkmcnt(4)
    v_mfma_f32_32x32x16_bf16 v[56:71], v[112:115], a[68:71], v[56:71]
    buffer_load_dwordx4 a[108:111], v3, s[24:27], s19 offen offset:1536 sc1
    ds_read_b128 v[104:107], v15 offset:20480
    v_mfma_f32_32x32x16_bf16 v[72:87], v[116:119], a[68:71], v[72:87]
    ds_read_b128 v[108:111], v15 offset:53248
    s_waitcnt vmcnt(10)
    s_waitcnt lgkmcnt(4)
    v_mfma_f32_32x32x16_bf16 v[56:71], v[120:123], a[72:75], v[56:71]
    buffer_load_dwordx4 a[112:115], v3, s[24:27], s19 offen offset:2048 sc1
    ds_read_b128 v[112:115], v15 offset:21504
    v_mfma_f32_32x32x16_bf16 v[72:87], v[124:127], a[72:75], v[72:87]
    ds_read_b128 v[116:119], v15 offset:54272
    s_waitcnt vmcnt(9)
    s_waitcnt lgkmcnt(4)
    v_mfma_f32_32x32x16_bf16 v[56:71], v[128:131], a[76:79], v[56:71]
    buffer_load_dwordx4 a[116:119], v3, s[24:27], s19 offen offset:2560 sc1
    ds_read_b128 v[120:123], v15 offset:22528
    v_add_f32 v88, v88, v90
    v_add_f32 v88, v88, v92
    v_mfma_f32_32x32x16_bf16 v[72:87], v[132:135], a[76:79], v[72:87]
    ds_read_b128 v[124:127], v15 offset:55296
    s_waitcnt vmcnt(9)
    v_add_f32 v88, v88, v94
    v_add_f32 v88, v88, v96
    v_add_f32 v88, v88, v98
    v_add_f32 v88, v88, v100
    s_waitcnt lgkmcnt(4)
    v_mfma_f32_32x32x16_bf16 v[56:71], v[104:107], a[80:83], v[56:71]
    buffer_load_dwordx4 a[120:123], v3, s[24:27], s19 offen offset:3072 sc1
    ds_read_b128 v[128:131], v15 offset:23552
    v_add_f32 v88, v88, v102
    v_add_f32 v89, v89, v91
    v_mfma_f32_32x32x16_bf16 v[72:87], v[108:111], a[80:83], v[72:87]
    ds_read_b128 v[132:135], v15 offset:56320
    s_waitcnt vmcnt(9)
    v_add_f32 v89, v89, v93
    v_add_f32 v89, v89, v95
    v_add_f32 v89, v89, v97
    v_add_f32 v89, v89, v99
    s_waitcnt lgkmcnt(4)
    v_mfma_f32_32x32x16_bf16 v[56:71], v[112:115], a[84:87], v[56:71]
    buffer_load_dwordx4 a[124:127], v3, s[24:27], s19 offen offset:3584 sc1
    ds_read_b128 v[104:107], v15 offset:24576
    v_add_f32 v89, v89, v101
    v_add_f32 v89, v89, v103
    v_mfma_f32_32x32x16_bf16 v[72:87], v[116:119], a[84:87], v[72:87]
    ds_read_b128 v[108:111], v15 offset:57344
    s_waitcnt vmcnt(9)
    v_mov_b32 v90, v88
    v_mov_b32 v91, v89
    s_nop 1
    v_permlane32_swap_b32 v88, v90
    s_cmp_lg_u32 s66, 1
    s_cbranch_scc1 L_w1_62
    s_add_u32 s62, s68, 288
    s_lshl_b32 s62, s62, 7
    v_mov_b32 v51, s62
    s_mov_b64 exec, 1
    v_mov_b32 v52, 0
    buffer_atomic_add v52, v51, s[24:27], 0 offen sc0 sc1
    s_mov_b64 exec, -1
L_w1_62:
    s_waitcnt lgkmcnt(4)
    v_mfma_f32_32x32x16_bf16 v[56:71], v[120:123], a[88:91], v[56:71]
    ds_read_b128 v[112:115], v15 offset:25600
    v_permlane32_swap_b32 v89, v91
    s_nop 0
    v_add_f32 v88, v88, v90
    v_add_f32 v89, v89, v91
    v_mfma_f32_32x32x16_bf16 v[72:87], v[124:127], a[88:91], v[72:87]
    ds_read_b128 v[116:119], v15 offset:58368
    s_waitcnt vmcnt(8)
    v_mul_f32 v92, 0xbb000000, v88
    v_mul_f32 v142, v92, v92
    v_mov_b32 v93, 0x3b000000
    v_fma_f32 v142, v89, v93, -v142
    s_waitcnt lgkmcnt(4)
    v_mfma_f32_32x32x16_bf16 v[56:71], v[128:131], a[92:95], v[56:71]
    s_add_u32 m0, s82, 32768
    s_add_u32 s63, s83, 98304
    buffer_load_dwordx4 v2, s[24:27], s63 offen offset:0 sc1 lds
    ds_read_b128 v[120:123], v15 offset:26624
    v_mfma_f32_32x32x16_bf16 v[72:87], v[132:135], a[92:95], v[72:87]
    ds_read_b128 v[124:127], v15 offset:59392
    s_waitcnt vmcnt(8)
    v_max_f32 v142, 0, v142
    v_add_f32 v142, 0x3727c5ac, v142
    v_rsq_f32 v93, v142
    s_waitcnt lgkmcnt(4)
    v_mfma_f32_32x32x16_bf16 v[56:71], v[104:107], a[96:99], v[56:71]
    buffer_load_dwordx4 v2, s[24:27], s63 offen offset:1024 sc1 lds
    ds_read_b128 v[128:131], v15 offset:27648
    v_cvt_pk_bf16_f32 v136, v92, v92
    v_and_b32 v94, 0xffff0000, v136
    v_mfma_f32_32x32x16_bf16 v[72:87], v[108:111], a[96:99], v[72:87]
    ds_read_b128 v[132:135], v15 offset:60416
    s_waitcnt vmcnt(8)
    v_mul_f32 v140, 0xc0135761, v93
    v_sub_f32 v94, v92, v94
    v_mul_f32 v95, v93, v93
    v_cvt_pk_bf16_f32 v137, v94, v55
    s_waitcnt lgkmcnt(4)
    v_mfma_f32_32x32x16_bf16 v[56:71], v[112:115], a[100:103], v[56:71]
    buffer_load_dwordx4 v2, s[24:27], s63 offen offset:2048 sc1 lds
    ds_read_b128 v[104:107], v15 offset:28672
    v_mul_f32 v95, 0x3d372713, v95
    v_mov_b32 v138, v136
    v_mfma_f32_32x32x16_bf16 v[72:87], v[116:119], a[100:103], v[72:87]
    ds_read_b128 v[108:111], v15 offset:61440
    s_waitcnt vmcnt(8)
    v_mul_f32 v141, v140, v95
    v_mov_b32 v139, v137
    s_waitcnt lgkmcnt(4)
    v_mfma_f32_32x32x16_bf16 v[56:71], v[120:123], a[104:107], v[56:71]
    buffer_load_dwordx4 v2, s[24:27], s63 offen offset:3072 sc1 lds
    ds_read_b128 v[112:115], v15 offset:29696
    v_mfma_f32_32x32x16_bf16 v[72:87], v[124:127], a[104:107], v[72:87]
    ds_read_b128 v[116:119], v15 offset:62464
    s_waitcnt vmcnt(8)
    s_waitcnt lgkmcnt(4)
    v_mfma_f32_32x32x16_bf16 v[56:71], v[128:131], a[108:111], v[56:71]
    s_add_u32 m0, s82, 36864
    s_add_u32 s63, s83, 102400
    buffer_load_dwordx4 v2, s[24:27], s63 offen offset:0 sc1 lds
    ds_read_b128 v[120:123], v15 offset:30720
    v_mfma_f32_32x32x16_bf16 v[72:87], v[132:135], a[108:111], v[72:87]
    ds_read_b128 v[124:127], v15 offset:63488
    s_waitcnt vmcnt(8)
    s_waitcnt lgkmcnt(4)
    v_mfma_f32_32x32x16_bf16 v[56:71], v[104:107], a[112:115], v[56:71]
    buffer_load_dwordx4 v2, s[24:27], s63 offen offset:1024 sc1 lds
    ds_read_b128 v[128:131], v15 offset:31744
    v_mfma_f32_32x32x16_bf16 v[72:87], v[108:111], a[112:115], v[72:87]
    ds_read_b128 v[132:135], v15 offset:64512
    s_waitcnt vmcnt(8)
    s_waitcnt lgkmcnt(4)
    v_mfma_f32_32x32x16_bf16 v[56:71], v[112:115], a[116:119], v[56:71]
    buffer_load_dwordx4 v2, s[24:27], s63 offen offset:2048 sc1 lds
    ds_read_b128 v[104:107], v18 offset:0
    v_mfma_f32_32x32x16_bf16 v[72:87], v[116:119], a[116:119], v[72:87]
    ds_read_b128 v[108:111], v18 offset:1024
    s_waitcnt vmcnt(8)
    s_waitcnt lgkmcnt(4)
    v_mfma_f32_32x32x16_bf16 v[56:71], v[120:123], a[120:123], v[56:71]
    buffer_load_dwordx4 v2, s[24:27], s63 offen offset:3072 sc1 lds
    ds_read_b128 v[112:115], v2 offset:0
    v_mfma_f32_32x32x16_bf16 v[72:87], v[124:127], a[120:123], v[72:87]
    ds_read_b128 v[116:119], v2 offset:1024
    s_waitcnt vmcnt(8)
    s_waitcnt lgkmcnt(4)
    v_mfma_f32_32x32x16_bf16 v[56:71], v[128:131], a[124:127], v[56:71]
    ds_read_b128 v[120:123], v2 offset:2048
    v_mfma_f32_32x32x16_bf16 v[72:87], v[132:135], a[124:127], v[72:87]
    ds_read_b128 v[124:127], v2 offset:3072
    s_waitcnt lgkmcnt(4)
    v_mfma_f32_32x32x16_bf16 v[56:71], v[104:107], v[136:139], v[56:71]
    ds_read_b128 v[128:131], v2 offset:4096
    v_mfma_f32_32x32x16_bf16 v[72:87], v[108:111], v[136:139], v[72:87]
    ds_read_b128 v[132:135], v2 offset:5120
    s_waitcnt lgkmcnt(4)
    v_mfma_f32_32x32x16_bf16 v[88:103], v[112:115], a[0:3], 0
    ds_read_b128 v[104:107], v2 offset:6144
    v_mfma_f32_32x32x16_bf16 v[88:103], v[116:119], a[4:7], v[88:103]
    ds_read_b128 v[108:111], v2 offset:7168
    s_cmp_lg_u32 s66, 1
    s_cbranch_scc1 L_w1_63
    s_mov_b64 exec, 1
    s_mov_b32 s90, 0
    s_waitcnt vmcnt(8)
    s_branch L_pollc_66
L_poll_64:
    v_mov_b32 v52, 0
    buffer_atomic_add v52, v51, s[24:27], 0 offen sc0 sc1
    s_waitcnt vmcnt(0)
L_pollc_66:
    v_cmp_ne_u32 vcc, 28, v52
    s_cbranch_vccz L_polld_65
    s_add_u32 s90, s90, 1
    s_cmp_lt_u32 s90, 0x4000
    s_cbranch_scc1 L_poll_64
    v_mov_b32 v52, 260
    buffer_store_dword v52, v55, s[48:51], 0 offen offset:4
L_polld_65:
    s_mov_b64 exec, -1
L_w1_63:
    s_barrier
    s_and_b32 s62, s67, 1
    s_cbranch_scc1 L_cq_67
    s_cmp_lg_u32 s66, 0
    s_cbranch_scc1 L_sig_68
    s_add_u32 s62, s68, 296
    s_lshl_b32 s62, s62, 7
    s_mov_b64 exec, 1
    buffer_atomic_add v54, v55, s[24:27], s62 offen sc1
    s_mov_b64 exec, -1
L_sig_68:
L_cq_67:
    s_waitcnt lgkmcnt(4)
    v_mfma_f32_32x32x16_bf16 v[88:103], v[120:123], a[8:11], v[88:103]
    s_add_u32 m0, s82, 65536
    s_add_u32 s63, s83, 131072
    buffer_load_dwordx4 v2, s[24:27], s63 offen offset:0 sc1 lds
    ds_read_b128 v[112:115], v2 offset:8192
    v_mfma_f32_32x32x16_bf16 v[88:103], v[124:127], a[12:15], v[88:103]
    ds_read_b128 v[116:119], v2 offset:9216
    v_mul_f32 v144, v56, v56
    v_mul_f32 v145, v57, v57
    v_mul_f32 v146, v58, v58
    v_mul_f32 v147, v59, v59
    v_fma_f32 v144, v144, v141, v140
    s_waitcnt lgkmcnt(4)
    v_mfma_f32_32x32x16_bf16 v[88:103], v[128:131], a[16:19], v[88:103]
    s_add_u32 s64, s84, 0
    buffer_load_dwordx4 a[128:131], v2, s[24:27], s64 offen offset:0 sc1
    ds_read_b128 v[120:123], v2 offset:10240
    v_fma_f32 v145, v145, v141, v140
    v_mfma_f32_32x32x16_bf16 v[88:103], v[132:135], a[20:23], v[88:103]
    ds_read_b128 v[124:127], v2 offset:11264
    v_fma_f32 v146, v146, v141, v140
    v_fma_f32 v147, v147, v141, v140
    v_mul_f32 v144, v144, v56
    v_mul_f32 v145, v145, v57
    v_mul_f32 v146, v146, v58
    s_waitcnt lgkmcnt(4)
    v_mfma_f32_32x32x16_bf16 v[88:103], v[104:107], a[24:27], v[88:103]
    buffer_load_dwordx4 v2, s[24:27], s63 offen offset:1024 sc1 lds
    ds_read_b128 v[128:131], v2 offset:12288
    v_mul_f32 v147, v147, v59
    v_exp_f32 v144, v144
    v_mfma_f32_32x32x16_bf16 v[88:103], v[108:111], a[28:31], v[88:103]
    ds_read_b128 v[132:135], v2 offset:13312
    v_mul_f32 v56, v56, v64
    v_exp_f32 v145, v145
    v_mul_f32 v57, v57, v65
    v_exp_f32 v146, v146
    s_waitcnt lgkmcnt(4)
    v_mfma_f32_32x32x16_bf16 v[88:103], v[112:115], a[32:35], v[88:103]
    buffer_load_dwordx4 a[132:135], v2, s[24:27], s64 offen offset:1024 sc1
    ds_read_b128 v[104:107], v2 offset:14336
    v_mul_f32 v58, v58, v66
    v_exp_f32 v147, v147
    v_mfma_f32_32x32x16_bf16 v[88:103], v[116:119], a[36:39], v[88:103]
    ds_read_b128 v[108:111], v2 offset:15360
    v_mul_f32 v59, v59, v67
    v_fma_f32 v144, v144, v142, v142
    v_fma_f32 v145, v145, v142, v142
    v_fma_f32 v146, v146, v142, v142
    v_fma_f32 v147, v147, v142, v142
    s_waitcnt lgkmcnt(4)
    v_mfma_f32_32x32x16_bf16 v[88:103], v[120:123], a[40:43], v[88:103]
    buffer_load_dwordx4 v2, s[24:27], s63 offen offset:2048 sc1 lds
    ds_read_b128 v[112:115], v2 offset:16384
    v_rcp_f32 v144, v144
    v_mfma_f32_32x32x16_bf16 v[88:103], v[124:127], a[44:47], v[88:103]
    ds_read_b128 v[116:119], v2 offset:17408
    v_rcp_f32 v145, v145
    v_rcp_f32 v146, v146
    v_rcp_f32 v147, v147
    s_waitcnt lgkmcnt(4)
    v_mfma_f32_32x32x16_bf16 v[88:103], v[128:131], a[48:51], v[88:103]
    buffer_load_dwordx4 a[136:139], v2, s[24:27], s64 offen offset:2048 sc1
    ds_read_b128 v[120:123], v2 offset:18432
    v_mul_f32 v56, v56, v144
    v_mul_f32 v57, v57, v145
    v_mfma_f32_32x32x16_bf16 v[88:103], v[132:135], a[52:55], v[88:103]
    ds_read_b128 v[124:127], v2 offset:19456
    v_mul_f32 v58, v58, v146
    v_mul_f32 v59, v59, v147
    v_cvt_pk_bf16_f32 v152, v56, v57
    v_cvt_pk_bf16_f32 v153, v58, v59
    v_mul_f32 v148, v60, v60
    s_waitcnt lgkmcnt(4)
    v_mfma_f32_32x32x16_bf16 v[88:103], v[104:107], a[56:59], v[88:103]
    buffer_load_dwordx4 v2, s[24:27], s63 offen offset:3072 sc1 lds
    ds_read_b128 v[128:131], v2 offset:20480
    v_mul_f32 v149, v61, v61
    v_mul_f32 v150, v62, v62
    v_mfma_f32_32x32x16_bf16 v[88:103], v[108:111], a[60:63], v[88:103]
    ds_read_b128 v[132:135], v2 offset:21504
    v_mul_f32 v151, v63, v63
    v_fma_f32 v148, v148, v141, v140
    v_fma_f32 v149, v149, v141, v140
    v_fma_f32 v150, v150, v141, v140
    v_fma_f32 v151, v151, v141, v140
    s_waitcnt lgkmcnt(4)
    v_mfma_f32_32x32x16_bf16 v[88:103], v[112:115], a[64:67], v[88:103]
    buffer_load_dwordx4 a[140:143], v2, s[24:27], s64 offen offset:3072 sc1
    ds_read_b128 v[104:107], v2 offset:22528
    v_mul_f32 v148, v148, v60
    v_mul_f32 v149, v149, v61
    v_mfma_f32_32x32x16_bf16 v[88:103], v[116:119], a[68:71], v[88:103]
    ds_read_b128 v[108:111], v2 offset:23552
    v_mul_f32 v150, v150, v62
    v_mul_f32 v151, v151, v63
    v_exp_f32 v148, v148
    v_mul_f32 v60, v60, v68
    s_waitcnt lgkmcnt(4)
    v_mfma_f32_32x32x16_bf16 v[88:103], v[120:123], a[72:75], v[88:103]
    s_add_u32 m0, s82, 69632
    s_add_u32 s63, s83, 135168
    buffer_load_dwordx4 v2, s[24:27], s63 offen offset:0 sc1 lds
    ds_read_b128 v[112:115], v2 offset:24576
    v_mfma_f32_32x32x16_bf16 v[88:103], v[124:127], a[76:79], v[88:103]
    ds_read_b128 v[116:119], v2 offset:25600
    v_exp_f32 v149, v149
    v_mul_f32 v61, v61, v69
    v_exp_f32 v150, v150
    s_waitcnt lgkmcnt(4)
    v_mfma_f32_32x32x16_bf16 v[88:103], v[128:131], a[80:83], v[88:103]
    buffer_load_dwordx4 v[156:159], v16, s[24:27], s64 offen offset:0 sc1
    ds_read_b128 v[120:123], v2 offset:26624
    v_mul_f32 v62, v62, v70
    v_exp_f32 v151, v151
    v_mfma_f32_32x32x16_bf16 v[88:103], v[132:135], a[84:87], v[88:103]
    ds_read_b128 v[124:127], v2 offset:27648
    v_mul_f32 v63, v63, v71
    v_fma_f32 v148, v148, v142, v142
    v_fma_f32 v149, v149, v142, v142
    v_fma_f32 v150, v150, v142, v142
    v_fma_f32 v151, v151, v142, v142
    s_waitcnt lgkmcnt(4)
    v_mfma_f32_32x32x16_bf16 v[88:103], v[104:107], a[88:91], v[88:103]
    buffer_load_dwordx4 v2, s[24:27], s63 offen offset:1024 sc1 lds
    ds_read_b128 v[128:131], v2 offset:28672
    v_rcp_f32 v148, v148
    v_mfma_f32_32x32x16_bf16 v[88:103], v[108:111], a[92:95], v[88:103]
    ds_read_b128 v[132:135], v2 offset:29696
    v_rcp_f32 v149, v149
    v_rcp_f32 v150, v150
    v_rcp_f32 v151, v151
    s_waitcnt vmcnt(11)
    s_barrier
    s_waitcnt lgkmcnt(4)
    v_mfma_f32_32x32x16_bf16 v[88:103], v[112:115], a[96:99], v[88:103]
    s_add_u32 s64, s84, 7168
    buffer_load_dwordx4 a[144:147], v2, s[24:27], s64 offen offset:0 sc1
    ds_read_b128 v[104:107], v2 offset:30720
    v_mul_f32 v60, v60, v148
    v_mul_f32 v61, v61, v149
    v_mul_f32 v62, v62, v150
    v_mfma_f32_32x32x16_bf16 v[88:103], v[116:119], a[100:103], v[88:103]
    ds_read_b128 v[108:111], v2 offset:31744
    v_mul_f32 v63, v63, v151
    v_cvt_pk_bf16_f32 v154, v60, v61
    v_cvt_pk_bf16_f32 v155, v62, v63
    buffer_store_dwordx4 v[152:155], v4, s[24:27], s87 offen offset:0 sc1
    s_waitcnt lgkmcnt(4)
    v_mfma_f32_32x32x16_bf16 v[88:103], v[120:123], a[104:107], v[88:103]
    buffer_load_dwordx4 v2, s[24:27], s63 offen offset:2048 sc1 lds
    ds_read_b128 v[112:115], v18 offset:2048
    v_mul_f32 v144, v72, v72
    v_mul_f32 v145, v73, v73
    v_mfma_f32_32x32x16_bf16 v[88:103], v[124:127], a[108:111], v[88:103]
    ds_read_b128 v[116:119], v2 offset:32768
    v_mul_f32 v146, v74, v74
    v_mul_f32 v147, v75, v75
    v_fma_f32 v144, v144, v141, v140
    v_fma_f32 v145, v145, v141, v140
    v_fma_f32 v146, v146, v141, v140
    s_waitcnt lgkmcnt(4)
    v_mfma_f32_32x32x16_bf16 v[88:103], v[128:131], a[112:115], v[88:103]
    buffer_load_dwordx4 a[148:151], v2, s[24:27], s64 offen offset:1024 sc1
    ds_read_b128 v[120:123], v2 offset:33792
    v_fma_f32 v147, v147, v141, v140
    v_mul_f32 v144, v144, v72
    v_mfma_f32_32x32x16_bf16 v[88:103], v[132:135], a[116:119], v[88:103]
    ds_read_b128 v[124:127], v2 offset:34816
    v_mul_f32 v145, v145, v73
    v_mul_f32 v146, v146, v74
    v_mul_f32 v147, v147, v75
    v_exp_f32 v144, v144
    s_waitcnt lgkmcnt(4)
    v_mfma_f32_32x32x16_bf16 v[88:103], v[104:107], a[120:123], v[88:103]
    buffer_load_dwordx4 v2, s[24:27], s63 offen offset:3072 sc1 lds
    ds_read_b128 v[128:131], v2 offset:35840
    v_mul_f32 v72, v72, v80
    v_exp_f32 v145, v145
    v_mfma_f32_32x32x16_bf16 v[88:103], v[108:111], a[124:127], v[88:103]
    ds_read_b128 v[132:135], v2 offset:36864
    v_mul_f32 v73, v73, v81
    v_exp_f32 v146, v146
    v_mul_f32 v74, v74, v82
    v_exp_f32 v147, v147
    s_waitcnt lgkmcnt(4)
    v_mfma_f32_32x32x16_bf16 v[88:103], v[112:115], v[136:139], v[88:103]
    buffer_load_dwordx4 a[152:155], v2, s[24:27], s64 offen offset:2048 sc1
    ds_read_b128 v[104:107], v2 offset:37888
    v_mul_f32 v75, v75, v83
    v_fma_f32 v144, v144, v142, v142
    v_mfma_f32_32x32x16_bf16 v[56:71], v[116:119], a[0:3], 0
    ds_read_b128 v[108:111], v2 offset:38912
    v_fma_f32 v145, v145, v142, v142
    v_fma_f32 v146, v146, v142, v142
    v_fma_f32 v147, v147, v142, v142
    v_rcp_f32 v144, v144
    s_waitcnt lgkmcnt(4)
    v_mfma_f32_32x32x16_bf16 v[56:71], v[120:123], a[4:7], v[56:71]
    buffer_load_dwordx4 a[156:159], v2, s[24:27], s64 offen offset:3072 sc1
    ds_read_b128 v[112:115], v2 offset:39936
    v_rcp_f32 v145, v145
    v_mfma_f32_32x32x16_bf16 v[56:71], v[124:127], a[8:11], v[56:71]
    ds_read_b128 v[116:119], v2 offset:40960
    v_rcp_f32 v146, v146
    v_rcp_f32 v147, v147
    v_mul_f32 v72, v72, v144
    s_waitcnt lgkmcnt(4)
    v_mfma_f32_32x32x16_bf16 v[56:71], v[128:131], a[12:15], v[56:71]
    buffer_load_dwordx4 v[160:163], v16, s[24:27], s64 offen offset:0 sc1
    ds_read_b128 v[120:123], v2 offset:41984
    v_mul_f32 v73, v73, v145
    v_mul_f32 v74, v74, v146
    v_mfma_f32_32x32x16_bf16 v[56:71], v[132:135], a[16:19], v[56:71]
    ds_read_b128 v[124:127], v2 offset:43008
    v_mul_f32 v75, v75, v147
    v_cvt_pk_bf16_f32 v152, v72, v73
    v_cvt_pk_bf16_f32 v153, v74, v75
    v_mul_f32 v148, v76, v76
    v_mul_f32 v149, v77, v77
    s_waitcnt lgkmcnt(4)
    v_mfma_f32_32x32x16_bf16 v[56:71], v[104:107], a[20:23], v[56:71]
    s_add_u32 m0, s82, 98304
    s_add_u32 s63, s83, 163840
    buffer_load_dwordx4 v2, s[24:27], s63 offen offset:0 sc1 lds
    ds_read_b128 v[128:131], v2 offset:44032
    v_mfma_f32_32x32x16_bf16 v[56:71], v[108:111], a[24:27], v[56:71]
    ds_read_b128 v[132:135], v2 offset:45056
    v_mul_f32 v150, v78, v78
    v_mul_f32 v151, v79, v79
    v_fma_f32 v148, v148, v141, v140
    v_fma_f32 v149, v149, v141, v140
    v_fma_f32 v150, v150, v141, v140
    s_waitcnt lgkmcnt(4)
    v_mfma_f32_32x32x16_bf16 v[56:71], v[112:115], a[28:31], v[56:71]
    s_add_u32 s64, s84, 14336
    buffer_load_dwordx4 a[160:163], v2, s[24:27], s64 offen offset:0 sc1
    ds_read_b128 v[104:107], v2 offset:46080
    v_fma_f32 v151, v151, v141, v140
    v_mfma_f32_32x32x16_bf16 v[56:71], v[116:119], a[32:35], v[56:71]
    ds_read_b128 v[108:111], v2 offset:47104
    v_mul_f32 v148, v148, v76
    v_mul_f32 v149, v149, v77
    v_mul_f32 v150, v150, v78
    v_mul_f32 v151, v151, v79
    v_exp_f32 v148, v148
    s_waitcnt lgkmcnt(4)
    v_mfma_f32_32x32x16_bf16 v[56:71], v[120:123], a[36:39], v[56:71]
    buffer_load_dwordx4 v2, s[24:27], s63 offen offset:1024 sc1 lds
    ds_read_b128 v[112:115], v2 offset:48128
    v_mul_f32 v76, v76, v84
    v_exp_f32 v149, v149
    s_cmp_lg_u32 s66, 1
    s_cbranch_scc1 L_w1_69
    s_add_u32 s62, s68, 296
    s_lshl_b32 s62, s62, 7
    v_mov_b32 v51, s62
    s_mov_b64 exec, 1
    v_mov_b32 v52, 0
    buffer_atomic_add v52, v51, s[24:27], 0 offen sc0 sc1
    s_mov_b64 exec, -1
L_w1_69:
    v_mfma_f32_32x32x16_bf16 v[56:71], v[124:127], a[40:43], v[56:71]
    ds_read_b128 v[116:119], v2 offset:49152
    v_mul_f32 v77, v77, v85
    v_exp_f32 v150, v150
    v_mul_f32 v78, v78, v86
    v_exp_f32 v151, v151
    s_waitcnt lgkmcnt(4)
    v_mfma_f32_32x32x16_bf16 v[56:71], v[128:131], a[44:47], v[56:71]
    buffer_load_dwordx4 a[164:167], v2, s[24:27], s64 offen offset:1024 sc1
    ds_read_b128 v[120:123], v2 offset:50176
    v_mul_f32 v79, v79, v87
    v_fma_f32 v148, v148, v142, v142
    v_mfma_f32_32x32x16_bf16 v[56:71], v[132:135], a[48:51], v[56:71]
    ds_read_b128 v[124:127], v2 offset:51200
    v_fma_f32 v149, v149, v142, v142
    v_fma_f32 v150, v150, v142, v142
    v_fma_f32 v151, v151, v142, v142
    v_rcp_f32 v148, v148
    s_waitcnt lgkmcnt(4)
    v_mfma_f32_32x32x16_bf16 v[56:71], v[104:107], a[52:55], v[56:71]
    buffer_load_dwordx4 v2, s[24:27], s63 offen offset:2048 sc1 lds
    ds_read_b128 v[128:131], v2 offset:52224
    v_rcp_f32 v149, v149
    v_mfma_f32_32x32x16_bf16 v[56:71], v[108:111], a[56:59], v[56:71]
    ds_read_b128 v[132:135], v2 offset:53248
    v_rcp_f32 v150, v150
    v_rcp_f32 v151, v151
    v_mul_f32 v76, v76, v148
    s_waitcnt lgkmcnt(4)
    v_mfma_f32_32x32x16_bf16 v[56:71], v[112:115], a[60:63], v[56:71]
    buffer_load_dwordx4 a[168:171], v2, s[24:27], s64 offen offset:2048 sc1
    ds_read_b128 v[104:107], v2 offset:54272
    v_mul_f32 v77, v77, v149
    v_mul_f32 v78, v78, v150
    v_mfma_f32_32x32x16_bf16 v[56:71], v[116:119], a[64:67], v[56:71]
    ds_read_b128 v[108:111], v2 offset:55296
    v_mul_f32 v79, v79, v151
    v_cvt_pk_bf16_f32 v154, v76, v77
    v_cvt_pk_bf16_f32 v155, v78, v79
    buffer_store_dwordx4 v[152:155], v4, s[24:27], s87 offen offset:512 sc1
    s_waitcnt lgkmcnt(4)
    v_mfma_f32_32x32x16_bf16 v[56:71], v[120:123], a[68:71], v[56:71]
    buffer_load_dwordx4 v2, s[24:27], s63 offen offset:3072 sc1 lds
    ds_read_b128 v[112:115], v2 offset:56320
    v_mul_f32 v144, v88, v88
    v_mul_f32 v145, v89, v89
    v_mfma_f32_32x32x16_bf16 v[56:71], v[124:127], a[72:75], v[56:71]
    ds_read_b128 v[116:119], v2 offset:57344
    v_mul_f32 v146, v90, v90
    v_mul_f32 v147, v91, v91
    v_fma_f32 v144, v144, v141, v140
    v_fma_f32 v145, v145, v141, v140
    v_fma_f32 v146, v146, v141, v140
    s_waitcnt lgkmcnt(4)
    v_mfma_f32_32x32x16_bf16 v[56:71], v[128:131], a[76:79], v[56:71]
    buffer_load_dwordx4 a[172:175], v2, s[24:27], s64 offen offset:3072 sc1
    ds_read_b128 v[120:123], v2 offset:58368
    v_fma_f32 v147, v147, v141, v140
    v_mul_f32 v144, v144, v88
    v_mfma_f32_32x32x16_bf16 v[56:71], v[132:135], a[80:83], v[56:71]
    ds_read_b128 v[124:127], v2 offset:59392
    v_mul_f32 v145, v145, v89
    v_mul_f32 v146, v146, v90
    v_mul_f32 v147, v147, v91
    v_exp_f32 v144, v144
    s_waitcnt lgkmcnt(4)
    v_mfma_f32_32x32x16_bf16 v[56:71], v[104:107], a[84:87], v[56:71]
    s_add_u32 m0, s82, 102400
    s_add_u32 s63, s83, 167936
    buffer_load_dwordx4 v2, s[24:27], s63 offen offset:0 sc1 lds
    ds_read_b128 v[128:131], v2 offset:60416
    v_mfma_f32_32x32x16_bf16 v[56:71], v[108:111], a[88:91], v[56:71]
    ds_read_b128 v[132:135], v2 offset:61440
    v_mul_f32 v88, v88, v96
    v_exp_f32 v145, v145
    v_mul_f32 v89, v89, v97
    v_exp_f32 v146, v146
    s_waitcnt lgkmcnt(4)
    v_mfma_f32_32x32x16_bf16 v[56:71], v[112:115], a[92:95], v[56:71]
    buffer_load_dwordx4 v[164:167], v16, s[24:27], s64 offen offset:0 sc1
    ds_read_b128 v[104:107], v2 offset:62464
    v_mul_f32 v90, v90, v98
    v_exp_f32 v147, v147
    s_waitcnt vmcnt(14)
    s_cmp_lg_u32 s66, 1
    s_cbranch_scc1 L_w1_70
    s_mov_b64 exec, 1
    s_mov_b32 s90, 0
    s_waitcnt vmcnt(8)
    s_branch L_pollc_73
L_poll_71:
    v_mov_b32 v52, 0
    buffer_atomic_add v52, v51, s[24:27], 0 offen sc0 sc1
    s_waitcnt vmcnt(0)
L_pollc_73:
    v_cmp_ne_u32 vcc, 16, v52
    s_cbranch_vccz L_polld_72
    s_add_u32 s90, s90, 1
    s_cmp_lt_u32 s90, 0x4000
    s_cbranch_scc1 L_poll_71
    v_mov_b32 v52, 263
    buffer_store_dword v52, v55, s[48:51], 0 offen offset:4
L_polld_72:
    s_mov_b64 exec, -1
L_w1_70:
    s_barrier
    v_mfma_f32_32x32x16_bf16 v[56:71], v[116:119], a[96:99], v[56:71]
    ds_read_b128 v[108:111], v2 offset:63488
    v_mul_f32 v91, v91, v99
    v_fma_f32 v144, v144, v142, v142
    v_fma_f32 v145, v145, v142, v142
    v_fma_f32 v146, v146, v142, v142
    v_fma_f32 v147, v147, v142, v142
    s_waitcnt lgkmcnt(4)
    v_mfma_f32_32x32x16_bf16 v[56:71], v[120:123], a[100:103], v[56:71]
    buffer_load_dwordx4 v2, s[24:27], s63 offen offset:1024 sc1 lds
    ds_read_b128 v[112:115], v2 offset:64512
    v_rcp_f32 v144, v144
    v_mfma_f32_32x32x16_bf16 v[56:71], v[124:127], a[104:107], v[56:71]
    ds_read_b128 v[116:119], v18 offset:3072
    v_rcp_f32 v145, v145
    v_rcp_f32 v146, v146
    v_rcp_f32 v147, v147
    s_waitcnt lgkmcnt(4)
    v_mfma_f32_32x32x16_bf16 v[56:71], v[128:131], a[108:111], v[56:71]
    s_add_u32 s64, s84, 21504
    buffer_load_dwordx4 a[176:179], v2, s[24:27], s64 offen offset:0 sc1
    ds_read_b128 v[120:123], v15 offset:0
    v_mul_f32 v88, v88, v144
    v_mfma_f32_32x32x16_bf16 v[56:71], v[132:135], a[112:115], v[56:71]
    ds_read_b128 v[124:127], v15 offset:1024
    v_mul_f32 v89, v89, v145
    v_mul_f32 v90, v90, v146
    v_mul_f32 v91, v91, v147
    v_cvt_pk_bf16_f32 v152, v88, v89
    v_cvt_pk_bf16_f32 v153, v90, v91
    s_waitcnt lgkmcnt(4)
    v_mfma_f32_32x32x16_bf16 v[56:71], v[104:107], a[116:119], v[56:71]
    buffer_load_dwordx4 v2, s[24:27], s63 offen offset:2048 sc1 lds
    ds_read_b128 v[128:131], v15 offset:2048
    v_mul_f32 v148, v92, v92
    v_mul_f32 v149, v93, v93
    v_mfma_f32_32x32x16_bf16 v[56:71], v[108:111], a[120:123], v[56:71]
    ds_read_b128 v[132:135], v15 offset:3072
    v_mul_f32 v150, v94, v94
    v_mul_f32 v151, v95, v95
    v_fma_f32 v148, v148, v141, v140
    v_fma_f32 v149, v149, v141, v140
    v_fma_f32 v150, v150, v141, v140
    s_waitcnt lgkmcnt(4)
    v_mfma_f32_32x32x16_bf16 v[56:71], v[112:115], a[124:127], v[56:71]
    buffer_load_dwordx4 a[180:183], v2, s[24:27], s64 offen offset:1024 sc1
    ds_read_b128 v[104:107], v15 offset:4096
    v_fma_f32 v151, v151, v141, v140
    v_mul_f32 v148, v148, v92
    v_mfma_f32_32x32x16_bf16 v[56:71], v[116:119], v[136:139], v[56:71]
    ds_read_b128 v[108:111], v15 offset:5120
    v_mul_f32 v149, v149, v93
    v_mul_f32 v150, v150, v94
    v_mul_f32 v151, v151, v95
    v_exp_f32 v148, v148
    s_waitcnt lgkmcnt(4)
    v_mfma_f32_32x32x16_bf16 v[72:87], v[120:123], a[0:3], 0
    buffer_load_dwordx4 v2, s[24:27], s63 offen offset:3072 sc1 lds
    ds_read_b128 v[112:115], v15 offset:6144
    v_mul_f32 v92, v92, v100
    v_exp_f32 v149, v149
    v_mfma_f32_32x32x16_bf16 v[72:87], v[124:127], a[4:7], v[72:87]
    ds_read_b128 v[116:119], v15 offset:7168
    v_mul_f32 v93, v93, v101
    v_exp_f32 v150, v150
    v_mul_f32 v94, v94, v102
    v_exp_f32 v151, v151
    s_waitcnt lgkmcnt(4)
    v_mfma_f32_32x32x16_bf16 v[72:87], v[128:131], a[8:11], v[72:87]
    buffer_load_dwordx4 a[184:187], v2, s[24:27], s64 offen offset:2048 sc1
    ds_read_b128 v[120:123], v15 offset:8192
    v_mul_f32 v95, v95, v103
    v_fma_f32 v148, v148, v142, v142
    v_mfma_f32_32x32x16_bf16 v[72:87], v[132:135], a[12:15], v[72:87]
    ds_read_b128 v[124:127], v15 offset:9216
    v_fma_f32 v149, v149, v142, v142
    v_fma_f32 v150, v150, v142, v142
    v_fma_f32 v151, v151, v142, v142
    v_rcp_f32 v148, v148
    s_waitcnt lgkmcnt(4)
    v_mfma_f32_32x32x16_bf16 v[72:87], v[104:107], a[16:19], v[72:87]
    s_add_u32 m0, s82, 0
    s_add_u32 s63, s83, 196608
    buffer_load_dwordx4 v2, s[24:27], s63 offen offset:0 sc1 lds
    ds_read_b128 v[128:131], v15 offset:10240
    v_mfma_f32_32x32x16_bf16 v[72:87], v[108:111], a[20:23], v[72:87]
    ds_read_b128 v[132:135], v15 offset:11264
    v_rcp_f32 v149, v149
    v_rcp_f32 v150, v150
    v_rcp_f32 v151, v151
    s_waitcnt vmcnt(11)
    s_barrier
    s_cmp_lg_u32 s66, 0
    s_cbranch_scc1 L_sig_74
    s_mov_b64 exec, 0xffff
    v_mov_b32 v52, 0x1
    buffer_atomic_add v52, v7, s[24:27], 0 offen offset:4 sc1
    s_mov_b64 exec, -1
L_sig_74:
    s_waitcnt lgkmcnt(4)
    v_mfma_f32_32x32x16_bf16 v[72:87], v[112:115], a[24:27], v[72:87]
    buffer_load_dwordx4 a[188:191], v2, s[24:27], s64 offen offset:3072 sc1
    ds_read_b128 v[104:107], v15 offset:12288
    v_mul_f32 v92, v92, v148
    v_mul_f32 v93, v93, v149
    v_mfma_f32_32x32x16_bf16 v[72:87], v[116:119], a[28:31], v[72:87]
    ds_read_b128 v[108:111], v15 offset:13312
    v_mul_f32 v94, v94, v150
    v_mul_f32 v95, v95, v151
    v_cvt_pk_bf16_f32 v154, v92, v93
    v_cvt_pk_bf16_f32 v155, v94, v95
    buffer_store_dwordx4 v[152:155], v4, s[24:27], s87 offen offset:1024 sc1
    s_waitcnt lgkmcnt(4)
    v_mfma_f32_32x32x16_bf16 v[72:87], v[120:123], a[32:35], v[72:87]
    buffer_load_dwordx4 v2, s[24:27], s63 offen offset:1024 sc1 lds
    ds_read_b128 v[112:115], v15 offset:14336
    v_mul_f32 v144, v56, v56
    v_mul_f32 v145, v57, v57
    v_mfma_f32_32x32x16_bf16 v[72:87], v[124:127], a[36:39], v[72:87]
    ds_read_b128 v[116:119], v15 offset:15360
    v_mul_f32 v146, v58, v58
    v_mul_f32 v147, v59, v59
    v_fma_f32 v144, v144, v141, v140
    v_fma_f32 v145, v145, v141, v140
    v_fma_f32 v146, v146, v141, v140
    s_waitcnt lgkmcnt(4)
    v_mfma_f32_32x32x16_bf16 v[72:87], v[128:131], a[40:43], v[72:87]
    buffer_load_dwordx4 v[168:171], v16, s[24:27], s64 offen offset:0 sc1
    ds_read_b128 v[120:123], v15 offset:16384
    v_fma_f32 v147, v147, v141, v140
    v_mul_f32 v144, v144, v56
    v_mfma_f32_32x32x16_bf16 v[72:87], v[132:135], a[44:47], v[72:87]
    ds_read_b128 v[124:127], v15 offset:17408
    v_mul_f32 v145, v145, v57
    v_mul_f32 v146, v146, v58
    v_mul_f32 v147, v147, v59
    v_exp_f32 v144, v144
    s_waitcnt lgkmcnt(4)
    v_mfma_f32_32x32x16_bf16 v[72:87], v[104:107], a[48:51], v[72:87]
    buffer_load_dwordx4 v2, s[24:27], s63 offen offset:2048 sc1 lds
    ds_read_b128 v[128:131], v15 offset:18432
    v_mul_f32 v56, v56, v64
    v_exp_f32 v145, v145
    v_mfma_f32_32x32x16_bf16 v[72:87], v[108:111], a[52:55], v[72:87]
    ds_read_b128 v[132:135], v15 offset:19456
    v_mul_f32 v57, v57, v65
    v_exp_f32 v146, v146
    v_mul_f32 v58, v58, v66
    v_exp_f32 v147, v147
    s_waitcnt lgkmcnt(4)
    v_mfma_f32_32x32x16_bf16 v[72:87], v[112:115], a[56:59], v[72:87]
    s_add_u32 s64, s84, 28672
    buffer_load_dwordx4 a[192:195], v2, s[24:27], s64 offen offset:0 sc1
    ds_read_b128 v[104:107], v15 offset:20480
    v_mul_f32 v59, v59, v67
    v_mfma_f32_32x32x16_bf16 v[72:87], v[116:119], a[60:63], v[72:87]
    ds_read_b128 v[108:111], v15 offset:21504
    v_fma_f32 v144, v144, v142, v142
    v_fma_f32 v145, v145, v142, v142
    v_fma_f32 v146, v146, v142, v142
    v_fma_f32 v147, v147, v142, v142
    v_rcp_f32 v144, v144
    s_waitcnt lgkmcnt(4)
    v_mfma_f32_32x32x16_bf16 v[72:87], v[120:123], a[64:67], v[72:87]
    buffer_load_dwordx4 v2, s[24:27], s63 offen offset:3072 sc1 lds
    ds_read_b128 v[112:115], v15 offset:22528
    v_rcp_f32 v145, v145
    v_mfma_f32_32x32x16_bf16 v[72:87], v[124:127], a[68:71], v[72:87]
    ds_read_b128 v[116:119], v15 offset:23552
    v_rcp_f32 v146, v146
    v_rcp_f32 v147, v147
    v_mul_f32 v56, v56, v144
    s_waitcnt lgkmcnt(4)
    v_mfma_f32_32x32x16_bf16 v[72:87], v[128:131], a[72:75], v[72:87]
    buffer_load_dwordx4 a[196:199], v2, s[24:27], s64 offen offset:1024 sc1
    ds_read_b128 v[120:123], v15 offset:24576
    v_mul_f32 v57, v57, v145
    v_mul_f32 v58, v58, v146
    v_mfma_f32_32x32x16_bf16 v[72:87], v[132:135], a[76:79], v[72:87]
    ds_read_b128 v[124:127], v15 offset:25600
    v_mul_f32 v59, v59, v147
    v_cvt_pk_bf16_f32 v152, v56, v57
    v_cvt_pk_bf16_f32 v153, v58, v59
    v_mul_f32 v148, v60, v60
    v_mul_f32 v149, v61, v61
    s_waitcnt lgkmcnt(4)
    v_mfma_f32_32x32x16_bf16 v[72:87], v[104:107], a[80:83], v[72:87]
    s_add_u32 m0, s82, 4096
    s_add_u32 s63, s83, 200704
    buffer_load_dwordx4 v2, s[24:27], s63 offen offset:0 sc1 lds
    ds_read_b128 v[128:131], v15 offset:26624
    v_mfma_f32_32x32x16_bf16 v[72:87], v[108:111], a[84:87], v[72:87]
    ds_read_b128 v[132:135], v15 offset:27648
    v_mul_f32 v150, v62, v62
    v_mul_f32 v151, v63, v63
    v_fma_f32 v148, v148, v141, v140
    v_fma_f32 v149, v149, v141, v140
    v_fma_f32 v150, v150, v141, v140
    s_waitcnt lgkmcnt(4)
    v_mfma_f32_32x32x16_bf16 v[72:87], v[112:115], a[88:91], v[72:87]
    buffer_load_dwordx4 a[200:203], v2, s[24:27], s64 offen offset:2048 sc1
    ds_read_b128 v[104:107], v15 offset:28672
    v_fma_f32 v151, v151, v141, v140
    v_mul_f32 v148, v148, v60
    v_mfma_f32_32x32x16_bf16 v[72:87], v[116:119], a[92:95], v[72:87]
    ds_read_b128 v[108:111], v15 offset:29696
    v_mul_f32 v149, v149, v61
    v_mul_f32 v150, v150, v62
    v_mul_f32 v151, v151, v63
    v_exp_f32 v148, v148
    s_waitcnt vmcnt(12)
    s_barrier
    s_waitcnt lgkmcnt(4)
    v_mfma_f32_32x32x16_bf16 v[72:87], v[120:123], a[96:99], v[72:87]
    buffer_load_dwordx4 v2, s[24:27], s63 offen offset:1024 sc1 lds
    ds_read_b128 v[112:115], v15 offset:30720
    v_mul_f32 v60, v60, v68
    v_exp_f32 v149, v149
    v_mfma_f32_32x32x16_bf16 v[72:87], v[124:127], a[100:103], v[72:87]
    ds_read_b128 v[116:119], v15 offset:31744
    v_mul_f32 v61, v61, v69
    v_exp_f32 v150, v150
    v_mul_f32 v62, v62, v70
    v_exp_f32 v151, v151
    s_waitcnt lgkmcnt(4)
    v_mfma_f32_32x32x16_bf16 v[72:87], v[128:131], a[104:107], v[72:87]
    buffer_load_dwordx4 a[204:207], v2, s[24:27], s64 offen offset:3072 sc1
    ds_read_b128 v[120:123], v18 offset:4096
    v_mul_f32 v63, v63, v71
    v_fma_f32 v148, v148, v142, v142
    v_mfma_f32_32x32x16_bf16 v[72:87], v[132:135], a[108:111], v[72:87]
    ds_read_b128 v[124:127], v15 offset:32768
    v_fma_f32 v149, v149, v142, v142
    v_fma_f32 v150, v150, v142, v142
    v_fma_f32 v151, v151, v142, v142
    v_rcp_f32 v148, v148
    s_waitcnt lgkmcnt(4)
    v_mfma_f32_32x32x16_bf16 v[72:87], v[104:107], a[112:115], v[72:87]
    buffer_load_dwordx4 v2, s[24:27], s63 offen offset:2048 sc1 lds
    ds_read_b128 v[128:131], v15 offset:33792
    v_rcp_f32 v149, v149
    v_mfma_f32_32x32x16_bf16 v[72:87], v[108:111], a[116:119], v[72:87]
    ds_read_b128 v[132:135], v15 offset:34816
    v_rcp_f32 v150, v150
    v_rcp_f32 v151, v151
    v_mul_f32 v60, v60, v148
    s_waitcnt lgkmcnt(4)
    v_mfma_f32_32x32x16_bf16 v[72:87], v[112:115], a[120:123], v[72:87]
    buffer_load_dwordx4 v[172:175], v16, s[24:27], s64 offen offset:0 sc1
    ds_read_b128 v[104:107], v15 offset:35840
    v_mul_f32 v61, v61, v149
    v_mul_f32 v62, v62, v150
    v_mfma_f32_32x32x16_bf16 v[72:87], v[116:119], a[124:127], v[72:87]
    ds_read_b128 v[108:111], v15 offset:36864
    v_mul_f32 v63, v63, v151
    v_cvt_pk_bf16_f32 v154, v60, v61
    v_cvt_pk_bf16_f32 v155, v62, v63
    buffer_store_dwordx4 v[152:155], v4, s[24:27], s87 offen offset:1536 sc1
    s_waitcnt lgkmcnt(4)
    v_mfma_f32_32x32x16_bf16 v[72:87], v[120:123], v[136:139], v[72:87]
    buffer_load_dwordx4 v2, s[24:27], s63 offen offset:3072 sc1 lds
    ds_read_b128 v[112:115], v15 offset:37888
    v_mfma_f32_32x32x16_bf16 v[88:103], v[124:127], a[0:3], 0
    ds_read_b128 v[116:119], v15 offset:38912
    s_waitcnt lgkmcnt(4)
    v_mfma_f32_32x32x16_bf16 v[88:103], v[128:131], a[4:7], v[88:103]
    s_add_u32 s64, s84, 35840
    buffer_load_dwordx4 a[208:211], v2, s[24:27], s64 offen offset:0 sc1
    ds_read_b128 v[120:123], v15 offset:39936
    s_cmp_lg_u32 s66, 1
    s_cbranch_scc1 L_w1_75
    s_add_u32 s62, s86, 4
    v_mov_b32 v51, s62
    s_mov_b64 exec, 1
    v_mov_b32 v52, 0
    buffer_atomic_add v52, v51, s[24:27], 0 offen sc0 sc1
    s_mov_b64 exec, -1
L_w1_75:
    v_mfma_f32_32x32x16_bf16 v[88:103], v[132:135], a[8:11], v[88:103]
    ds_read_b128 v[124:127], v15 offset:40960
    s_waitcnt lgkmcnt(4)
    v_mfma_f32_32x32x16_bf16 v[88:103], v[104:107], a[12:15], v[88:103]
    buffer_load_dwordx4 a[212:215], v2, s[24:27], s64 offen offset:1024 sc1
    ds_read_b128 v[128:131], v15 offset:41984
    v_mfma_f32_32x32x16_bf16 v[88:103], v[108:111], a[16:19], v[88:103]
    ds_read_b128 v[132:135], v15 offset:43008
    v_mul_f32 v144, v72, v72
    v_mul_f32 v145, v73, v73
    v_mul_f32 v146, v74, v74
    v_mul_f32 v147, v75, v75
    v_fma_f32 v144, v144, v141, v140
    s_waitcnt lgkmcnt(4)
    v_mfma_f32_32x32x16_bf16 v[88:103], v[112:115], a[20:23], v[88:103]
    buffer_load_dwordx4 a[216:219], v2, s[24:27], s64 offen offset:2048 sc1
    ds_read_b128 v[104:107], v15 offset:44032
    v_fma_f32 v145, v145, v141, v140
    v_fma_f32 v146, v146, v141, v140
    v_mfma_f32_32x32x16_bf16 v[88:103], v[116:119], a[24:27], v[88:103]
    ds_read_b128 v[108:111], v15 offset:45056
    v_fma_f32 v147, v147, v141, v140
    v_mul_f32 v144, v144, v72
    v_mul_f32 v145, v145, v73
    v_mul_f32 v146, v146, v74
    v_mul_f32 v147, v147, v75
    s_waitcnt lgkmcnt(4)
    v_mfma_f32_32x32x16_bf16 v[88:103], v[120:123], a[28:31], v[88:103]
    buffer_load_dwordx4 a[220:223], v2, s[24:27], s64 offen offset:3072 sc1
    ds_read_b128 v[112:115], v15 offset:46080
    v_exp_f32 v144, v144
    v_mfma_f32_32x32x16_bf16 v[88:103], v[124:127], a[32:35], v[88:103]
    ds_read_b128 v[116:119], v15 offset:47104
    v_mul_f32 v72, v72, v80
    v_exp_f32 v145, v145
    v_mul_f32 v73, v73, v81
    v_exp_f32 v146, v146
    s_waitcnt lgkmcnt(4)
    v_mfma_f32_32x32x16_bf16 v[88:103], v[128:131], a[36:39], v[88:103]
    buffer_load_dwordx4 v[176:179], v16, s[24:27], s64 offen offset:0 sc1
    ds_read_b128 v[120:123], v15 offset:48128
    v_mul_f32 v74, v74, v82
    v_exp_f32 v147, v147
    v_mfma_f32_32x32x16_bf16 v[88:103], v[132:135], a[40:43], v[88:103]
    ds_read_b128 v[124:127], v15 offset:49152
    v_mul_f32 v75, v75, v83
    v_fma_f32 v144, v144, v142, v142
    v_fma_f32 v145, v145, v142, v142
    v_fma_f32 v146, v146, v142, v142
    v_fma_f32 v147, v147, v142, v142
    s_waitcnt lgkmcnt(4)
    v_mfma_f32_32x32x16_bf16 v[88:103], v[104:107], a[44:47], v[88:103]
    s_add_u32 s64, s84, 43008
    buffer_load_dwordx4 a[224:227], v2, s[24:27], s64 offen offset:0 sc1
    ds_read_b128 v[128:131], v15 offset:50176
    v_rcp_f32 v144, v144
    v_mfma_f32_32x32x16_bf16 v[88:103], v[108:111], a[48:51], v[88:103]
    ds_read_b128 v[132:135], v15 offset:51200
    v_rcp_f32 v145, v145
    v_rcp_f32 v146, v146
    v_rcp_f32 v147, v147
    s_waitcnt lgkmcnt(4)
    v_mfma_f32_32x32x16_bf16 v[88:103], v[112:115], a[52:55], v[88:103]
    buffer_load_dwordx4 a[228:231], v2, s[24:27], s64 offen offset:1024 sc1
    ds_read_b128 v[104:107], v15 offset:52224
    v_mul_f32 v72, v72, v144
    v_mul_f32 v73, v73, v145
    v_mul_f32 v74, v74, v146
    v_mfma_f32_32x32x16_bf16 v[88:103], v[116:119], a[56:59], v[88:103]
    ds_read_b128 v[108:111], v15 offset:53248
    v_mul_f32 v75, v75, v147
    v_cvt_pk_bf16_f32 v152, v72, v73
    v_cvt_pk_bf16_f32 v153, v74, v75
    v_mul_f32 v148, v76, v76
    v_mul_f32 v149, v77, v77
    s_waitcnt lgkmcnt(4)
    v_mfma_f32_32x32x16_bf16 v[88:103], v[120:123], a[60:63], v[88:103]
    buffer_load_dwordx4 a[232:235], v2, s[24:27], s64 offen offset:2048 sc1
    ds_read_b128 v[112:115], v15 offset:54272
    v_mul_f32 v150, v78, v78
    v_mul_f32 v151, v79, v79
    v_mfma_f32_32x32x16_bf16 v[88:103], v[124:127], a[64:67], v[88:103]
    ds_read_b128 v[116:119], v15 offset:55296
    v_fma_f32 v148, v148, v141, v140
    v_fma_f32 v149, v149, v141, v140
    v_fma_f32 v150, v150, v141, v140
    v_fma_f32 v151, v151, v141, v140
    v_mul_f32 v148, v148, v76
    s_waitcnt lgkmcnt(4)
    v_mfma_f32_32x32x16_bf16 v[88:103], v[128:131], a[68:71], v[88:103]
    buffer_load_dwordx4 a[236:239], v2, s[24:27], s64 offen offset:3072 sc1
    ds_read_b128 v[120:123], v15 offset:56320
    v_mul_f32 v149, v149, v77
    v_mul_f32 v150, v150, v78
    v_mfma_f32_32x32x16_bf16 v[88:103], v[132:135], a[72:75], v[88:103]
    ds_read_b128 v[124:127], v15 offset:57344
    v_mul_f32 v151, v151, v79
    v_exp_f32 v148, v148
    v_mul_f32 v76, v76, v84
    v_exp_f32 v149, v149
    s_waitcnt lgkmcnt(4)
    v_mfma_f32_32x32x16_bf16 v[88:103], v[104:107], a[76:79], v[88:103]
    buffer_load_dwordx4 v[180:183], v16, s[24:27], s64 offen offset:0 sc1
    ds_read_b128 v[128:131], v15 offset:58368
    v_mul_f32 v77, v77, v85
    v_exp_f32 v150, v150
    v_mfma_f32_32x32x16_bf16 v[88:103], v[108:111], a[80:83], v[88:103]
    ds_read_b128 v[132:135], v15 offset:59392
    v_mul_f32 v78, v78, v86
    v_exp_f32 v151, v151
    v_mul_f32 v79, v79, v87
    v_fma_f32 v148, v148, v142, v142
    s_waitcnt lgkmcnt(4)
    v_mfma_f32_32x32x16_bf16 v[88:103], v[112:115], a[84:87], v[88:103]
    s_add_u32 s64, s84, 50176
    buffer_load_dwordx4 a[240:243], v2, s[24:27], s64 offen offset:0 sc1
    ds_read_b128 v[104:107], v15 offset:60416
    v_fma_f32 v149, v149, v142, v142
    v_fma_f32 v150, v150, v142, v142
    v_fma_f32 v151, v151, v142, v142
    v_mfma_f32_32x32x16_bf16 v[88:103], v[116:119], a[88:91], v[88:103]
    ds_read_b128 v[108:111], v15 offset:61440
    v_rcp_f32 v148, v148
    v_rcp_f32 v149, v149
    v_rcp_f32 v150, v150
    v_rcp_f32 v151, v151
    s_waitcnt lgkmcnt(4)
    v_mfma_f32_32x32x16_bf16 v[88:103], v[120:123], a[92:95], v[88:103]
    buffer_load_dwordx4 a[244:247], v2, s[24:27], s64 offen offset:1024 sc1
    ds_read_b128 v[112:115], v15 offset:62464
    v_mul_f32 v76, v76, v148
    v_mul_f32 v77, v77, v149
    v_mul_f32 v78, v78, v150
    s_waitcnt vmcnt(12)
    s_cmp_lg_u32 s66, 1
    s_cbranch_scc1 L_w1_76
    s_mov_b64 exec, 1
    s_mov_b32 s90, 0
    s_waitcnt vmcnt(11)
    s_branch L_pollc_79
L_poll_77:
    v_mov_b32 v52, 0
    buffer_atomic_add v52, v51, s[24:27], 0 offen sc0 sc1
    s_waitcnt vmcnt(0)
L_pollc_79:
    v_bfe_u32 v52, v52, 0, 6
    v_cmp_ne_u32 vcc, 16, v52
    s_cbranch_vccz L_polld_78
    s_add_u32 s90, s90, 1
    s_cmp_lt_u32 s90, 0x4000
    s_cbranch_scc1 L_poll_77
    v_mov_b32 v52, 272
    buffer_store_dword v52, v55, s[48:51], 0 offen offset:4
L_polld_78:
    s_mov_b64 exec, -1
L_w1_76:
    s_barrier
    s_cmp_lg_u32 s66, 0
    s_cbranch_scc1 L_sig_80
    s_mov_b64 exec, 0xffff
    v_mov_b32 v52, 0x40
    buffer_atomic_add v52, v7, s[24:27], 0 offen offset:4 sc1
    s_mov_b64 exec, -1
L_sig_80:
    v_mfma_f32_32x32x16_bf16 v[88:103], v[124:127], a[96:99], v[88:103]
    ds_read_b128 v[116:119], v15 offset:63488
    v_mul_f32 v79, v79, v151
    v_cvt_pk_bf16_f32 v154, v76, v77
    v_cvt_pk_bf16_f32 v155, v78, v79
    buffer_store_dwordx4 v[152:155], v4, s[24:27], s87 offen offset:2048 sc1
    s_waitcnt lgkmcnt(4)
    v_mfma_f32_32x32x16_bf16 v[88:103], v[128:131], a[100:103], v[88:103]
    v_add_u32 v254, 0, v4
    s_add_u32 m0, s85, 32768
    ds_read_b128 v[120:123], v15 offset:64512
    buffer_load_dwordx4 v254, s[24:27], s8 offen sc1 lds
    v_mfma_f32_32x32x16_bf16 v[88:103], v[132:135], a[104:107], v[88:103]
    ds_read_b128 v[124:127], v18 offset:5120
    s_waitcnt lgkmcnt(4)
    v_mfma_f32_32x32x16_bf16 v[88:103], v[104:107], a[108:111], v[88:103]
    s_add_u32 m0, s85, 34816
    ds_read_b128 v[128:131], v2 offset:0
    buffer_load_dwordx4 v254, s[24:27], s9 offen sc1 lds
    v_mfma_f32_32x32x16_bf16 v[88:103], v[108:111], a[112:115], v[88:103]
    ds_read_b128 v[132:135], v2 offset:1024
    s_waitcnt lgkmcnt(4)
    v_mfma_f32_32x32x16_bf16 v[88:103], v[112:115], a[116:119], v[88:103]
    s_add_u32 m0, s85, 36864
    ds_read_b128 v[104:107], v2 offset:2048
    buffer_load_dwordx4 v254, s[24:27], s10 offen sc1 lds
    v_mfma_f32_32x32x16_bf16 v[88:103], v[116:119], a[120:123], v[88:103]
    ds_read_b128 v[108:111], v2 offset:3072
    s_waitcnt lgkmcnt(4)
    v_mfma_f32_32x32x16_bf16 v[88:103], v[120:123], a[124:127], v[88:103]
    s_add_u32 m0, s85, 38912
    ds_read_b128 v[112:115], v2 offset:4096
    buffer_load_dwordx4 v254, s[24:27], s11 offen sc1 lds
    v_mfma_f32_32x32x16_bf16 v[88:103], v[124:127], v[136:139], v[88:103]
    ds_read_b128 v[116:119], v2 offset:5120
    s_waitcnt lgkmcnt(4)
    v_mfma_f32_32x32x16_bf16 v[56:71], v[128:131], a[0:3], 0
    s_add_u32 m0, s85, 40960
    ds_read_b128 v[120:123], v2 offset:6144
    buffer_load_dwordx4 v254, s[24:27], s12 offen sc1 lds
    v_mfma_f32_32x32x16_bf16 v[56:71], v[132:135], a[4:7], v[56:71]
    ds_read_b128 v[124:127], v2 offset:7168
    s_waitcnt lgkmcnt(4)
    v_mfma_f32_32x32x16_bf16 v[56:71], v[104:107], a[8:11], v[56:71]
    s_add_u32 m0, s85, 43008
    ds_read_b128 v[128:131], v2 offset:8192
    buffer_load_dwordx4 v254, s[24:27], s13 offen sc1 lds
    v_mfma_f32_32x32x16_bf16 v[56:71], v[108:111], a[12:15], v[56:71]
    ds_read_b128 v[132:135], v2 offset:9216
    s_waitcnt lgkmcnt(4)
    v_mfma_f32_32x32x16_bf16 v[56:71], v[112:115], a[16:19], v[56:71]
    s_add_u32 m0, s85, 45056
    ds_read_b128 v[104:107], v2 offset:10240
    buffer_load_dwordx4 v254, s[24:27], s14 offen sc1 lds
    v_mul_f32 v144, v88, v88
    v_mfma_f32_32x32x16_bf16 v[56:71], v[116:119], a[20:23], v[56:71]
    ds_read_b128 v[108:111], v2 offset:11264
    v_mul_f32 v145, v89, v89
    v_mul_f32 v146, v90, v90
    v_mul_f32 v147, v91, v91
    v_fma_f32 v144, v144, v141, v140
    v_fma_f32 v145, v145, v141, v140
    s_waitcnt lgkmcnt(4)
    v_mfma_f32_32x32x16_bf16 v[56:71], v[120:123], a[24:27], v[56:71]
    s_add_u32 m0, s85, 47104
    ds_read_b128 v[112:115], v2 offset:12288
    buffer_load_dwordx4 v254, s[24:27], s15 offen sc1 lds
    v_fma_f32 v146, v146, v141, v140
    v_fma_f32 v147, v147, v141, v140
    v_mul_f32 v144, v144, v88
    v_mfma_f32_32x32x16_bf16 v[56:71], v[124:127], a[28:31], v[56:71]
    ds_read_b128 v[116:119], v2 offset:13312
    v_mul_f32 v145, v145, v89
    v_mul_f32 v146, v146, v90
    v_mul_f32 v147, v147, v91
    v_exp_f32 v144, v144
    v_mul_f32 v88, v88, v96
    s_waitcnt lgkmcnt(4)
    v_mfma_f32_32x32x16_bf16 v[56:71], v[128:131], a[32:35], v[56:71]
    v_add_u32 v254, 512, v4
    s_add_u32 m0, s85, 65536
    ds_read_b128 v[120:123], v2 offset:14336
    buffer_load_dwordx4 v254, s[24:27], s8 offen sc1 lds
    v_exp_f32 v145, v145
    v_mul_f32 v89, v89, v97
    v_exp_f32 v146, v146
    v_mul_f32 v90, v90, v98
    v_exp_f32 v147, v147
    v_mfma_f32_32x32x16_bf16 v[56:71], v[132:135], a[36:39], v[56:71]
    ds_read_b128 v[124:127], v2 offset:15360
    v_mul_f32 v91, v91, v99
    v_fma_f32 v144, v144, v142, v142
    v_fma_f32 v145, v145, v142, v142
    v_fma_f32 v146, v146, v142, v142
    v_fma_f32 v147, v147, v142, v142
    s_waitcnt vmcnt(9)
    s_barrier
    s_cmp_lg_u32 s66, 0
    s_cbranch_scc1 L_sig_81
    s_mov_b64 exec, 0xffff
    v_mov_b32 v52, 0x1000
    buffer_atomic_add v52, v7, s[24:27], 0 offen offset:4 sc1
    s_mov_b64 exec, -1
L_sig_81:
    s_cmp_lg_u32 s66, 1
    s_cbranch_scc1 L_w1_82
    s_add_u32 s62, s86, 4
    v_mov_b32 v51, s62
    s_mov_b64 exec, 1
    v_mov_b32 v52, 0
    buffer_atomic_add v52, v51, s[24:27], 0 offen sc0 sc1
    s_mov_b64 exec, -1
L_w1_82:
    s_waitcnt lgkmcnt(4)
    v_mfma_f32_32x32x16_bf16 v[56:71], v[104:107], a[40:43], v[56:71]
    s_add_u32 m0, s85, 67584
    ds_read_b128 v[128:131], v2 offset:16384
    buffer_load_dwordx4 v254, s[24:27], s9 offen sc1 lds
    v_rcp_f32 v144, v144
    v_rcp_f32 v145, v145
    v_rcp_f32 v146, v146
    v_rcp_f32 v147, v147
    v_mul_f32 v88, v88, v144
    v_mfma_f32_32x32x16_bf16 v[56:71], v[108:111], a[44:47], v[56:71]
    ds_read_b128 v[132:135], v2 offset:17408
    v_mul_f32 v89, v89, v145
    v_mul_f32 v90, v90, v146
    v_mul_f32 v91, v91, v147
    v_cvt_pk_bf16_f32 v152, v88, v89
    v_cvt_pk_bf16_f32 v153, v90, v91
    s_waitcnt lgkmcnt(4)
    v_mfma_f32_32x32x16_bf16 v[56:71], v[112:115], a[48:51], v[56:71]
    s_add_u32 m0, s85, 69632
    ds_read_b128 v[104:107], v2 offset:18432
    buffer_load_dwordx4 v254, s[24:27], s10 offen sc1 lds
    v_mul_f32 v148, v92, v92
    v_mul_f32 v149, v93, v93
    v_mul_f32 v150, v94, v94
    v_mul_f32 v151, v95, v95
    v_fma_f32 v148, v148, v141, v140
    v_mfma_f32_32x32x16_bf16 v[56:71], v[116:119], a[52:55], v[56:71]
    ds_read_b128 v[108:111], v2 offset:19456
    v_fma_f32 v149, v149, v141, v140
    v_fma_f32 v150, v150, v141, v140
    v_fma_f32 v151, v151, v141, v140
    v_mul_f32 v148, v148, v92
    v_mul_f32 v149, v149, v93
    s_waitcnt lgkmcnt(4)
    v_mfma_f32_32x32x16_bf16 v[56:71], v[120:123], a[56:59], v[56:71]
    s_add_u32 m0, s85, 71680
    ds_read_b128 v[112:115], v2 offset:20480
    buffer_load_dwordx4 v254, s[24:27], s11 offen sc1 lds
    v_mul_f32 v150, v150, v94
    v_mul_f32 v151, v151, v95
    v_exp_f32 v148, v148
    v_mul_f32 v92, v92, v100
    v_exp_f32 v149, v149
    v_mfma_f32_32x32x16_bf16 v[56:71], v[124:127], a[60:63], v[56:71]
    ds_read_b128 v[116:119], v2 offset:21504
    v_mul_f32 v93, v93, v101
    v_exp_f32 v150, v150
    v_mul_f32 v94, v94, v102
    v_exp_f32 v151, v151
    v_mul_f32 v95, v95, v103
    s_waitcnt lgkmcnt(4)
    v_mfma_f32_32x32x16_bf16 v[56:71], v[128:131], a[64:67], v[56:71]
    s_add_u32 m0, s85, 73728
    ds_read_b128 v[120:123], v2 offset:22528
    buffer_load_dwordx4 v254, s[24:27], s12 offen sc1 lds
    v_fma_f32 v148, v148, v142, v142
    v_fma_f32 v149, v149, v142, v142
    v_fma_f32 v150, v150, v142, v142
    v_fma_f32 v151, v151, v142, v142
    v_rcp_f32 v148, v148
    v_mfma_f32_32x32x16_bf16 v[56:71], v[132:135], a[68:71], v[56:71]
    ds_read_b128 v[124:127], v2 offset:23552
    v_rcp_f32 v149, v149
    v_rcp_f32 v150, v150
    v_rcp_f32 v151, v151
    v_mul_f32 v92, v92, v148
    v_mul_f32 v93, v93, v149
    s_waitcnt lgkmcnt(4)
    v_mfma_f32_32x32x16_bf16 v[56:71], v[104:107], a[72:75], v[56:71]
    s_add_u32 m0, s85, 75776
    ds_read_b128 v[128:131], v2 offset:24576
    buffer_load_dwordx4 v254, s[24:27], s13 offen sc1 lds
    v_mul_f32 v94, v94, v150
    v_mul_f32 v95, v95, v151
    v_cvt_pk_bf16_f32 v154, v92, v93
    v_cvt_pk_bf16_f32 v155, v94, v95
    buffer_store_dwordx4 v[152:155], v4, s[24:27], s87 offen offset:2560 sc1
    v_mfma_f32_32x32x16_bf16 v[56:71], v[108:111], a[76:79], v[56:71]
    ds_read_b128 v[132:135], v2 offset:25600
    v_lshlrev_b32 v72, 16, v26
    v_and_b32 v73, 0xffff0000, v26
    v_lshlrev_b32 v74, 16, v27
    v_and_b32 v75, 0xffff0000, v27
    v_lshlrev_b32 v76, 16, v28
    s_waitcnt lgkmcnt(4)
    v_mfma_f32_32x32x16_bf16 v[56:71], v[112:115], a[80:83], v[56:71]
    s_add_u32 m0, s85, 77824
    ds_read_b128 v[104:107], v2 offset:26624
    buffer_load_dwordx4 v254, s[24:27], s14 offen sc1 lds
    v_and_b32 v77, 0xffff0000, v28
    v_mfma_f32_32x32x16_bf16 v[56:71], v[116:119], a[84:87], v[56:71]
    ds_read_b128 v[108:111], v2 offset:27648
    v_lshlrev_b32 v78, 16, v29
    v_and_b32 v79, 0xffff0000, v29
    v_lshlrev_b32 v80, 16, v30
    v_and_b32 v81, 0xffff0000, v30
    v_lshlrev_b32 v82, 16, v31
    s_waitcnt lgkmcnt(4)
    v_mfma_f32_32x32x16_bf16 v[56:71], v[120:123], a[88:91], v[56:71]
    s_add_u32 m0, s85, 79872
    ds_read_b128 v[112:115], v2 offset:28672
    buffer_load_dwordx4 v254, s[24:27], s15 offen sc1 lds
    v_and_b32 v83, 0xffff0000, v31
    v_mfma_f32_32x32x16_bf16 v[56:71], v[124:127], a[92:95], v[56:71]
    ds_read_b128 v[116:119], v2 offset:29696
    v_lshlrev_b32 v84, 16, v32
    v_and_b32 v85, 0xffff0000, v32
    v_lshlrev_b32 v86, 16, v33
    v_and_b32 v87, 0xffff0000, v33
    s_waitcnt lgkmcnt(4)
    v_mfma_f32_32x32x16_bf16 v[56:71], v[128:131], a[96:99], v[56:71]
    buffer_load_dwordx4 a[248:251], v2, s[24:27], s64 offen offset:2048 sc1
    ds_read_b128 v[120:123], v2 offset:30720
    v_mfma_f32_32x32x16_bf16 v[56:71], v[132:135], a[100:103], v[56:71]
    ds_read_b128 v[124:127], v2 offset:31744
    s_waitcnt vmcnt(10)
    s_cmp_lg_u32 s66, 1
    s_cbranch_scc1 L_w1_83
    s_mov_b64 exec, 1
    s_mov_b32 s90, 0
    s_waitcnt vmcnt(9)
    s_branch L_pollc_86
L_poll_84:
    v_mov_b32 v52, 0
    buffer_atomic_add v52, v51, s[24:27], 0 offen sc0 sc1
    s_waitcnt vmcnt(0)
L_pollc_86:
    v_bfe_u32 v52, v52, 6, 6
    v_cmp_ne_u32 vcc, 16, v52
    s_cbranch_vccz L_polld_85
    s_add_u32 s90, s90, 1
    s_cmp_lt_u32 s90, 0x4000
    s_cbranch_scc1 L_poll_84
    v_mov_b32 v52, 273
    buffer_store_dword v52, v55, s[48:51], 0 offen offset:4
L_polld_85:
    s_mov_b64 exec, -1
L_w1_83:
    s_barrier
    s_waitcnt lgkmcnt(4)
    v_mfma_f32_32x32x16_bf16 v[56:71], v[104:107], a[104:107], v[56:71]
    v_add_u32 v254, 1024, v4
    s_add_u32 m0, s85, 98304
    ds_read_b128 v[128:131], v18 offset:6144
    buffer_load_dwordx4 v254, s[24:27], s8 offen sc1 lds
    v_mfma_f32_32x32x16_bf16 v[56:71], v[108:111], a[108:111], v[56:71]
    ds_read_b128 v[132:135], v250 offset:32768
    s_waitcnt lgkmcnt(4)
    v_mfma_f32_32x32x16_bf16 v[56:71], v[112:115], a[112:115], v[56:71]
    s_add_u32 m0, s85, 100352
    ds_read_b128 v[104:107], v251 offset:32768
    buffer_load_dwordx4 v254, s[24:27], s9 offen sc1 lds
    v_mfma_f32_32x32x16_bf16 v[56:71], v[116:119], a[116:119], v[56:71]
    ds_read_b128 v[108:111], v250 offset:34816
    s_waitcnt lgkmcnt(4)
    v_mfma_f32_32x32x16_bf16 v[56:71], v[120:123], a[120:123], v[56:71]
    s_add_u32 m0, s85, 102400
    ds_read_b128 v[112:115], v251 offset:34816
    buffer_load_dwordx4 v254, s[24:27], s10 offen sc1 lds
    v_mfma_f32_32x32x16_bf16 v[56:71], v[124:127], a[124:127], v[56:71]
    ds_read_b128 v[116:119], v250 offset:36864
    s_waitcnt lgkmcnt(4)
    v_mfma_f32_32x32x16_bf16 v[56:71], v[128:131], v[136:139], v[56:71]
    s_add_u32 m0, s85, 104448
    ds_read_b128 v[120:123], v251 offset:36864
    buffer_load_dwordx4 v254, s[24:27], s11 offen sc1 lds
    v_mfma_f32_32x32x16_bf16 v[72:87], a[128:131], v[132:135], v[72:87]
    s_add_u32 m0, s85, 106496
    ds_read_b128 v[124:127], v250 offset:38912
    buffer_load_dwordx4 v254, s[24:27], s12 offen sc1 lds
    s_waitcnt lgkmcnt(4)
    v_mfma_f32_32x32x16_bf16 v[88:103], a[128:131], v[104:107], 0
    s_add_u32 m0, s85, 108544
    ds_read_b128 v[128:131], v251 offset:38912
    buffer_load_dwordx4 v254, s[24:27], s13 offen sc1 lds
    v_mfma_f32_32x32x16_bf16 v[72:87], a[144:147], v[108:111], v[72:87]
    s_add_u32 m0, s85, 110592
    ds_read_b128 v[132:135], v250 offset:40960
    buffer_load_dwordx4 v254, s[24:27], s14 offen sc1 lds
    s_waitcnt lgkmcnt(4)
    v_mfma_f32_32x32x16_bf16 v[88:103], a[144:147], v[112:115], v[88:103]
    s_add_u32 m0, s85, 112640
    ds_read_b128 v[104:107], v251 offset:40960
    buffer_load_dwordx4 v254, s[24:27], s15 offen sc1 lds
    v_mfma_f32_32x32x16_bf16 v[72:87], a[160:163], v[116:119], v[72:87]
    ds_read_b128 v[108:111], v250 offset:43008
    v_mul_f32 v144, v56, v56
    v_mul_f32 v145, v57, v57
    v_mul_f32 v146, v58, v58
    v_mul_f32 v147, v59, v59
    v_fma_f32 v144, v144, v141, v140
    s_waitcnt lgkmcnt(4)
    v_mfma_f32_32x32x16_bf16 v[88:103], a[160:163], v[120:123], v[88:103]
    buffer_load_dwordx4 a[252:255], v2, s[24:27], s64 offen offset:3072 sc1
    ds_read_b128 v[112:115], v251 offset:43008
    v_fma_f32 v145, v145, v141, v140
    v_fma_f32 v146, v146, v141, v140
    v_fma_f32 v147, v147, v141, v140
    s_cmp_lg_u32 s66, 1
    s_cbranch_scc1 L_w1_87
    s_add_u32 s62, s86, 4
    v_mov_b32 v51, s62
    s_mov_b64 exec, 1
    v_mov_b32 v52, 0
    buffer_atomic_add v52, v51, s[24:27], 0 offen sc0 sc1
    s_mov_b64 exec, -1
L_w1_87:
    v_mfma_f32_32x32x16_bf16 v[72:87], a[176:179], v[124:127], v[72:87]
    ds_read_b128 v[116:119], v250 offset:45056
    v_mul_f32 v144, v144, v56
    v_mul_f32 v145, v145, v57
    v_mul_f32 v146, v146, v58
    v_mul_f32 v147, v147, v59
    v_exp_f32 v144, v144
    v_mul_f32 v56, v56, v64
    v_exp_f32 v145, v145
    v_mul_f32 v57, v57, v65
    v_exp_f32 v146, v146
    s_waitcnt lgkmcnt(4)
    v_mfma_f32_32x32x16_bf16 v[88:103], a[176:179], v[128:131], v[88:103]
    buffer_load_dwordx4 v[184:187], v16, s[24:27], s64 offen offset:0 sc1
    ds_read_b128 v[120:123], v251 offset:45056
    v_mul_f32 v58, v58, v66
    v_exp_f32 v147, v147
    v_mul_f32 v59, v59, v67
    v_fma_f32 v144, v144, v142, v142
    v_fma_f32 v145, v145, v142, v142
    v_fma_f32 v146, v146, v142, v142
    v_fma_f32 v147, v147, v142, v142
    v_rcp_f32 v144, v144
    v_mfma_f32_32x32x16_bf16 v[72:87], a[192:195], v[132:135], v[72:87]
    ds_read_b128 v[124:127], v250 offset:47104
    v_rcp_f32 v145, v145
    v_rcp_f32 v146, v146
    v_rcp_f32 v147, v147
    v_mul_f32 v56, v56, v144
    v_mul_f32 v57, v57, v145
    v_mul_f32 v58, v58, v146
    v_mul_f32 v59, v59, v147
    v_cvt_pk_bf16_f32 v152, v56, v57
    v_cvt_pk_bf16_f32 v153, v58, v59
    s_waitcnt vmcnt(11)
    s_barrier
    s_cmp_lg_u32 s66, 0
    s_cbranch_scc1 L_sig_88
    s_mov_b64 exec, 0xffff
    v_mov_b32 v52, 0x40000
    buffer_atomic_add v52, v7, s[24:27], 0 offen offset:4 sc1
    s_mov_b64 exec, -1
L_sig_88:
    s_waitcnt lgkmcnt(4)
    v_mfma_f32_32x32x16_bf16 v[88:103], a[192:195], v[104:107], v[88:103]
    v_add_u32 v254, 1536, v4
    s_add_u32 m0, s85, 0
    ds_read_b128 v[128:131], v251 offset:47104
    buffer_load_dwordx4 v254, s[24:27], s8 offen sc1 lds
    v_mul_f32 v148, v60, v60
    v_mul_f32 v149, v61, v61
    v_mul_f32 v150, v62, v62
    v_mul_f32 v151, v63, v63
    v_fma_f32 v148, v148, v141, v140
    v_fma_f32 v149, v149, v141, v140
    v_fma_f32 v150, v150, v141, v140
    v_fma_f32 v151, v151, v141, v140
    v_mul_f32 v148, v148, v60
    v_mfma_f32_32x32x16_bf16 v[72:87], a[208:211], v[108:111], v[72:87]
    s_add_u32 m0, s85, 2048
    ds_read_b128 v[132:135], v252 offset:0
    buffer_load_dwordx4 v254, s[24:27], s9 offen sc1 lds
    v_mul_f32 v149, v149, v61
    v_mul_f32 v150, v150, v62
    v_mul_f32 v151, v151, v63
    v_exp_f32 v148, v148
    v_mul_f32 v60, v60, v68
    v_exp_f32 v149, v149
    v_mul_f32 v61, v61, v69
    v_exp_f32 v150, v150
    s_waitcnt lgkmcnt(4)
    v_mfma_f32_32x32x16_bf16 v[88:103], a[208:211], v[112:115], v[88:103]
    s_add_u32 m0, s85, 4096
    ds_read_b128 v[104:107], v253 offset:0
    buffer_load_dwordx4 v254, s[24:27], s10 offen sc1 lds
    v_mul_f32 v62, v62, v70
    v_exp_f32 v151, v151
    v_mul_f32 v63, v63, v71
    v_fma_f32 v148, v148, v142, v142
    v_fma_f32 v149, v149, v142, v142
    v_fma_f32 v150, v150, v142, v142
    v_fma_f32 v151, v151, v142, v142
    v_rcp_f32 v148, v148
    v_rcp_f32 v149, v149
    v_mfma_f32_32x32x16_bf16 v[72:87], a[224:227], v[116:119], v[72:87]
    s_add_u32 m0, s85, 6144
    ds_read_b128 v[108:111], v252 offset:2048
    buffer_load_dwordx4 v254, s[24:27], s11 offen sc1 lds
    v_rcp_f32 v150, v150
    v_rcp_f32 v151, v151
    v_mul_f32 v60, v60, v148
    v_mul_f32 v61, v61, v149
    v_mul_f32 v62, v62, v150
    v_mul_f32 v63, v63, v151
    v_cvt_pk_bf16_f32 v154, v60, v61
    v_cvt_pk_bf16_f32 v155, v62, v63
    buffer_store_dwordx4 v[152:155], v4, s[24:27], s87 offen offset:3072 sc1
    s_waitcnt lgkmcnt(4)
    v_mfma_f32_32x32x16_bf16 v[88:103], a[224:227], v[120:123], v[88:103]
    s_add_u32 m0, s85, 8192
    ds_read_b128 v[112:115], v253 offset:2048
    buffer_load_dwordx4 v254, s[24:27], s12 offen sc1 lds
    v_mfma_f32_32x32x16_bf16 v[72:87], a[240:243], v[124:127], v[72:87]
    s_add_u32 m0, s85, 10240
    ds_read_b128 v[116:119], v252 offset:4096
    buffer_load_dwordx4 v254, s[24:27], s13 offen sc1 lds
    s_waitcnt lgkmcnt(4)
    v_mfma_f32_32x32x16_bf16 v[88:103], a[240:243], v[128:131], v[88:103]
    s_add_u32 m0, s85, 12288
    ds_read_b128 v[120:123], v253 offset:4096
    buffer_load_dwordx4 v254, s[24:27], s14 offen sc1 lds
    v_mfma_f32_32x32x16_bf16 v[72:87], a[132:135], v[132:135], v[72:87]
    s_add_u32 m0, s85, 14336
    ds_read_b128 v[124:127], v252 offset:6144
    buffer_load_dwordx4 v254, s[24:27], s15 offen sc1 lds
    s_waitcnt lgkmcnt(4)
    v_mfma_f32_32x32x16_bf16 v[88:103], a[132:135], v[104:107], v[88:103]
    ds_read_b128 v[128:131], v253 offset:6144
    v_mfma_f32_32x32x16_bf16 v[72:87], a[148:151], v[108:111], v[72:87]
    s_add_u32 s64, s84, 0
    buffer_load_dwordx4 a[0:3], v16, s[24:27], s64 offen offset:1024 sc1
    ds_read_b128 v[132:135], v252 offset:8192
    s_waitcnt lgkmcnt(4)
    v_mfma_f32_32x32x16_bf16 v[88:103], a[148:151], v[112:115], v[88:103]
    ds_read_b128 v[104:107], v253 offset:8192
    v_mfma_f32_32x32x16_bf16 v[72:87], a[164:167], v[116:119], v[72:87]
    s_add_u32 s64, s84, 7168
    buffer_load_dwordx4 a[4:7], v16, s[24:27], s64 offen offset:1024 sc1
    ds_read_b128 v[108:111], v252 offset:10240
    s_waitcnt lgkmcnt(4)
    v_mfma_f32_32x32x16_bf16 v[88:103], a[164:167], v[120:123], v[88:103]
    ds_read_b128 v[112:115], v253 offset:10240
    v_mfma_f32_32x32x16_bf16 v[72:87], a[180:183], v[124:127], v[72:87]
    s_add_u32 s64, s84, 14336
    buffer_load_dwordx4 a[8:11], v16, s[24:27], s64 offen offset:1024 sc1
    ds_read_b128 v[116:119], v252 offset:12288
    s_waitcnt lgkmcnt(4)
    v_mfma_f32_32x32x16_bf16 v[88:103], a[180:183], v[128:131], v[88:103]
    ds_read_b128 v[120:123], v253 offset:12288
    v_mfma_f32_32x32x16_bf16 v[72:87], a[196:199], v[132:135], v[72:87]
    s_add_u32 s64, s84, 21504
    buffer_load_dwordx4 a[12:15], v16, s[24:27], s64 offen offset:1024 sc1
    ds_read_b128 v[124:127], v252 offset:14336
    s_waitcnt vmcnt(15)
    s_cmp_lg_u32 s66, 1
    s_cbranch_scc1 L_w1_89
    s_mov_b64 exec, 1
    s_mov_b32 s90, 0
    s_waitcnt vmcnt(14)
    s_branch L_pollc_92
L_poll_90:
    v_mov_b32 v52, 0
    buffer_atomic_add v52, v51, s[24:27], 0 offen sc0 sc1
    s_waitcnt vmcnt(0)
L_pollc_92:
    v_bfe_u32 v52, v52, 12, 6
    v_cmp_ne_u32 vcc, 16, v52
    s_cbranch_vccz L_polld_91
    s_add_u32 s90, s90, 1
    s_cmp_lt_u32 s90, 0x4000
    s_cbranch_scc1 L_poll_90
    v_mov_b32 v52, 274
    buffer_store_dword v52, v55, s[48:51], 0 offen offset:4
L_polld_91:
    s_mov_b64 exec, -1
L_w1_89:
    s_barrier
    s_waitcnt lgkmcnt(4)
    v_mfma_f32_32x32x16_bf16 v[88:103], a[196:199], v[104:107], v[88:103]
    v_add_u32 v254, 2048, v4
    s_add_u32 m0, s85, 32768
    ds_read_b128 v[128:131], v253 offset:14336
    buffer_load_dwordx4 v254, s[24:27], s8 offen sc1 lds
    v_mfma_f32_32x32x16_bf16 v[72:87], a[212:215], v[108:111], v[72:87]
    s_add_u32 m0, s85, 34816
    ds_read_b128 v[132:135], v252 offset:32768
    buffer_load_dwordx4 v254, s[24:27], s9 offen sc1 lds
    s_waitcnt lgkmcnt(4)
    v_mfma_f32_32x32x16_bf16 v[88:103], a[212:215], v[112:115], v[88:103]
    s_add_u32 m0, s85, 36864
    ds_read_b128 v[104:107], v253 offset:32768
    buffer_load_dwordx4 v254, s[24:27], s10 offen sc1 lds
    v_mfma_f32_32x32x16_bf16 v[72:87], a[228:231], v[116:119], v[72:87]
    s_add_u32 m0, s85, 38912
    ds_read_b128 v[108:111], v252 offset:34816
    buffer_load_dwordx4 v254, s[24:27], s11 offen sc1 lds
    s_cmp_lg_u32 s66, 1
    s_cbranch_scc1 L_w1_93
    s_add_u32 s62, s86, 4
    v_mov_b32 v51, s62
    s_mov_b64 exec, 1
    v_mov_b32 v52, 0
    buffer_atomic_add v52, v51, s[24:27], 0 offen sc0 sc1
    s_mov_b64 exec, -1
L_w1_93:
    s_waitcnt lgkmcnt(4)
    v_mfma_f32_32x32x16_bf16 v[88:103], a[228:231], v[120:123], v[88:103]
    s_add_u32 m0, s85, 40960
    ds_read_b128 v[112:115], v253 offset:34816
    buffer_load_dwordx4 v254, s[24:27], s12 offen sc1 lds
    v_mfma_f32_32x32x16_bf16 v[72:87], a[244:247], v[124:127], v[72:87]
    s_add_u32 m0, s85, 43008
    ds_read_b128 v[116:119], v252 offset:36864
    buffer_load_dwordx4 v254, s[24:27], s13 offen sc1 lds
    s_waitcnt lgkmcnt(4)
    v_mfma_f32_32x32x16_bf16 v[88:103], a[244:247], v[128:131], v[88:103]
    s_add_u32 m0, s85, 45056
    ds_read_b128 v[120:123], v253 offset:36864
    buffer_load_dwordx4 v254, s[24:27], s14 offen sc1 lds
    v_mfma_f32_32x32x16_bf16 v[72:87], a[136:139], v[132:135], v[72:87]
    s_add_u32 m0, s85, 47104
    ds_read_b128 v[124:127], v252 offset:38912
    buffer_load_dwordx4 v254, s[24:27], s15 offen sc1 lds
    s_waitcnt vmcnt(16)
    s_barrier
    s_cmp_lg_u32 s66, 0
    s_cbranch_scc1 L_sig_94
    s_mov_b64 exec, 0xffff
    v_mov_b32 v52, 0x1000000
    buffer_atomic_add v52, v7, s[24:27], 0 offen offset:4 sc1
    s_mov_b64 exec, -1
L_sig_94:
    s_waitcnt lgkmcnt(4)
    v_mfma_f32_32x32x16_bf16 v[88:103], a[136:139], v[104:107], v[88:103]
    ds_read_b128 v[128:131], v253 offset:38912
    v_mfma_f32_32x32x16_bf16 v[72:87], a[152:155], v[108:111], v[72:87]
    s_add_u32 s64, s84, 28672
    buffer_load_dwordx4 a[16:19], v16, s[24:27], s64 offen offset:1024 sc1
    ds_read_b128 v[132:135], v252 offset:40960
    s_waitcnt lgkmcnt(4)
    v_mfma_f32_32x32x16_bf16 v[88:103], a[152:155], v[112:115], v[88:103]
    ds_read_b128 v[104:107], v253 offset:40960
    v_mfma_f32_32x32x16_bf16 v[72:87], a[168:171], v[116:119], v[72:87]
    s_add_u32 s64, s84, 35840
    buffer_load_dwordx4 a[20:23], v16, s[24:27], s64 offen offset:1024 sc1
    ds_read_b128 v[108:111], v252 offset:43008
    s_waitcnt lgkmcnt(4)
    v_mfma_f32_32x32x16_bf16 v[88:103], a[168:171], v[120:123], v[88:103]
    ds_read_b128 v[112:115], v253 offset:43008
    v_mfma_f32_32x32x16_bf16 v[72:87], a[184:187], v[124:127], v[72:87]
    s_add_u32 s64, s84, 43008
    buffer_load_dwordx4 a[24:27], v16, s[24:27], s64 offen offset:1024 sc1
    ds_read_b128 v[116:119], v252 offset:45056
    s_waitcnt lgkmcnt(4)
    v_mfma_f32_32x32x16_bf16 v[88:103], a[184:187], v[128:131], v[88:103]
    ds_read_b128 v[120:123], v253 offset:45056
    v_mfma_f32_32x32x16_bf16 v[72:87], a[200:203], v[132:135], v[72:87]
    s_add_u32 s64, s84, 50176
    buffer_load_dwordx4 a[28:31], v16, s[24:27], s64 offen offset:1024 sc1
    ds_read_b128 v[124:127], v252 offset:47104
    s_waitcnt vmcnt(16)
    s_barrier
    s_waitcnt lgkmcnt(4)
    v_mfma_f32_32x32x16_bf16 v[88:103], a[200:203], v[104:107], v[88:103]
    ds_read_b128 v[128:131], v253 offset:47104
    v_mfma_f32_32x32x16_bf16 v[72:87], a[216:219], v[108:111], v[72:87]
    s_add_u32 s64, s84, 0
    buffer_load_dwordx4 a[32:35], v16, s[24:27], s64 offen offset:2048 sc1
    ds_read_b128 v[132:135], v250 offset:0
    s_waitcnt lgkmcnt(4)
    v_mfma_f32_32x32x16_bf16 v[88:103], a[216:219], v[112:115], v[88:103]
    ds_read_b128 v[104:107], v251 offset:0
    v_mfma_f32_32x32x16_bf16 v[72:87], a[232:235], v[116:119], v[72:87]
    s_add_u32 s64, s84, 7168
    buffer_load_dwordx4 a[36:39], v16, s[24:27], s64 offen offset:2048 sc1
    ds_read_b128 v[108:111], v250 offset:2048
    s_waitcnt lgkmcnt(4)
    v_mfma_f32_32x32x16_bf16 v[88:103], a[232:235], v[120:123], v[88:103]
    ds_read_b128 v[112:115], v251 offset:2048
    v_mfma_f32_32x32x16_bf16 v[72:87], a[248:251], v[124:127], v[72:87]
    s_add_u32 s64, s84, 14336
    buffer_load_dwordx4 a[40:43], v16, s[24:27], s64 offen offset:2048 sc1
    ds_read_b128 v[116:119], v250 offset:4096
    s_cmp_lg_u32 s66, 1
    s_cbranch_scc1 L_w1_95
    s_mov_b64 exec, 1
    s_mov_b32 s90, 0
    s_waitcnt vmcnt(11)
    s_branch L_pollc_98
L_poll_96:
    v_mov_b32 v52, 0
    buffer_atomic_add v52, v51, s[24:27], 0 offen sc0 sc1
    s_waitcnt vmcnt(0)
L_pollc_98:
    v_bfe_u32 v52, v52, 18, 6
    v_cmp_ne_u32 vcc, 16, v52
    s_cbranch_vccz L_polld_97
    s_add_u32 s90, s90, 1
    s_cmp_lt_u32 s90, 0x4000
    s_cbranch_scc1 L_poll_96
    v_mov_b32 v52, 275
    buffer_store_dword v52, v55, s[48:51], 0 offen offset:4
L_polld_97:
    s_mov_b64 exec, -1
L_w1_95:
    s_barrier
    s_waitcnt lgkmcnt(4)
    v_mfma_f32_32x32x16_bf16 v[88:103], a[248:251], v[128:131], v[88:103]
    v_add_u32 v254, 2560, v4
    s_add_u32 m0, s85, 65536
    ds_read_b128 v[120:123], v251 offset:4096
    buffer_load_dwordx4 v254, s[24:27], s8 offen sc1 lds
    v_mfma_f32_32x32x16_bf16 v[72:87], a[140:143], v[132:135], v[72:87]
    s_add_u32 m0, s85, 67584
    ds_read_b128 v[124:127], v250 offset:6144
    buffer_load_dwordx4 v254, s[24:27], s9 offen sc1 lds
    s_waitcnt lgkmcnt(4)
    v_mfma_f32_32x32x16_bf16 v[88:103], a[140:143], v[104:107], v[88:103]
    s_add_u32 m0, s85, 69632
    ds_read_b128 v[128:131], v251 offset:6144
    buffer_load_dwordx4 v254, s[24:27], s10 offen sc1 lds
    v_mfma_f32_32x32x16_bf16 v[72:87], a[156:159], v[108:111], v[72:87]
    s_add_u32 m0, s85, 71680
    ds_read_b128 v[132:135], v250 offset:8192
    buffer_load_dwordx4 v254, s[24:27], s11 offen sc1 lds
    s_cmp_lg_u32 s66, 1
    s_cbranch_scc1 L_w1_99
    s_add_u32 s62, s86, 4
    v_mov_b32 v51, s62
    s_mov_b64 exec, 1
    v_mov_b32 v52, 0
    buffer_atomic_add v52, v51, s[24:27], 0 offen sc0 sc1
    s_mov_b64 exec, -1
L_w1_99:
    s_waitcnt lgkmcnt(4)
    v_mfma_f32_32x32x16_bf16 v[88:103], a[156:159], v[112:115], v[88:103]
    s_add_u32 m0, s85, 73728
    ds_read_b128 v[104:107], v251 offset:8192
    buffer_load_dwordx4 v254, s[24:27], s12 offen sc1 lds
    v_mfma_f32_32x32x16_bf16 v[72:87], a[172:175], v[116:119], v[72:87]
    s_add_u32 m0, s85, 75776
    ds_read_b128 v[108:111], v250 offset:10240
    buffer_load_dwordx4 v254, s[24:27], s13 offen sc1 lds
    s_waitcnt lgkmcnt(4)
    v_mfma_f32_32x32x16_bf16 v[88:103], a[172:175], v[120:123], v[88:103]
    s_add_u32 m0, s85, 77824
    ds_read_b128 v[112:115], v251 offset:10240
    buffer_load_dwordx4 v254, s[24:27], s14 offen sc1 lds
    v_mfma_f32_32x32x16_bf16 v[72:87], a[188:191], v[124:127], v[72:87]
    s_add_u32 m0, s85, 79872
    ds_read_b128 v[116:119], v250 offset:12288
    buffer_load_dwordx4 v254, s[24:27], s15 offen sc1 lds
    s_waitcnt lgkmcnt(4)
    v_mfma_f32_32x32x16_bf16 v[88:103], a[188:191], v[128:131], v[88:103]
    ds_read_b128 v[120:123], v251 offset:12288
    v_mfma_f32_32x32x16_bf16 v[72:87], a[204:207], v[132:135], v[72:87]
    s_add_u32 s64, s84, 21504
    buffer_load_dwordx4 a[44:47], v16, s[24:27], s64 offen offset:2048 sc1
    ds_read_b128 v[124:127], v250 offset:14336
    s_waitcnt vmcnt(16)
    s_barrier
    s_waitcnt lgkmcnt(4)
    v_mfma_f32_32x32x16_bf16 v[88:103], a[204:207], v[104:107], v[88:103]
    ds_read_b128 v[128:131], v251 offset:14336
    v_mfma_f32_32x32x16_bf16 v[72:87], a[220:223], v[108:111], v[72:87]
    s_add_u32 s64, s84, 28672
    buffer_load_dwordx4 a[48:51], v16, s[24:27], s64 offen offset:2048 sc1
    ds_read_b128 v[132:135], v250 offset:32768
    s_waitcnt lgkmcnt(4)
    v_mfma_f32_32x32x16_bf16 v[88:103], a[220:223], v[112:115], v[88:103]
    ds_read_b128 v[104:107], v251 offset:32768
    v_mfma_f32_32x32x16_bf16 v[72:87], a[236:239], v[116:119], v[72:87]
    s_add_u32 s64, s84, 35840
    buffer_load_dwordx4 a[52:55], v16, s[24:27], s64 offen offset:2048 sc1
    ds_read_b128 v[108:111], v250 offset:34816
    s_waitcnt lgkmcnt(4)
    v_mfma_f32_32x32x16_bf16 v[88:103], a[236:239], v[120:123], v[88:103]
    ds_read_b128 v[112:115], v251 offset:34816
    v_mfma_f32_32x32x16_bf16 v[72:87], a[252:255], v[124:127], v[72:87]
    s_add_u32 s64, s84, 43008
    buffer_load_dwordx4 a[56:59], v16, s[24:27], s64 offen offset:2048 sc1
    ds_read_b128 v[116:119], v250 offset:36864
    s_waitcnt lgkmcnt(4)
    v_mfma_f32_32x32x16_bf16 v[88:103], a[252:255], v[128:131], v[88:103]
    ds_read_b128 v[120:123], v251 offset:36864
    v_mfma_f32_32x32x16_bf16 v[72:87], v[156:159], v[132:135], v[72:87]
    s_add_u32 s64, s84, 50176
    buffer_load_dwordx4 a[60:63], v16, s[24:27], s64 offen offset:2048 sc1
    ds_read_b128 v[124:127], v250 offset:38912
    s_waitcnt lgkmcnt(4)
    v_mfma_f32_32x32x16_bf16 v[88:103], v[156:159], v[104:107], v[88:103]
    ds_read_b128 v[128:131], v251 offset:38912
    v_mfma_f32_32x32x16_bf16 v[72:87], v[160:163], v[108:111], v[72:87]
    ds_read_b128 v[132:135], v250 offset:40960
    s_waitcnt lgkmcnt(4)
    v_mfma_f32_32x32x16_bf16 v[88:103], v[160:163], v[112:115], v[88:103]
    ds_read_b128 v[104:107], v251 offset:40960
    v_mfma_f32_32x32x16_bf16 v[72:87], v[164:167], v[116:119], v[72:87]
    ds_read_b128 v[108:111], v250 offset:43008
    s_cmp_lg_u32 s66, 1
    s_cbranch_scc1 L_w1_100
    s_mov_b64 exec, 1
    s_mov_b32 s90, 0
    s_waitcnt vmcnt(9)
    s_branch L_pollc_103
L_poll_101:
    v_mov_b32 v52, 0
    buffer_atomic_add v52, v51, s[24:27], 0 offen sc0 sc1
    s_waitcnt vmcnt(0)
L_pollc_103:
    v_bfe_u32 v52, v52, 24, 6
    v_cmp_ne_u32 vcc, 16, v52
    s_cbranch_vccz L_polld_102
    s_add_u32 s90, s90, 1
    s_cmp_lt_u32 s90, 0x4000
    s_cbranch_scc1 L_poll_101
    v_mov_b32 v52, 276
    buffer_store_dword v52, v55, s[48:51], 0 offen offset:4
L_polld_102:
    s_mov_b64 exec, -1
L_w1_100:
    s_barrier
    s_waitcnt lgkmcnt(4)
    v_mfma_f32_32x32x16_bf16 v[88:103], v[164:167], v[120:123], v[88:103]
    v_add_u32 v254, 3072, v4
    s_add_u32 m0, s85, 98304
    ds_read_b128 v[112:115], v251 offset:43008
    buffer_load_dwordx4 v254, s[24:27], s8 offen sc1 lds
    v_mfma_f32_32x32x16_bf16 v[72:87], v[168:171], v[124:127], v[72:87]
    s_add_u32 m0, s85, 100352
    ds_read_b128 v[116:119], v250 offset:45056
    buffer_load_dwordx4 v254, s[24:27], s9 offen sc1 lds
    s_waitcnt lgkmcnt(4)
    v_mfma_f32_32x32x16_bf16 v[88:103], v[168:171], v[128:131], v[88:103]
    s_add_u32 m0, s85, 102400
    ds_read_b128 v[120:123], v251 offset:45056
    buffer_load_dwordx4 v254, s[24:27], s10 offen sc1 lds
    v_mfma_f32_32x32x16_bf16 v[72:87], v[172:175], v[132:135], v[72:87]
    s_add_u32 m0, s85, 104448
    ds_read_b128 v[124:127], v250 offset:47104
    buffer_load_dwordx4 v254, s[24:27], s11 offen sc1 lds
    s_waitcnt vmcnt(9)
    s_barrier
    s_waitcnt lgkmcnt(4)
    v_mfma_f32_32x32x16_bf16 v[88:103], v[172:175], v[104:107], v[88:103]
    s_add_u32 m0, s85, 106496
    ds_read_b128 v[128:131], v251 offset:47104
    buffer_load_dwordx4 v254, s[24:27], s12 offen sc1 lds
    v_mfma_f32_32x32x16_bf16 v[72:87], v[176:179], v[108:111], v[72:87]
    s_add_u32 m0, s85, 108544
    ds_read_b128 v[132:135], v252 offset:0
    buffer_load_dwordx4 v254, s[24:27], s13 offen sc1 lds
    s_waitcnt lgkmcnt(4)
    v_mfma_f32_32x32x16_bf16 v[88:103], v[176:179], v[112:115], v[88:103]
    s_add_u32 m0, s85, 110592
    ds_read_b128 v[104:107], v253 offset:0
    buffer_load_dwordx4 v254, s[24:27], s14 offen sc1 lds
    v_mfma_f32_32x32x16_bf16 v[72:87], v[180:183], v[116:119], v[72:87]
    s_add_u32 m0, s85, 112640
    ds_read_b128 v[108:111], v252 offset:2048
    buffer_load_dwordx4 v254, s[24:27], s15 offen sc1 lds
    s_waitcnt lgkmcnt(4)
    v_mfma_f32_32x32x16_bf16 v[88:103], v[180:183], v[120:123], v[88:103]
    ds_read_b128 v[112:115], v253 offset:2048
    v_mfma_f32_32x32x16_bf16 v[72:87], v[184:187], v[124:127], v[72:87]
    s_add_u32 s64, s95, 0
    buffer_load_dwordx4 a[128:131], v2, s[44:47], s64 offen offset:0 sc1
    ds_read_b128 v[116:119], v252 offset:4096
    s_waitcnt lgkmcnt(4)
    v_mfma_f32_32x32x16_bf16 v[88:103], v[184:187], v[128:131], v[88:103]
    ds_read_b128 v[120:123], v253 offset:4096
    v_mfma_f32_32x32x16_bf16 v[72:87], a[0:3], v[132:135], v[72:87]
    buffer_load_dwordx4 a[132:135], v2, s[44:47], s64 offen offset:1024 sc1
    ds_read_b128 v[124:127], v252 offset:6144
    s_waitcnt lgkmcnt(4)
    v_mfma_f32_32x32x16_bf16 v[88:103], a[0:3], v[104:107], v[88:103]
    ds_read_b128 v[128:131], v253 offset:6144
    v_mfma_f32_32x32x16_bf16 v[72:87], a[4:7], v[108:111], v[72:87]
    buffer_load_dwordx4 a[136:139], v2, s[44:47], s64 offen offset:2048 sc1
    ds_read_b128 v[132:135], v252 offset:8192
    s_waitcnt lgkmcnt(4)
    v_mfma_f32_32x32x16_bf16 v[88:103], a[4:7], v[112:115], v[88:103]
    ds_read_b128 v[104:107], v253 offset:8192
    v_mfma_f32_32x32x16_bf16 v[72:87], a[8:11], v[116:119], v[72:87]
    buffer_load_dwordx4 a[140:143], v2, s[44:47], s64 offen offset:3072 sc1
    ds_read_b128 v[108:111], v252 offset:10240
    s_waitcnt lgkmcnt(4)
    v_mfma_f32_32x32x16_bf16 v[88:103], a[8:11], v[120:123], v[88:103]
    ds_read_b128 v[112:115], v253 offset:10240
    v_mfma_f32_32x32x16_bf16 v[72:87], a[12:15], v[124:127], v[72:87]
    s_add_u32 s64, s95, 4096
    buffer_load_dwordx4 a[144:147], v2, s[44:47], s64 offen offset:0 sc1
    ds_read_b128 v[116:119], v252 offset:12288
    s_waitcnt lgkmcnt(4)
    v_mfma_f32_32x32x16_bf16 v[88:103], a[12:15], v[128:131], v[88:103]
    ds_read_b128 v[120:123], v253 offset:12288
    v_mfma_f32_32x32x16_bf16 v[72:87], a[16:19], v[132:135], v[72:87]
    buffer_load_dwordx4 a[148:151], v2, s[44:47], s64 offen offset:1024 sc1
    ds_read_b128 v[124:127], v252 offset:14336
    s_waitcnt vmcnt(6)
    s_barrier
    s_waitcnt lgkmcnt(4)
    v_mfma_f32_32x32x16_bf16 v[88:103], a[16:19], v[104:107], v[88:103]
    ds_read_b128 v[128:131], v253 offset:14336
    v_mfma_f32_32x32x16_bf16 v[72:87], a[20:23], v[108:111], v[72:87]
    buffer_load_dwordx4 a[152:155], v2, s[44:47], s64 offen offset:2048 sc1
    ds_read_b128 v[132:135], v252 offset:32768
    s_waitcnt lgkmcnt(4)
    v_mfma_f32_32x32x16_bf16 v[88:103], a[20:23], v[112:115], v[88:103]
    ds_read_b128 v[104:107], v253 offset:32768
    v_mfma_f32_32x32x16_bf16 v[72:87], a[24:27], v[116:119], v[72:87]
    buffer_load_dwordx4 a[156:159], v2, s[44:47], s64 offen offset:3072 sc1
    ds_read_b128 v[108:111], v252 offset:34816
    s_waitcnt lgkmcnt(4)
    v_mfma_f32_32x32x16_bf16 v[88:103], a[24:27], v[120:123], v[88:103]
    ds_read_b128 v[112:115], v253 offset:34816
    v_mfma_f32_32x32x16_bf16 v[72:87], a[28:31], v[124:127], v[72:87]
    s_add_u32 s64, s95, 8192
    buffer_load_dwordx4 a[160:163], v2, s[44:47], s64 offen offset:0 sc1
    ds_read_b128 v[116:119], v252 offset:36864
    s_waitcnt lgkmcnt(4)
    v_mfma_f32_32x32x16_bf16 v[88:103], a[28:31], v[128:131], v[88:103]
    ds_read_b128 v[120:123], v253 offset:36864
    v_mfma_f32_32x32x16_bf16 v[72:87], a[32:35], v[132:135], v[72:87]
    buffer_load_dwordx4 a[164:167], v2, s[44:47], s64 offen offset:1024 sc1
    ds_read_b128 v[124:127], v252 offset:38912
    s_waitcnt lgkmcnt(4)
    v_mfma_f32_32x32x16_bf16 v[88:103], a[32:35], v[104:107], v[88:103]
    ds_read_b128 v[128:131], v253 offset:38912
    v_mfma_f32_32x32x16_bf16 v[72:87], a[36:39], v[108:111], v[72:87]
    buffer_load_dwordx4 a[168:171], v2, s[44:47], s64 offen offset:2048 sc1
    ds_read_b128 v[132:135], v252 offset:40960
    s_getpc_b64 s[36:37]
L_pc_104:
    s_sub_u32 s36, s36, L_pc_104-interleave_layers__sliding_local_dilated__glu_gated_geglu__prompt_kernel
    s_subb_u32 s37, s37, 0
    s_and_b32 s37, s37, 0xffff
    s_mov_b32 s39, 0x20000
    s_mov_b32 s38, L_c34b-interleave_layers__sliding_local_dilated__glu_gated_geglu__prompt_kernel
    s_lshr_b32 s62, s2, 3
    s_lshl_b32 s62, s62, 2
    s_add_u32 s62, s62, s66
    s_lshl_b32 s62, s62, 7
    s_add_u32 s62, s62, (L_c1b-interleave_layers__sliding_local_dilated__glu_gated_geglu__prompt_kernel)&0xffffff80
    v_min_u32 v9, 7, v1
    v_lshl_add_u32 v9, v9, 14, s62
    buffer_load_dword v255, v9, s[36:39], 0 offen
    s_waitcnt lgkmcnt(4)
    v_mfma_f32_32x32x16_bf16 v[88:103], a[36:39], v[112:115], v[88:103]
    ds_read_b128 v[104:107], v253 offset:40960
    v_mfma_f32_32x32x16_bf16 v[72:87], a[40:43], v[116:119], v[72:87]
    buffer_load_dwordx4 a[172:175], v2, s[44:47], s64 offen offset:3072 sc1
    ds_read_b128 v[108:111], v252 offset:43008
    s_waitcnt lgkmcnt(4)
    v_mfma_f32_32x32x16_bf16 v[88:103], a[40:43], v[120:123], v[88:103]
    ds_read_b128 v[112:115], v253 offset:43008
    v_mfma_f32_32x32x16_bf16 v[72:87], a[44:47], v[124:127], v[72:87]
    s_add_u32 s64, s95, 12288
    buffer_load_dwordx4 a[176:179], v2, s[44:47], s64 offen offset:0 sc1
    ds_read_b128 v[116:119], v252 offset:45056
    s_waitcnt lgkmcnt(4)
    v_mfma_f32_32x32x16_bf16 v[88:103], a[44:47], v[128:131], v[88:103]
    ds_read_b128 v[120:123], v253 offset:45056
    v_mfma_f32_32x32x16_bf16 v[72:87], a[48:51], v[132:135], v[72:87]
    buffer_load_dwordx4 a[180:183], v2, s[44:47], s64 offen offset:1024 sc1
    ds_read_b128 v[124:127], v252 offset:47104
    s_waitcnt lgkmcnt(4)
    v_mfma_f32_32x32x16_bf16 v[88:103], a[48:51], v[104:107], v[88:103]
    ds_read_b128 v[128:131], v253 offset:47104
    v_mfma_f32_32x32x16_bf16 v[72:87], a[52:55], v[108:111], v[72:87]
    buffer_load_dwordx4 a[184:187], v2, s[44:47], s64 offen offset:2048 sc1
    s_waitcnt lgkmcnt(3)
    v_mfma_f32_32x32x16_bf16 v[88:103], a[52:55], v[112:115], v[88:103]
    v_mfma_f32_32x32x16_bf16 v[72:87], a[56:59], v[116:119], v[72:87]
    buffer_load_dwordx4 a[188:191], v2, s[44:47], s64 offen offset:3072 sc1
    s_waitcnt lgkmcnt(1)
    v_mfma_f32_32x32x16_bf16 v[88:103], a[56:59], v[120:123], v[88:103]
    v_mfma_f32_32x32x16_bf16 v[72:87], a[60:63], v[124:127], v[72:87]
    s_waitcnt lgkmcnt(0)
    v_mfma_f32_32x32x16_bf16 v[88:103], a[60:63], v[128:131], v[88:103]
    s_add_u32 s65, s94, 0x80000
    s_lshl_b32 s62, s66, 12
    s_add_u32 s62, s62, 0x20000
    v_add_u32 v144, s62, v2
    s_xor_b32 s62, s62, 0x1000
    v_add_u32 v145, s62, v2
    v_mov_b32 v146, 0
    v_mov_b32 v147, 0
    v_mov_b32 v148, 0
    v_mov_b32 v149, 0
    s_nop 3
    ds_write_b128 v144, v[88:91] offset:0
    ds_write_b128 v144, v[92:95] offset:1024
    ds_write_b128 v144, v[96:99] offset:2048
    ds_write_b128 v144, v[100:103] offset:3072
    s_waitcnt lgkmcnt(0)
    s_barrier
    ds_read_b128 v[88:91], v145 offset:0
    ds_read_b128 v[92:95], v145 offset:1024
    ds_read_b128 v[96:99], v145 offset:2048
    ds_read_b128 v[100:103], v145 offset:3072
    s_waitcnt lgkmcnt(3)
    v_pk_add_f32 v[72:73], v[72:73], v[88:89]
    v_pk_add_f32 v[74:75], v[74:75], v[90:91]
    v_cvt_pk_bf16_f32 v26, v72, v73
    v_cvt_pk_bf16_f32 v27, v74, v75
    s_waitcnt lgkmcnt(2)
    v_pk_add_f32 v[76:77], v[76:77], v[92:93]
    v_pk_add_f32 v[78:79], v[78:79], v[94:95]
    v_cvt_pk_bf16_f32 v28, v76, v77
    v_cvt_pk_bf16_f32 v29, v78, v79
    buffer_store_dwordx4 v[26:29], v3, s[24:27], s88 offen sc1
    s_waitcnt lgkmcnt(1)
    v_pk_add_f32 v[80:81], v[80:81], v[96:97]
    v_pk_add_f32 v[82:83], v[82:83], v[98:99]
    v_cvt_pk_bf16_f32 v30, v80, v81
    v_cvt_pk_bf16_f32 v31, v82, v83
    s_waitcnt lgkmcnt(0)
    v_pk_add_f32 v[84:85], v[84:85], v[100:101]
    v_pk_add_f32 v[86:87], v[86:87], v[102:103]
    v_cvt_pk_bf16_f32 v32, v84, v85
    v_cvt_pk_bf16_f32 v33, v86, v87
    buffer_store_dwordx4 v[30:33], v3, s[24:27], s88 offen offset:512 sc1
    v_dot2c_f32_bf16 v146, v26, v46
    v_dot2c_f32_bf16 v147, v26, v26
    v_dot2c_f32_bf16 v148, v27, v46
    v_dot2c_f32_bf16 v149, v27, v27
    v_dot2c_f32_bf16 v146, v28, v46
    v_dot2c_f32_bf16 v147, v28, v28
    v_dot2c_f32_bf16 v148, v29, v46
    v_dot2c_f32_bf16 v149, v29, v29
    v_dot2c_f32_bf16 v146, v30, v46
    v_dot2c_f32_bf16 v147, v30, v30
    v_dot2c_f32_bf16 v148, v31, v46
    v_dot2c_f32_bf16 v149, v31, v31
    v_dot2c_f32_bf16 v146, v32, v46
    v_dot2c_f32_bf16 v147, v32, v32
    v_dot2c_f32_bf16 v148, v33, v46
    v_dot2c_f32_bf16 v149, v33, v33
    s_nop 2
    v_add_f32 v146, v146, v148
    v_add_f32 v147, v147, v149
    v_mov_b32 v148, v146
    v_mov_b32 v149, v147
    s_nop 1
    v_permlane32_swap_b32 v146, v148
    v_permlane32_swap_b32 v147, v149
    s_nop 0
    v_add_f32 v146, v146, v148
    v_add_f32 v147, v147, v149
    buffer_store_dwordx2 v[146:147], v19, s[24:27], s65 offen sc1
    s_add_u32 s64, s95, 16384
    buffer_load_dwordx4 a[192:195], v2, s[44:47], s64 offen offset:0 sc1
    buffer_load_dwordx4 a[196:199], v2, s[44:47], s64 offen offset:1024 sc1
    buffer_load_dwordx4 a[200:203], v2, s[44:47], s64 offen offset:2048 sc1
    buffer_load_dwordx4 a[204:207], v2, s[44:47], s64 offen offset:3072 sc1
    s_add_u32 s64, s95, 20480
    buffer_load_dwordx4 a[208:211], v2, s[44:47], s64 offen offset:0 sc1
    buffer_load_dwordx4 a[212:215], v2, s[44:47], s64 offen offset:1024 sc1
    buffer_load_dwordx4 a[216:219], v2, s[44:47], s64 offen offset:2048 sc1
    buffer_load_dwordx4 a[220:223], v2, s[44:47], s64 offen offset:3072 sc1
    s_waitcnt vmcnt(8)
    s_barrier
    s_cmp_lg_u32 s66, 0
    s_cbranch_scc1 L_sig_105
    s_mov_b64 exec, 0xffff
    s_cmp_eq_u32 s67, 31
    s_cselect_b32 exec_lo, 0xff, exec_lo
    v_mov_b32 v52, 0x1000000
    buffer_atomic_add v52, v6, s[24:27], 0 offen offset:0 sc1
    s_mov_b64 exec, -1
L_sig_105:
    s_add_u32 s64, s95, 24576
    buffer_load_dwordx4 a[224:227], v2, s[44:47], s64 offen offset:0 sc1
    buffer_load_dwordx4 a[228:231], v2, s[44:47], s64 offen offset:1024 sc1
    buffer_load_dwordx4 a[232:235], v2, s[44:47], s64 offen offset:2048 sc1
    buffer_load_dwordx4 a[236:239], v2, s[44:47], s64 offen offset:3072 sc1
    s_add_u32 s64, s95, 28672
    buffer_load_dwordx4 a[240:243], v2, s[44:47], s64 offen offset:0 sc1
    buffer_load_dwordx4 a[244:247], v2, s[44:47], s64 offen offset:1024 sc1
    buffer_load_dwordx4 a[248:251], v2, s[44:47], s64 offen offset:2048 sc1
    buffer_load_dwordx4 a[252:255], v2, s[44:47], s64 offen offset:3072 sc1
    s_add_u32 s64, s95, 32768
    buffer_load_dwordx4 a[0:3], v2, s[44:47], s64 offen offset:0 sc1
    s_cmp_lg_u32 s66, 1
    s_cbranch_scc1 L_w1_106
    s_cmp_eq_u32 s67, 0
    s_cselect_b32 s65, 8, 16
    v_mov_b32 v51, s86
    v_mov_b32 v53, s65
    s_mov_b64 exec, 1
    v_mov_b32 v52, 0
    buffer_atomic_add v52, v51, s[24:27], 0 offen sc0 sc1
    s_mov_b64 exec, -1
L_w1_106:
    buffer_load_dwordx4 a[4:7], v2, s[44:47], s64 offen offset:1024 sc1
    buffer_load_dwordx4 a[8:11], v2, s[44:47], s64 offen offset:2048 sc1
    buffer_load_dwordx4 a[12:15], v2, s[44:47], s64 offen offset:3072 sc1
    s_cmp_lg_u32 s66, 1
    s_cbranch_scc1 L_w1_107
    s_mov_b64 exec, 1
    v_mov_b32 v5, 0
    buffer_atomic_add v5, v51, s[24:27], 0 offen sc0 sc1
    s_mov_b64 exec, -1
L_w1_107:
L_c1b:
    s_mov_b32 s71, 1
    s_mov_b32 s96, 18
    s_mov_b32 s3, 8
    s_mov_b32 s91, 32
    s_add_u32 s92, s92, 0x400000
    s_add_u32 s93, s93, 0x400000
    s_add_u32 s94, s94, 0x40000
    v_add_u32 v10, 40960, v15
    s_and_b32 s62, s67, 15
    s_lshl_b32 s62, s62, 17
    s_xor_b32 s63, s98, 0x2000
    s_add_u32 s62, s62, s63
    s_lshl_b32 s63, s72, 10
    s_add_u32 s62, s62, s63
    s_lshl_b32 s63, s73, 15
    s_add_u32 s75, s62, s63
    s_sub_u32 s74, s75, 32768
    s_cselect_b32 s63, 0x2000, 0
    s_xor_b32 s74, s74, s63
    s_and_b32 s74, s74, 0x1fffff
    s_add_u32 s74, s74, 0xe00000
    s_add_u32 s75, s75, 0xe08000
    s_lshl_b32 s63, s73, 11
    s_add_u32 s76, s62, s63
    s_add_u32 s76, s76, 0xe18000
    s_or_b32 s63, s67, s73
    s_cmp_eq_u32 s63, 0
    s_cselect_b32 s74, 0x80000000, s74
    s_lshl_b32 s77, s66, 10
    s_add_u32 s77, s77, 65536
    s_add_u32 s78, s77, 4096
    s_mul_i32 s63, s73, 10240
    s_lshl_b32 s79, s72, 10
    s_add_u32 s79, s79, s63
    s_add_u32 s79, s79, 73728
    s_cmp_lg_u32 s66, 1
    s_cbranch_scc1 L_w1_108
    s_mov_b64 exec, 1
    s_mov_b32 s90, 0
    s_waitcnt vmcnt(4)
    v_bfe_u32 v52, v52, 24, 6
    v_cmp_ne_u32 vcc, v53, v52
    s_cbranch_vccz L_mpd_110
L_mp_109:
    s_waitcnt vmcnt(0)
    v_bfe_u32 v5, v5, 24, 6
    v_cmp_ne_u32 vcc, v53, v5
    s_cbranch_vccz L_mpd_110
    v_mov_b32 v5, 0
    buffer_atomic_add v5, v51, s[24:27], 0 offen sc0 sc1
    s_add_u32 s90, s90, 1
    s_cmp_lt_u32 s90, 0x2000
    s_cbranch_scc1 L_mp_109
    v_mov_b32 v53, 262
    buffer_store_dword v53, v55, s[48:51], 0 offen offset:4
L_mpd_110:
    s_mov_b64 exec, -1
L_w1_108:
    s_barrier
    s_add_u32 m0, s77, 0
    s_nop 0
    buffer_load_dwordx4 v2, s[24:27], s74 offen sc1 lds
    s_add_u32 m0, s78, 0
    s_nop 0
    buffer_load_dwordx4 v2, s[24:27], s75 offen sc1 lds
    s_add_u32 m0, s79, 0
    s_nop 0
    buffer_load_dwordx4 v2, s[24:27], s76 offen sc1 lds
    s_add_u32 m0, s77, 10240
    s_add_u32 s74, s74, 2048
    buffer_load_dwordx4 v2, s[24:27], s74 offen sc1 lds
    s_add_u32 m0, s78, 10240
    s_add_u32 s75, s75, 2048
    buffer_load_dwordx4 v2, s[24:27], s75 offen sc1 lds
    s_barrier
    s_add_u32 m0, s77, 20480
    s_add_u32 s74, s74, 2048
    buffer_load_dwordx4 v2, s[24:27], s74 offen sc1 lds
    s_add_u32 m0, s78, 20480
    s_add_u32 s75, s75, 2048
    buffer_load_dwordx4 v2, s[24:27], s75 offen sc1 lds
    s_add_u32 m0, s79, 20480
    s_add_u32 s76, s76, 4096
    buffer_load_dwordx4 v2, s[24:27], s76 offen sc1 lds
    s_add_u32 m0, s77, 30720
    s_add_u32 s74, s74, 2048
    buffer_load_dwordx4 v2, s[24:27], s74 offen sc1 lds
    s_add_u32 m0, s78, 30720
    s_add_u32 s75, s75, 2048
    buffer_load_dwordx4 v2, s[24:27], s75 offen sc1 lds
    s_waitcnt vmcnt(5)
    s_barrier
    ds_read_b128 v[112:115], v15 offset:0
    ds_read_b128 v[116:119], v15 offset:2048
    ds_read_b128 v[120:123], v15 offset:4096
    ds_read_b128 v[124:127], v15 offset:6144
    ds_read_b128 v[128:131], v15 offset:8192
    s_waitcnt lgkmcnt(3)
    v_mfma_f32_16x16x32_bf16 v[72:75], a[132:135], v[112:115], 0
    ds_read_b128 v[132:135], v15 offset:1024
    v_mfma_f32_16x16x32_bf16 v[92:95], v[112:115], a[136:139], 0
    s_add_u32 m0, s77, 40960
    s_add_u32 s74, s74, 10240
    buffer_load_dwordx4 v2, s[24:27], s74 offen sc1 lds
    v_mfma_f32_16x16x32_bf16 v[76:79], a[132:135], v[116:119], 0
    ds_read_b128 v[136:139], v15 offset:3072
    v_mfma_f32_16x16x32_bf16 v[96:99], v[116:119], a[136:139], 0
    v_mfma_f32_16x16x32_bf16 v[56:59], a[128:131], v[116:119], 0
    ds_read_b128 v[140:143], v15 offset:5120
    s_waitcnt lgkmcnt(3)
    v_mfma_f32_16x16x32_bf16 v[80:83], a[132:135], v[120:123], 0
    s_add_u32 m0, s78, 40960
    s_add_u32 s75, s75, 10240
    buffer_load_dwordx4 v2, s[24:27], s75 offen sc1 lds
    v_mfma_f32_16x16x32_bf16 v[100:103], v[120:123], a[136:139], 0
    ds_read_b128 v[144:147], v15 offset:7168
    v_mfma_f32_16x16x32_bf16 v[60:63], a[128:131], v[120:123], 0
    v_mfma_f32_16x16x32_bf16 v[84:87], a[132:135], v[124:127], 0
    ds_read_b128 v[148:151], v15 offset:9216
    v_mfma_f32_16x16x32_bf16 v[104:107], v[124:127], a[136:139], 0
    s_add_u32 m0, s79, 40960
    s_add_u32 s76, s76, 12288
    buffer_load_dwordx4 v2, s[24:27], s76 offen sc1 lds
    v_mfma_f32_16x16x32_bf16 v[64:67], a[128:131], v[124:127], 0
    v_mfma_f32_16x16x32_bf16 v[88:91], a[132:135], v[128:131], 0
    v_mfma_f32_16x16x32_bf16 v[108:111], v[128:131], a[136:139], 0
    v_mfma_f32_16x16x32_bf16 v[68:71], a[128:131], v[128:131], 0
    s_add_u32 m0, s77, 51200
    s_add_u32 s74, s74, 2048
    buffer_load_dwordx4 v2, s[24:27], s74 offen sc1 lds
    s_waitcnt lgkmcnt(3)
    v_mfma_f32_16x16x32_bf16 v[72:75], a[144:147], v[132:135], v[72:75]
    ds_read_b128 v[112:115], v15 offset:10240
    v_mfma_f32_16x16x32_bf16 v[92:95], v[132:135], a[148:151], v[92:95]
    v_mfma_f32_16x16x32_bf16 v[76:79], a[144:147], v[136:139], v[76:79]
    ds_read_b128 v[116:119], v15 offset:12288
    v_mfma_f32_16x16x32_bf16 v[96:99], v[136:139], a[148:151], v[96:99]
    s_add_u32 m0, s78, 51200
    s_add_u32 s75, s75, 2048
    buffer_load_dwordx4 v2, s[24:27], s75 offen sc1 lds
    v_mfma_f32_16x16x32_bf16 v[56:59], a[140:143], v[136:139], v[56:59]
    ds_read_b128 v[120:123], v15 offset:14336
    s_waitcnt lgkmcnt(3)
    v_mfma_f32_16x16x32_bf16 v[80:83], a[144:147], v[140:143], v[80:83]
    v_mfma_f32_16x16x32_bf16 v[100:103], v[140:143], a[148:151], v[100:103]
    ds_read_b128 v[124:127], v15 offset:16384
    v_mfma_f32_16x16x32_bf16 v[60:63], a[140:143], v[140:143], v[60:63]
    s_add_u32 m0, s77, 61440
    s_add_u32 s74, s74, 2048
    buffer_load_dwordx4 v2, s[24:27], s74 offen sc1 lds
    v_mfma_f32_16x16x32_bf16 v[84:87], a[144:147], v[144:147], v[84:87]
    ds_read_b128 v[128:131], v15 offset:18432
    v_mfma_f32_16x16x32_bf16 v[104:107], v[144:147], a[148:151], v[104:107]
    v_mfma_f32_16x16x32_bf16 v[64:67], a[140:143], v[144:147], v[64:67]
    v_mfma_f32_16x16x32_bf16 v[88:91], a[144:147], v[148:151], v[88:91]
    s_add_u32 m0, s78, 61440
    s_add_u32 s75, s75, 2048
    buffer_load_dwordx4 v2, s[24:27], s75 offen sc1 lds
    v_mfma_f32_16x16x32_bf16 v[108:111], v[148:151], a[148:151], v[108:111]
    v_mfma_f32_16x16x32_bf16 v[68:71], a[140:143], v[148:151], v[68:71]
    s_waitcnt lgkmcnt(3)
    v_mfma_f32_16x16x32_bf16 v[72:75], a[156:159], v[112:115], v[72:75]
    ds_read_b128 v[132:135], v15 offset:11264
    v_mfma_f32_16x16x32_bf16 v[92:95], v[112:115], a[160:163], v[92:95]
    s_add_u32 m0, s79, 61440
    s_add_u32 s76, s76, 4096
    buffer_load_dwordx4 v2, s[24:27], s76 offen sc1 lds
    v_mfma_f32_16x16x32_bf16 v[76:79], a[156:159], v[116:119], v[76:79]
    ds_read_b128 v[136:139], v15 offset:13312
    v_mfma_f32_16x16x32_bf16 v[96:99], v[116:119], a[160:163], v[96:99]
    v_mfma_f32_16x16x32_bf16 v[56:59], a[152:155], v[116:119], v[56:59]
    ds_read_b128 v[140:143], v15 offset:15360
    s_waitcnt lgkmcnt(3)
    v_mfma_f32_16x16x32_bf16 v[80:83], a[156:159], v[120:123], v[80:83]
    s_add_u32 m0, s77, 71680
    s_add_u32 s74, s74, 2048
    buffer_load_dwordx4 v2, s[24:27], s74 offen sc1 lds
    v_mfma_f32_16x16x32_bf16 v[100:103], v[120:123], a[160:163], v[100:103]
    ds_read_b128 v[144:147], v15 offset:17408
    v_mfma_f32_16x16x32_bf16 v[60:63], a[152:155], v[120:123], v[60:63]
    v_mfma_f32_16x16x32_bf16 v[84:87], a[156:159], v[124:127], v[84:87]
    ds_read_b128 v[148:151], v15 offset:19456
    v_mfma_f32_16x16x32_bf16 v[104:107], v[124:127], a[160:163], v[104:107]
    s_add_u32 m0, s78, 71680
    s_add_u32 s75, s75, 2048
    buffer_load_dwordx4 v2, s[24:27], s75 offen sc1 lds
    v_mfma_f32_16x16x32_bf16 v[64:67], a[152:155], v[124:127], v[64:67]
    s_and_b32 s65, s67, 15
    s_lshl_b32 s65, s65, 2
    s_add_u32 s62, s65, s66
    s_lshl_b32 s62, s62, 7
    s_add_u32 s62, s62, s98
    s_add_u32 s62, s62, 0x5c0000
    s_lshl_b32 s65, s65, 7
    s_add_u32 s65, s65, s98
    s_sub_u32 s65, s65, 128
    s_and_b32 s65, s65, 0x3fff
    s_add_u32 s65, s65, 0x5c0000
    buffer_load_dwordx2 v[176:177], v21, s[24:27], s62 offen sc1
    v_mfma_f32_16x16x32_bf16 v[88:91], a[156:159], v[128:131], v[88:91]
    s_add_u32 s62, s62, 0x10000
    buffer_load_dwordx2 v[178:179], v21, s[24:27], s62 offen sc1
    v_mfma_f32_16x16x32_bf16 v[108:111], v[128:131], a[160:163], v[108:111]
    s_add_u32 s62, s62, 0x10000
    buffer_load_dwordx2 v[180:181], v21, s[24:27], s62 offen sc1
    v_mfma_f32_16x16x32_bf16 v[68:71], a[152:155], v[128:131], v[68:71]
    s_add_u32 s62, s62, 0x10000
    buffer_load_dwordx2 v[182:183], v21, s[24:27], s62 offen sc1
    s_waitcnt vmcnt(14)
    s_barrier
    s_waitcnt lgkmcnt(3)
    v_mfma_f32_16x16x32_bf16 v[72:75], a[168:171], v[132:135], v[72:75]
    ds_read_b128 v[112:115], v15 offset:20480
    v_mfma_f32_16x16x32_bf16 v[92:95], v[132:135], a[172:175], v[92:95]
    buffer_load_dwordx2 v[184:185], v21, s[24:27], s65 offen sc1
    v_mfma_f32_16x16x32_bf16 v[76:79], a[168:171], v[136:139], v[76:79]
    ds_read_b128 v[116:119], v15 offset:22528
    v_mfma_f32_16x16x32_bf16 v[96:99], v[136:139], a[172:175], v[96:99]
    s_add_u32 s65, s65, 0x10000
    buffer_load_dwordx2 v[186:187], v21, s[24:27], s65 offen sc1
    v_mfma_f32_16x16x32_bf16 v[56:59], a[164:167], v[136:139], v[56:59]
    ds_read_b128 v[120:123], v15 offset:24576
    s_waitcnt lgkmcnt(3)
    v_mfma_f32_16x16x32_bf16 v[80:83], a[168:171], v[140:143], v[80:83]
    s_add_u32 s65, s65, 0x10000
    buffer_load_dwordx2 v[188:189], v21, s[24:27], s65 offen sc1
    v_mfma_f32_16x16x32_bf16 v[100:103], v[140:143], a[172:175], v[100:103]
    ds_read_b128 v[124:127], v15 offset:26624
    v_mfma_f32_16x16x32_bf16 v[60:63], a[164:167], v[140:143], v[60:63]
    s_add_u32 s65, s65, 0x10000
    buffer_load_dwordx2 v[190:191], v21, s[24:27], s65 offen sc1
    v_mfma_f32_16x16x32_bf16 v[84:87], a[168:171], v[144:147], v[84:87]
    ds_read_b128 v[128:131], v15 offset:28672
    v_mfma_f32_16x16x32_bf16 v[104:107], v[144:147], a[172:175], v[104:107]
    s_add_u32 s64, s95, 36864
    buffer_load_dwordx4 a[16:19], v2, s[44:47], s64 offen offset:0 sc1
    v_mfma_f32_16x16x32_bf16 v[64:67], a[164:167], v[144:147], v[64:67]
    v_mfma_f32_16x16x32_bf16 v[88:91], a[168:171], v[148:151], v[88:91]
    v_mfma_f32_16x16x32_bf16 v[108:111], v[148:151], a[172:175], v[108:111]
    v_mfma_f32_16x16x32_bf16 v[68:71], a[164:167], v[148:151], v[68:71]
    buffer_load_dwordx4 a[20:23], v2, s[44:47], s64 offen offset:1024 sc1
    s_waitcnt lgkmcnt(3)
    v_mfma_f32_16x16x32_bf16 v[72:75], a[180:183], v[112:115], v[72:75]
    ds_read_b128 v[132:135], v15 offset:21504
    v_mfma_f32_16x16x32_bf16 v[92:95], v[112:115], a[184:187], v[92:95]
    v_mfma_f32_16x16x32_bf16 v[76:79], a[180:183], v[116:119], v[76:79]
    ds_read_b128 v[136:139], v15 offset:23552
    v_mfma_f32_16x16x32_bf16 v[96:99], v[116:119], a[184:187], v[96:99]
    buffer_load_dwordx4 a[24:27], v2, s[44:47], s64 offen offset:2048 sc1
    v_mfma_f32_16x16x32_bf16 v[56:59], a[176:179], v[116:119], v[56:59]
    ds_read_b128 v[140:143], v15 offset:25600
    s_waitcnt lgkmcnt(3)
    v_mfma_f32_16x16x32_bf16 v[80:83], a[180:183], v[120:123], v[80:83]
    v_mfma_f32_16x16x32_bf16 v[100:103], v[120:123], a[184:187], v[100:103]
    ds_read_b128 v[144:147], v15 offset:27648
    v_mfma_f32_16x16x32_bf16 v[60:63], a[176:179], v[120:123], v[60:63]
    buffer_load_dwordx4 a[28:31], v2, s[44:47], s64 offen offset:3072 sc1
    v_mfma_f32_16x16x32_bf16 v[84:87], a[180:183], v[124:127], v[84:87]
    ds_read_b128 v[148:151], v15 offset:29696
    v_mfma_f32_16x16x32_bf16 v[104:107], v[124:127], a[184:187], v[104:107]
    v_mfma_f32_16x16x32_bf16 v[64:67], a[176:179], v[124:127], v[64:67]
    v_mfma_f32_16x16x32_bf16 v[88:91], a[180:183], v[128:131], v[88:91]
    s_add_u32 s64, s95, 40960
    buffer_load_dwordx4 a[32:35], v2, s[44:47], s64 offen offset:0 sc1
    v_mfma_f32_16x16x32_bf16 v[108:111], v[128:131], a[184:187], v[108:111]
    v_mfma_f32_16x16x32_bf16 v[68:71], a[176:179], v[128:131], v[68:71]
    s_waitcnt vmcnt(5)
    s_waitcnt lgkmcnt(3)
    v_mfma_f32_16x16x32_bf16 v[72:75], a[192:195], v[132:135], v[72:75]
    ds_read_b128 v[112:115], v15 offset:30720
    v_add_f32 v176, v176, v178
    v_mfma_f32_16x16x32_bf16 v[92:95], v[132:135], a[196:199], v[92:95]
    buffer_load_dwordx4 a[36:39], v2, s[44:47], s64 offen offset:1024 sc1
    v_mfma_f32_16x16x32_bf16 v[76:79], a[192:195], v[136:139], v[76:79]
    ds_read_b128 v[116:119], v15 offset:32768
    v_add_f32 v180, v180, v182
    v_mfma_f32_16x16x32_bf16 v[96:99], v[136:139], a[196:199], v[96:99]
    v_add_f32 v177, v177, v179
    v_add_f32 v181, v181, v183
    v_mfma_f32_16x16x32_bf16 v[56:59], a[188:191], v[136:139], v[56:59]
    ds_read_b128 v[120:123], v15 offset:34816
    v_add_f32 v208, v176, v180
    s_waitcnt lgkmcnt(3)
    v_mfma_f32_16x16x32_bf16 v[80:83], a[192:195], v[140:143], v[80:83]
    buffer_load_dwordx4 a[40:43], v2, s[44:47], s64 offen offset:2048 sc1
    v_mfma_f32_16x16x32_bf16 v[100:103], v[140:143], a[196:199], v[100:103]
    ds_read_b128 v[124:127], v15 offset:36864
    v_add_f32 v209, v177, v181
    v_mfma_f32_16x16x32_bf16 v[60:63], a[188:191], v[140:143], v[60:63]
    v_add_f32 v184, v184, v186
    v_add_f32 v188, v188, v190
    v_mfma_f32_16x16x32_bf16 v[84:87], a[192:195], v[144:147], v[84:87]
    ds_read_b128 v[128:131], v15 offset:38912
    v_add_f32 v185, v185, v187
    v_mfma_f32_16x16x32_bf16 v[104:107], v[144:147], a[196:199], v[104:107]
    buffer_load_dwordx4 a[44:47], v2, s[44:47], s64 offen offset:3072 sc1
    v_mfma_f32_16x16x32_bf16 v[64:67], a[188:191], v[144:147], v[64:67]
    v_add_f32 v189, v189, v191
    v_add_f32 v210, v184, v188
    v_mfma_f32_16x16x32_bf16 v[88:91], a[192:195], v[148:151], v[88:91]
    v_add_f32 v211, v185, v189
    v_mov_b32 v176, v208
    v_mfma_f32_16x16x32_bf16 v[108:111], v[148:151], a[196:199], v[108:111]
    v_mov_b32 v177, v209
    v_mov_b32 v178, v210
    v_mfma_f32_16x16x32_bf16 v[68:71], a[188:191], v[148:151], v[68:71]
    s_add_u32 s64, s95, 45056
    buffer_load_dwordx4 a[48:51], v2, s[44:47], s64 offen offset:0 sc1
    s_waitcnt lgkmcnt(3)
    v_mfma_f32_16x16x32_bf16 v[72:75], a[204:207], v[112:115], v[72:75]
    ds_read_b128 v[132:135], v15 offset:31744
    v_mov_b32 v179, v211
    v_mfma_f32_16x16x32_bf16 v[92:95], v[112:115], a[208:211], v[92:95]
    v_permlane16_swap_b32 v208, v176
    v_permlane16_swap_b32 v209, v177
    v_mfma_f32_16x16x32_bf16 v[76:79], a[204:207], v[116:119], v[76:79]
    ds_read_b128 v[136:139], v15 offset:33792
    v_permlane16_swap_b32 v210, v178
    v_mfma_f32_16x16x32_bf16 v[96:99], v[116:119], a[208:211], v[96:99]
    buffer_load_dwordx4 a[52:55], v2, s[44:47], s64 offen offset:1024 sc1
    v_mfma_f32_16x16x32_bf16 v[56:59], a[200:203], v[116:119], v[56:59]
    ds_read_b128 v[140:143], v15 offset:35840
    v_permlane16_swap_b32 v211, v179
    s_waitcnt lgkmcnt(3)
    v_mfma_f32_16x16x32_bf16 v[80:83], a[204:207], v[120:123], v[80:83]
    v_add_f32 v208, v208, v176
    v_add_f32 v209, v209, v177
    v_mfma_f32_16x16x32_bf16 v[100:103], v[120:123], a[208:211], v[100:103]
    ds_read_b128 v[144:147], v15 offset:37888
    v_add_f32 v210, v210, v178
    v_mfma_f32_16x16x32_bf16 v[60:63], a[200:203], v[120:123], v[60:63]
    buffer_load_dwordx4 a[56:59], v2, s[44:47], s64 offen offset:2048 sc1
    v_mfma_f32_16x16x32_bf16 v[84:87], a[204:207], v[124:127], v[84:87]
    ds_read_b128 v[148:151], v15 offset:39936
    v_add_f32 v211, v211, v179
    v_mfma_f32_16x16x32_bf16 v[104:107], v[124:127], a[208:211], v[104:107]
    v_mov_b32 v176, v208
    v_mov_b32 v177, v209
    v_mfma_f32_16x16x32_bf16 v[64:67], a[200:203], v[124:127], v[64:67]
    v_mov_b32 v178, v210
    v_mov_b32 v179, v211
    v_mfma_f32_16x16x32_bf16 v[88:91], a[204:207], v[128:131], v[88:91]
    buffer_load_dwordx4 a[60:63], v2, s[44:47], s64 offen offset:3072 sc1
    v_mfma_f32_16x16x32_bf16 v[108:111], v[128:131], a[208:211], v[108:111]
    v_permlane32_swap_b32 v208, v176
    v_permlane32_swap_b32 v209, v177
    v_mfma_f32_16x16x32_bf16 v[68:71], a[200:203], v[128:131], v[68:71]
    v_permlane32_swap_b32 v210, v178
    v_permlane32_swap_b32 v211, v179
    s_barrier
    s_waitcnt lgkmcnt(3)
    v_mfma_f32_16x16x32_bf16 v[72:75], a[216:219], v[132:135], v[72:75]
    ds_read_b128 v[112:115], v10 offset:0
    v_add_f32 v208, v208, v176
    v_mfma_f32_16x16x32_bf16 v[92:95], v[132:135], a[220:223], v[92:95]
    s_lshl_b32 s88, s73, 18
    s_lshl_b32 s89, s72, 16
    s_add_u32 s88, s88, s89
    s_add_u32 m0, s82, 0
    s_add_u32 s63, s88, 0x0
    buffer_load_dwordx4 v11, s[32:35], s63 offen lds
    v_mfma_f32_16x16x32_bf16 v[76:79], a[216:219], v[136:139], v[76:79]
    ds_read_b128 v[116:119], v10 offset:2048
    v_add_f32 v209, v209, v177
    v_mfma_f32_16x16x32_bf16 v[96:99], v[136:139], a[220:223], v[96:99]
    v_add_f32 v210, v210, v178
    v_add_f32 v211, v211, v179
    v_mfma_f32_16x16x32_bf16 v[56:59], a[212:215], v[136:139], v[56:59]
    ds_read_b128 v[120:123], v10 offset:4096
    v_mul_f32 v180, 0x3b000000, v208
    s_waitcnt lgkmcnt(3)
    v_mfma_f32_16x16x32_bf16 v[80:83], a[216:219], v[140:143], v[80:83]
    buffer_load_dwordx4 v12, s[32:35], s63 offen offset:1024 lds
    v_mfma_f32_16x16x32_bf16 v[100:103], v[140:143], a[220:223], v[100:103]
    ds_read_b128 v[124:127], v10 offset:6144
    v_mul_f32 v184, v180, v180
    v_mfma_f32_16x16x32_bf16 v[60:63], a[212:215], v[140:143], v[60:63]
    v_mov_b32 v181, 0x3b000000
    v_fma_f32 v184, v209, v181, -v184
    v_mfma_f32_16x16x32_bf16 v[84:87], a[216:219], v[144:147], v[84:87]
    ds_read_b128 v[128:131], v10 offset:8192
    v_max_f32 v184, 0, v184
    v_mfma_f32_16x16x32_bf16 v[104:107], v[144:147], a[220:223], v[104:107]
    s_add_u32 m0, s82, 2048
    s_add_u32 s63, s88, 0x4000
    buffer_load_dwordx4 v11, s[32:35], s63 offen lds
    v_mfma_f32_16x16x32_bf16 v[64:67], a[212:215], v[144:147], v[64:67]
    v_add_f32 v184, 0x3727c5ac, v184
    v_rsq_f32 v181, v184
    v_mfma_f32_16x16x32_bf16 v[88:91], a[216:219], v[148:151], v[88:91]
    v_mul_f32 v182, 0x3b000000, v210
    v_mul_f32 v185, v182, v182
    v_mfma_f32_16x16x32_bf16 v[108:111], v[148:151], a[220:223], v[108:111]
    v_mov_b32 v183, 0x3b000000
    v_fma_f32 v185, v211, v183, -v185
    v_mfma_f32_16x16x32_bf16 v[68:71], a[212:215], v[148:151], v[68:71]
    buffer_load_dwordx4 v12, s[32:35], s63 offen offset:1024 lds
    s_waitcnt lgkmcnt(3)
    v_mfma_f32_16x16x32_bf16 v[72:75], a[228:231], v[112:115], v[72:75]
    ds_read_b128 v[132:135], v10 offset:1024
    v_max_f32 v185, 0, v185
    v_mfma_f32_16x16x32_bf16 v[92:95], v[112:115], a[232:235], v[92:95]
    v_add_f32 v185, 0x3727c5ac, v185
    v_rsq_f32 v183, v185
    v_mfma_f32_16x16x32_bf16 v[76:79], a[228:231], v[116:119], v[76:79]
    ds_read_b128 v[136:139], v10 offset:3072
    v_and_b32 v186, 15, v1
    v_mfma_f32_16x16x32_bf16 v[96:99], v[116:119], a[232:235], v[96:99]
    s_add_u32 m0, s82, 4096
    s_add_u32 s63, s88, 0x8000
    buffer_load_dwordx4 v11, s[32:35], s63 offen lds
    v_mfma_f32_16x16x32_bf16 v[56:59], a[224:227], v[116:119], v[56:59]
    ds_read_b128 v[140:143], v10 offset:5120
    s_add_u32 s85, s66, 1
    s_waitcnt lgkmcnt(3)
    v_mfma_f32_16x16x32_bf16 v[80:83], a[228:231], v[120:123], v[80:83]
    s_lshl_b32 s85, s85, 4
    v_cndmask_b32 v182, 0, v182, s[60:61]
    v_mfma_f32_16x16x32_bf16 v[100:103], v[120:123], a[232:235], v[100:103]
    ds_read_b128 v[144:147], v10 offset:7168
    v_cndmask_b32 v183, 0, v183, s[60:61]
    v_mfma_f32_16x16x32_bf16 v[60:63], a[224:227], v[120:123], v[60:63]
    buffer_load_dwordx4 v12, s[32:35], s63 offen offset:1024 lds
    v_mfma_f32_16x16x32_bf16 v[84:87], a[228:231], v[124:127], v[84:87]
    ds_read_b128 v[148:151], v10 offset:9216
    v_add_u32 v187, s85, v186
    v_mfma_f32_16x16x32_bf16 v[104:107], v[124:127], a[232:235], v[104:107]
    v_lshlrev_b32 v188, 3, v186
    v_lshlrev_b32 v189, 3, v187
    v_mfma_f32_16x16x32_bf16 v[64:67], a[224:227], v[124:127], v[64:67]
    v_lshlrev_b32 v186, 2, v186
    v_lshlrev_b32 v187, 2, v187
    v_mfma_f32_16x16x32_bf16 v[88:91], a[228:231], v[128:131], v[88:91]
    s_add_u32 m0, s82, 6144
    s_add_u32 s63, s88, 0xc000
    buffer_load_dwordx4 v11, s[32:35], s63 offen lds
    v_mfma_f32_16x16x32_bf16 v[108:111], v[128:131], a[232:235], v[108:111]
    v_add_u32 v186, 0x26000, v186
    v_add_u32 v187, 0x26000, v187
    v_mfma_f32_16x16x32_bf16 v[68:71], a[224:227], v[128:131], v[68:71]
    v_add_u32 v188, 0x26000, v188
    v_add_u32 v189, 0x26000, v189
    s_waitcnt lgkmcnt(3)
    v_mfma_f32_16x16x32_bf16 v[72:75], a[240:243], v[132:135], v[72:75]
    ds_read_b128 v[112:115], v10 offset:10240
    ds_write_b64 v189, v[180:181]
    v_mfma_f32_16x16x32_bf16 v[92:95], v[132:135], a[244:247], v[92:95]
    buffer_load_dwordx4 v12, s[32:35], s63 offen offset:1024 lds
    v_mfma_f32_16x16x32_bf16 v[76:79], a[240:243], v[136:139], v[76:79]
    ds_read_b128 v[116:119], v10 offset:12288
    ds_write_b64 v188, v[182:183]
    v_mfma_f32_16x16x32_bf16 v[96:99], v[136:139], a[244:247], v[96:99]
    ds_write_b32 v187, v180 offset:640
    ds_write_b32 v186, v182 offset:640
    v_mfma_f32_16x16x32_bf16 v[56:59], a[236:239], v[136:139], v[56:59]
    ds_read_b128 v[120:123], v10 offset:14336
    ds_write_b32 v187, v181 offset:960
    s_waitcnt lgkmcnt(8)
    v_mfma_f32_16x16x32_bf16 v[80:83], a[240:243], v[140:143], v[80:83]
    s_lshl_b32 s88, s73, 18
    s_lshl_b32 s89, s72, 16
    s_add_u32 s88, s88, s89
    s_add_u32 m0, s82, 32768
    s_add_u32 s63, s88, 0x20000
    buffer_load_dwordx4 v11, s[32:35], s63 offen lds
    v_mfma_f32_16x16x32_bf16 v[100:103], v[140:143], a[244:247], v[100:103]
    ds_read_b128 v[124:127], v10 offset:16384
    ds_write_b32 v186, v183 offset:960
    v_mfma_f32_16x16x32_bf16 v[60:63], a[236:239], v[140:143], v[60:63]
    v_mfma_f32_16x16x32_bf16 v[84:87], a[240:243], v[144:147], v[84:87]
    ds_read_b128 v[128:131], v10 offset:18432
    v_mfma_f32_16x16x32_bf16 v[104:107], v[144:147], a[244:247], v[104:107]
    buffer_load_dwordx4 v12, s[32:35], s63 offen offset:1024 lds
    v_mfma_f32_16x16x32_bf16 v[64:67], a[236:239], v[144:147], v[64:67]
    v_mfma_f32_16x16x32_bf16 v[88:91], a[240:243], v[148:151], v[88:91]
    v_mfma_f32_16x16x32_bf16 v[108:111], v[148:151], a[244:247], v[108:111]
    v_mfma_f32_16x16x32_bf16 v[68:71], a[236:239], v[148:151], v[68:71]
    s_add_u32 m0, s82, 34816
    s_add_u32 s63, s88, 0x24000
    buffer_load_dwordx4 v11, s[32:35], s63 offen lds
    s_waitcnt lgkmcnt(8)
    v_mfma_f32_16x16x32_bf16 v[72:75], a[252:255], v[112:115], v[72:75]
    ds_read_b128 v[132:135], v10 offset:11264
    v_mfma_f32_16x16x32_bf16 v[92:95], v[112:115], a[0:3], v[92:95]
    v_mfma_f32_16x16x32_bf16 v[76:79], a[252:255], v[116:119], v[76:79]
    ds_read_b128 v[136:139], v10 offset:13312
    v_mfma_f32_16x16x32_bf16 v[96:99], v[116:119], a[0:3], v[96:99]
    buffer_load_dwordx4 v12, s[32:35], s63 offen offset:1024 lds
    v_mfma_f32_16x16x32_bf16 v[56:59], a[248:251], v[116:119], v[56:59]
    ds_read_b128 v[140:143], v10 offset:15360
    s_waitcnt lgkmcnt(3)
    v_mfma_f32_16x16x32_bf16 v[80:83], a[252:255], v[120:123], v[80:83]
    v_mfma_f32_16x16x32_bf16 v[100:103], v[120:123], a[0:3], v[100:103]
    ds_read_b128 v[144:147], v10 offset:17408
    v_mfma_f32_16x16x32_bf16 v[60:63], a[248:251], v[120:123], v[60:63]
    s_add_u32 m0, s82, 36864
    s_add_u32 s63, s88, 0x28000
    buffer_load_dwordx4 v11, s[32:35], s63 offen lds
    v_mfma_f32_16x16x32_bf16 v[84:87], a[252:255], v[124:127], v[84:87]
    ds_read_b128 v[148:151], v10 offset:19456
    v_mfma_f32_16x16x32_bf16 v[104:107], v[124:127], a[0:3], v[104:107]
    v_mfma_f32_16x16x32_bf16 v[64:67], a[248:251], v[124:127], v[64:67]
    v_mfma_f32_16x16x32_bf16 v[88:91], a[252:255], v[128:131], v[88:91]
    buffer_load_dwordx4 v12, s[32:35], s63 offen offset:1024 lds
    v_mfma_f32_16x16x32_bf16 v[108:111], v[128:131], a[0:3], v[108:111]
    v_mfma_f32_16x16x32_bf16 v[68:71], a[248:251], v[128:131], v[68:71]
    s_barrier
    s_waitcnt lgkmcnt(3)
    v_mfma_f32_16x16x32_bf16 v[72:75], a[8:11], v[132:135], v[72:75]
    ds_read_b128 v[112:115], v10 offset:20480
    v_mfma_f32_16x16x32_bf16 v[92:95], v[132:135], a[12:15], v[92:95]
    s_add_u32 m0, s82, 38912
    s_add_u32 s63, s88, 0x2c000
    buffer_load_dwordx4 v11, s[32:35], s63 offen lds
    v_mfma_f32_16x16x32_bf16 v[76:79], a[8:11], v[136:139], v[76:79]
    ds_read_b128 v[116:119], v10 offset:22528
    v_mfma_f32_16x16x32_bf16 v[96:99], v[136:139], a[12:15], v[96:99]
    v_mfma_f32_16x16x32_bf16 v[56:59], a[4:7], v[136:139], v[56:59]
    ds_read_b128 v[120:123], v10 offset:24576
    s_waitcnt lgkmcnt(3)
    v_mfma_f32_16x16x32_bf16 v[80:83], a[8:11], v[140:143], v[80:83]
    buffer_load_dwordx4 v12, s[32:35], s63 offen offset:1024 lds
    v_mfma_f32_16x16x32_bf16 v[100:103], v[140:143], a[12:15], v[100:103]
    ds_read_b128 v[124:127], v10 offset:26624
    v_mfma_f32_16x16x32_bf16 v[60:63], a[4:7], v[140:143], v[60:63]
    v_mfma_f32_16x16x32_bf16 v[84:87], a[8:11], v[144:147], v[84:87]
    ds_read_b128 v[128:131], v10 offset:28672
    v_mfma_f32_16x16x32_bf16 v[104:107], v[144:147], a[12:15], v[104:107]
    s_add_u32 s64, s84, 0
    buffer_load_dwordx4 a[128:131], v2, s[24:27], s64 offen offset:0 sc1
    v_mfma_f32_16x16x32_bf16 v[64:67], a[4:7], v[144:147], v[64:67]
    v_mfma_f32_16x16x32_bf16 v[88:91], a[8:11], v[148:151], v[88:91]
    v_mfma_f32_16x16x32_bf16 v[108:111], v[148:151], a[12:15], v[108:111]
    buffer_load_dwordx4 a[132:135], v2, s[24:27], s64 offen offset:1024 sc1
    v_mfma_f32_16x16x32_bf16 v[68:71], a[4:7], v[148:151], v[68:71]
    s_waitcnt vmcnt(27)
    s_waitcnt lgkmcnt(3)
    v_mfma_f32_16x16x32_bf16 v[72:75], a[20:23], v[112:115], v[72:75]
    ds_read_b128 v[132:135], v10 offset:21504
    v_mfma_f32_16x16x32_bf16 v[92:95], v[112:115], a[24:27], v[92:95]
    buffer_load_dwordx4 a[136:139], v2, s[24:27], s64 offen offset:2048 sc1
    v_mfma_f32_16x16x32_bf16 v[76:79], a[20:23], v[116:119], v[76:79]
    ds_read_b128 v[136:139], v10 offset:23552
    v_mfma_f32_16x16x32_bf16 v[96:99], v[116:119], a[24:27], v[96:99]
    v_mfma_f32_16x16x32_bf16 v[56:59], a[16:19], v[116:119], v[56:59]
    ds_read_b128 v[140:143], v10 offset:25600
    s_waitcnt lgkmcnt(3)
    v_mfma_f32_16x16x32_bf16 v[80:83], a[20:23], v[120:123], v[80:83]
    buffer_load_dwordx4 a[140:143], v2, s[24:27], s64 offen offset:3072 sc1
    v_mfma_f32_16x16x32_bf16 v[100:103], v[120:123], a[24:27], v[100:103]
    ds_read_b128 v[144:147], v10 offset:27648
    v_mfma_f32_16x16x32_bf16 v[60:63], a[16:19], v[120:123], v[60:63]
    v_mfma_f32_16x16x32_bf16 v[84:87], a[20:23], v[124:127], v[84:87]
    ds_read_b128 v[148:151], v10 offset:29696
    v_mfma_f32_16x16x32_bf16 v[104:107], v[124:127], a[24:27], v[104:107]
    s_add_u32 s64, s84, 7168
    buffer_load_dwordx4 a[144:147], v2, s[24:27], s64 offen offset:0 sc1
    v_mfma_f32_16x16x32_bf16 v[64:67], a[16:19], v[124:127], v[64:67]
    v_mfma_f32_16x16x32_bf16 v[88:91], a[20:23], v[128:131], v[88:91]
    v_mfma_f32_16x16x32_bf16 v[108:111], v[128:131], a[24:27], v[108:111]
    buffer_load_dwordx4 a[148:151], v2, s[24:27], s64 offen offset:1024 sc1
    v_mfma_f32_16x16x32_bf16 v[68:71], a[16:19], v[128:131], v[68:71]
    s_waitcnt vmcnt(28)
    s_waitcnt lgkmcnt(3)
    v_mfma_f32_16x16x32_bf16 v[72:75], a[32:35], v[132:135], v[72:75]
    ds_read_b128 v[112:115], v10 offset:30720
    v_mfma_f32_16x16x32_bf16 v[92:95], v[132:135], a[36:39], v[92:95]
    buffer_load_dwordx4 a[152:155], v2, s[24:27], s64 offen offset:2048 sc1
    v_mfma_f32_16x16x32_bf16 v[76:79], a[32:35], v[136:139], v[76:79]
    ds_read_b128 v[116:119], v10 offset:32768
    v_mfma_f32_16x16x32_bf16 v[96:99], v[136:139], a[36:39], v[96:99]
    v_mfma_f32_16x16x32_bf16 v[56:59], a[28:31], v[136:139], v[56:59]
    ds_read_b128 v[120:123], v10 offset:34816
    s_waitcnt lgkmcnt(3)
    v_mfma_f32_16x16x32_bf16 v[80:83], a[32:35], v[140:143], v[80:83]
    buffer_load_dwordx4 a[156:159], v2, s[24:27], s64 offen offset:3072 sc1
    v_mfma_f32_16x16x32_bf16 v[100:103], v[140:143], a[36:39], v[100:103]
    ds_read_b128 v[124:127], v10 offset:36864
    v_mfma_f32_16x16x32_bf16 v[60:63], a[28:31], v[140:143], v[60:63]
    v_mfma_f32_16x16x32_bf16 v[84:87], a[32:35], v[144:147], v[84:87]
    ds_read_b128 v[128:131], v10 offset:38912
    v_mfma_f32_16x16x32_bf16 v[104:107], v[144:147], a[36:39], v[104:107]
    s_add_u32 s64, s84, 14336
    buffer_load_dwordx4 a[160:163], v2, s[24:27], s64 offen offset:0 sc1
    v_mfma_f32_16x16x32_bf16 v[64:67], a[28:31], v[144:147], v[64:67]
    v_mfma_f32_16x16x32_bf16 v[88:91], a[32:35], v[148:151], v[88:91]
    v_mfma_f32_16x16x32_bf16 v[108:111], v[148:151], a[36:39], v[108:111]
    buffer_load_dwordx4 a[164:167], v2, s[24:27], s64 offen offset:1024 sc1
    v_mfma_f32_16x16x32_bf16 v[68:71], a[28:31], v[148:151], v[68:71]
    s_waitcnt vmcnt(29)
    s_waitcnt lgkmcnt(3)
    v_mfma_f32_16x16x32_bf16 v[72:75], a[44:47], v[112:115], v[72:75]
    ds_read_b128 v[132:135], v10 offset:31744
    v_mfma_f32_16x16x32_bf16 v[92:95], v[112:115], a[48:51], v[92:95]
    ds_read_b128 v[136:139], v10 offset:33792
    v_mfma_f32_16x16x32_bf16 v[76:79], a[44:47], v[116:119], v[76:79]
    ds_read_b128 v[140:143], v10 offset:35840
    v_mfma_f32_16x16x32_bf16 v[96:99], v[116:119], a[48:51], v[96:99]
    ds_read_b128 v[144:147], v10 offset:37888
    v_mfma_f32_16x16x32_bf16 v[56:59], a[40:43], v[116:119], v[56:59]
    ds_read_b128 v[148:151], v10 offset:39936
    s_waitcnt lgkmcnt(5)
    v_mfma_f32_16x16x32_bf16 v[80:83], a[44:47], v[120:123], v[80:83]
    buffer_load_dwordx4 a[168:171], v2, s[24:27], s64 offen offset:2048 sc1
    v_mfma_f32_16x16x32_bf16 v[100:103], v[120:123], a[48:51], v[100:103]
    v_mfma_f32_16x16x32_bf16 v[60:63], a[40:43], v[120:123], v[60:63]
    v_mfma_f32_16x16x32_bf16 v[84:87], a[44:47], v[124:127], v[84:87]
    buffer_load_dwordx4 a[172:175], v2, s[24:27], s64 offen offset:3072 sc1
    v_mfma_f32_16x16x32_bf16 v[104:107], v[124:127], a[48:51], v[104:107]
    v_mfma_f32_16x16x32_bf16 v[64:67], a[40:43], v[124:127], v[64:67]
    v_mfma_f32_16x16x32_bf16 v[88:91], a[44:47], v[128:131], v[88:91]
    s_add_u32 s64, s84, 21504
    buffer_load_dwordx4 a[176:179], v2, s[24:27], s64 offen offset:0 sc1
    v_mfma_f32_16x16x32_bf16 v[108:111], v[128:131], a[48:51], v[108:111]
    v_mfma_f32_16x16x32_bf16 v[68:71], a[40:43], v[128:131], v[68:71]
    s_waitcnt lgkmcnt(0)
    s_barrier
    v_and_b32 v112, 15, v1
    v_lshlrev_b32 v112, 3, v112
    v_add_u32 v112, 0x26000, v112
    v_and_b32 v113, 48, v1
    v_add_u32 v113, 0x26280, v113
    s_waitcnt vmcnt(29)
    v_mfma_f32_16x16x32_bf16 v[72:75], a[56:59], v[132:135], v[72:75]
    ds_read_b64 v[176:177], v112 offset:0
    ds_read_b64 v[178:179], v112 offset:128
    v_mfma_f32_16x16x32_bf16 v[92:95], v[132:135], a[60:63], v[92:95]
    ds_read_b64 v[180:181], v112 offset:256
    ds_read_b64 v[182:183], v112 offset:384
    v_mfma_f32_16x16x32_bf16 v[76:79], a[56:59], v[136:139], v[76:79]
    ds_read_b64 v[184:185], v112 offset:512
    ds_read_b128 v[186:189], v113 offset:0
    v_mfma_f32_16x16x32_bf16 v[96:99], v[136:139], a[60:63], v[96:99]
    ds_read_b128 v[206:209], v113 offset:320
    ds_read_b128 v[190:193], v113 offset:64
    v_mfma_f32_16x16x32_bf16 v[56:59], a[52:55], v[136:139], v[56:59]
    ds_read_b128 v[210:213], v113 offset:384
    ds_read_b128 v[194:197], v113 offset:128
    v_mfma_f32_16x16x32_bf16 v[80:83], a[56:59], v[140:143], v[80:83]
    ds_read_b128 v[214:217], v113 offset:448
    ds_read_b128 v[198:201], v113 offset:192
    v_mfma_f32_16x16x32_bf16 v[100:103], v[140:143], a[60:63], v[100:103]
    ds_read_b128 v[218:221], v113 offset:512
    ds_read_b128 v[202:205], v113 offset:256
    v_mfma_f32_16x16x32_bf16 v[60:63], a[52:55], v[140:143], v[60:63]
    ds_read_b128 v[222:225], v113 offset:576
    v_mfma_f32_16x16x32_bf16 v[84:87], a[56:59], v[144:147], v[84:87]
    buffer_load_dwordx4 a[180:183], v2, s[24:27], s64 offen offset:1024 sc1
    v_mfma_f32_16x16x32_bf16 v[104:107], v[144:147], a[60:63], v[104:107]
    v_mfma_f32_16x16x32_bf16 v[64:67], a[52:55], v[144:147], v[64:67]
    v_mfma_f32_16x16x32_bf16 v[88:91], a[56:59], v[148:151], v[88:91]
    buffer_load_dwordx4 a[184:187], v2, s[24:27], s64 offen offset:2048 sc1
    v_mfma_f32_16x16x32_bf16 v[108:111], v[148:151], a[60:63], v[108:111]
    v_mfma_f32_16x16x32_bf16 v[68:71], a[52:55], v[148:151], v[68:71]
L_ce2:
    s_waitcnt lgkmcnt(10)
    s_nop 3
    v_pk_fma_f32 v[72:73], v[38:39], v[176:177], v[72:73] op_sel_hi:[1,0,1] neg_lo:[0,1,0] neg_hi:[0,1,0]
    v_pk_fma_f32 v[74:75], v[40:41], v[176:177], v[74:75] op_sel_hi:[1,0,1] neg_lo:[0,1,0] neg_hi:[0,1,0]
    v_pk_mul_f32 v[72:73], v[72:73], v[176:177] op_sel:[0,1] op_sel_hi:[1,1]
    v_pk_mul_f32 v[74:75], v[74:75], v[176:177] op_sel:[0,1] op_sel_hi:[1,1]
    v_cvt_pk_bf16_f32 v116, v72, v73
    v_cvt_pk_bf16_f32 v117, v74, v75
    v_pk_fma_f32 v[76:77], v[38:39], v[178:179], v[76:77] op_sel_hi:[1,0,1] neg_lo:[0,1,0] neg_hi:[0,1,0]
    v_pk_fma_f32 v[78:79], v[40:41], v[178:179], v[78:79] op_sel_hi:[1,0,1] neg_lo:[0,1,0] neg_hi:[0,1,0]
    v_pk_mul_f32 v[76:77], v[76:77], v[178:179] op_sel:[0,1] op_sel_hi:[1,1]
    v_pk_mul_f32 v[78:79], v[78:79], v[178:179] op_sel:[0,1] op_sel_hi:[1,1]
    v_cvt_pk_bf16_f32 v118, v76, v77
    s_add_u32 m0, s82, 65536
    s_add_u32 s63, s83, 0
    buffer_load_dwordx4 v2, s[24:27], s63 offen offset:0 sc1 lds
    v_cvt_pk_bf16_f32 v119, v78, v79
    v_pk_fma_f32 v[80:81], v[38:39], v[180:181], v[80:81] op_sel_hi:[1,0,1] neg_lo:[0,1,0] neg_hi:[0,1,0]
    v_pk_fma_f32 v[82:83], v[40:41], v[180:181], v[82:83] op_sel_hi:[1,0,1] neg_lo:[0,1,0] neg_hi:[0,1,0]
    v_pk_mul_f32 v[80:81], v[80:81], v[180:181] op_sel:[0,1] op_sel_hi:[1,1]
    v_pk_mul_f32 v[82:83], v[82:83], v[180:181] op_sel:[0,1] op_sel_hi:[1,1]
    v_cvt_pk_bf16_f32 v120, v80, v81
    v_cvt_pk_bf16_f32 v121, v82, v83
    v_pk_fma_f32 v[84:85], v[38:39], v[182:183], v[84:85] op_sel_hi:[1,0,1] neg_lo:[0,1,0] neg_hi:[0,1,0]
    v_pk_fma_f32 v[86:87], v[40:41], v[182:183], v[86:87] op_sel_hi:[1,0,1] neg_lo:[0,1,0] neg_hi:[0,1,0]
    v_pk_mul_f32 v[84:85], v[84:85], v[182:183] op_sel:[0,1] op_sel_hi:[1,1]
    v_pk_mul_f32 v[86:87], v[86:87], v[182:183] op_sel:[0,1] op_sel_hi:[1,1]
    v_cvt_pk_bf16_f32 v122, v84, v85
    v_cvt_pk_bf16_f32 v123, v86, v87
    buffer_load_dwordx4 v2, s[24:27], s63 offen offset:1024 sc1 lds
    v_pk_fma_f32 v[88:89], v[38:39], v[184:185], v[88:89] op_sel_hi:[1,0,1] neg_lo:[0,1,0] neg_hi:[0,1,0]
    v_pk_fma_f32 v[90:91], v[40:41], v[184:185], v[90:91] op_sel_hi:[1,0,1] neg_lo:[0,1,0] neg_hi:[0,1,0]
    v_pk_mul_f32 v[88:89], v[88:89], v[184:185] op_sel:[0,1] op_sel_hi:[1,1]
    v_pk_mul_f32 v[90:91], v[90:91], v[184:185] op_sel:[0,1] op_sel_hi:[1,1]
    v_cvt_pk_bf16_f32 v124, v88, v89
    v_cvt_pk_bf16_f32 v125, v90, v91
    v_pk_fma_f32 v[56:57], v[34:35], v[178:179], v[56:57] op_sel_hi:[1,0,1] neg_lo:[0,1,0] neg_hi:[0,1,0]
    v_pk_fma_f32 v[58:59], v[36:37], v[178:179], v[58:59] op_sel_hi:[1,0,1] neg_lo:[0,1,0] neg_hi:[0,1,0]
    v_cvt_pk_bf16_f32 v126, v56, v57
    v_cvt_pk_bf16_f32 v127, v58, v59
    v_pk_fma_f32 v[60:61], v[34:35], v[180:181], v[60:61] op_sel_hi:[1,0,1] neg_lo:[0,1,0] neg_hi:[0,1,0]
    v_pk_fma_f32 v[62:63], v[36:37], v[180:181], v[62:63] op_sel_hi:[1,0,1] neg_lo:[0,1,0] neg_hi:[0,1,0]
    v_cvt_pk_bf16_f32 v128, v60, v61
    buffer_load_dwordx4 v2, s[24:27], s63 offen offset:2048 sc1 lds
    v_cvt_pk_bf16_f32 v129, v62, v63
    v_pk_fma_f32 v[64:65], v[34:35], v[182:183], v[64:65] op_sel_hi:[1,0,1] neg_lo:[0,1,0] neg_hi:[0,1,0]
    v_pk_fma_f32 v[66:67], v[36:37], v[182:183], v[66:67] op_sel_hi:[1,0,1] neg_lo:[0,1,0] neg_hi:[0,1,0]
    v_cvt_pk_bf16_f32 v130, v64, v65
    v_cvt_pk_bf16_f32 v131, v66, v67
    v_pk_fma_f32 v[68:69], v[34:35], v[184:185], v[68:69] op_sel_hi:[1,0,1] neg_lo:[0,1,0] neg_hi:[0,1,0]
    v_pk_fma_f32 v[70:71], v[36:37], v[184:185], v[70:71] op_sel_hi:[1,0,1] neg_lo:[0,1,0] neg_hi:[0,1,0]
    v_cvt_pk_bf16_f32 v132, v68, v69
    v_cvt_pk_bf16_f32 v133, v70, v71
    v_mov_b32 v112, 0xf149f2ca
    s_nop 0
    v_mfma_f32_16x16x16_bf16 v[144:147], v[116:117], v[126:127], 0
    v_mfma_f32_16x16x16_bf16 v[148:151], v[118:119], v[126:127], 0
    buffer_load_dwordx4 v2, s[24:27], s63 offen offset:3072 sc1 lds
    v_mfma_f32_16x16x16_bf16 v[152:155], v[118:119], v[128:129], 0
    v_mfma_f32_16x16x16_bf16 v[156:159], v[120:121], v[128:129], 0
    v_mfma_f32_16x16x16_bf16 v[160:163], v[120:121], v[130:131], 0
    v_mfma_f32_16x16x16_bf16 v[164:167], v[122:123], v[130:131], 0
    v_mfma_f32_16x16x16_bf16 v[168:171], v[122:123], v[132:133], 0
    v_mfma_f32_16x16x16_bf16 v[172:175], v[124:125], v[132:133], 0
    s_waitcnt lgkmcnt(0)
    v_pk_fma_f32 v[92:93], v[186:187], v[42:43], v[92:93] op_sel_hi:[1,0,1] neg_lo:[0,1,0] neg_hi:[0,1,0]
    v_pk_fma_f32 v[94:95], v[188:189], v[42:43], v[94:95] op_sel_hi:[1,0,1] neg_lo:[0,1,0] neg_hi:[0,1,0]
    v_pk_mul_f32 v[92:93], v[92:93], v[206:207]
    v_pk_mul_f32 v[94:95], v[94:95], v[208:209]
    v_cvt_pk_bf16_f32 v134, v92, v93
    v_cvt_pk_bf16_f32 v135, v94, v95
    s_add_u32 m0, s82, 69632
    s_add_u32 s63, s83, 4096
    buffer_load_dwordx4 v2, s[24:27], s63 offen offset:0 sc1 lds
    v_pk_fma_f32 v[96:97], v[190:191], v[42:43], v[96:97] op_sel_hi:[1,0,1] neg_lo:[0,1,0] neg_hi:[0,1,0]
    v_pk_fma_f32 v[98:99], v[192:193], v[42:43], v[98:99] op_sel_hi:[1,0,1] neg_lo:[0,1,0] neg_hi:[0,1,0]
    v_pk_mul_f32 v[96:97], v[96:97], v[210:211]
    v_pk_mul_f32 v[98:99], v[98:99], v[212:213]
    v_cvt_pk_bf16_f32 v136, v96, v97
    v_cvt_pk_bf16_f32 v137, v98, v99
    v_pk_fma_f32 v[100:101], v[194:195], v[42:43], v[100:101] op_sel_hi:[1,0,1] neg_lo:[0,1,0] neg_hi:[0,1,0]
    v_pk_fma_f32 v[102:103], v[196:197], v[42:43], v[102:103] op_sel_hi:[1,0,1] neg_lo:[0,1,0] neg_hi:[0,1,0]
    v_pk_mul_f32 v[100:101], v[100:101], v[214:215]
    v_pk_mul_f32 v[102:103], v[102:103], v[216:217]
    v_cvt_pk_bf16_f32 v138, v100, v101
    v_cvt_pk_bf16_f32 v139, v102, v103
    v_pk_fma_f32 v[104:105], v[198:199], v[42:43], v[104:105] op_sel_hi:[1,0,1] neg_lo:[0,1,0] neg_hi:[0,1,0]
    buffer_load_dwordx4 v2, s[24:27], s63 offen offset:1024 sc1 lds
    v_pk_fma_f32 v[106:107], v[200:201], v[42:43], v[106:107] op_sel_hi:[1,0,1] neg_lo:[0,1,0] neg_hi:[0,1,0]
    v_pk_mul_f32 v[104:105], v[104:105], v[218:219]
    v_pk_mul_f32 v[106:107], v[106:107], v[220:221]
    v_cvt_pk_bf16_f32 v140, v104, v105
    v_cvt_pk_bf16_f32 v141, v106, v107
    v_pk_fma_f32 v[108:109], v[202:203], v[42:43], v[108:109] op_sel_hi:[1,0,1] neg_lo:[0,1,0] neg_hi:[0,1,0]
    v_pk_fma_f32 v[110:111], v[204:205], v[42:43], v[110:111] op_sel_hi:[1,0,1] neg_lo:[0,1,0] neg_hi:[0,1,0]
    v_pk_mul_f32 v[108:109], v[108:109], v[222:223]
    v_pk_mul_f32 v[110:111], v[110:111], v[224:225]
    v_cvt_pk_bf16_f32 v142, v108, v109
    v_cvt_pk_bf16_f32 v143, v110, v111
    v_cndmask_b32 v144, v112, v144, s[60:61]
    v_cndmask_b32 v145, v112, v145, s[60:61]
    buffer_load_dwordx4 v2, s[24:27], s63 offen offset:2048 sc1 lds
    v_cndmask_b32 v146, v112, v146, s[60:61]
    v_cndmask_b32 v147, v112, v147, s[60:61]
    v_mul_f32 v56, 0x3eb8aa3b, v179
    v_mul_f32 v57, 0x3eb8aa3b, v181
    v_mul_f32 v58, 0x3eb8aa3b, v183
    v_mul_f32 v59, 0x3eb8aa3b, v185
    v_cndmask_b32 v144, v144, v145, s[52:53]
    v_cndmask_b32 v146, v146, v147, s[52:53]
    v_cndmask_b32 v148, v148, v149, s[52:53]
    v_cndmask_b32 v150, v150, v151, s[52:53]
    v_cndmask_b32 v60, v144, v148, s[54:55]
    v_cndmask_b32 v64, v146, v150, s[56:57]
    v_max_f32 v68, v60, v64
    buffer_load_dwordx4 v2, s[24:27], s63 offen offset:3072 sc1 lds
    v_cndmask_b32 v152, v152, v153, s[52:53]
    v_cndmask_b32 v154, v154, v155, s[52:53]
    v_cndmask_b32 v156, v156, v157, s[52:53]
    v_cndmask_b32 v158, v158, v159, s[52:53]
    v_cndmask_b32 v61, v152, v156, s[54:55]
    v_cndmask_b32 v65, v154, v158, s[56:57]
    v_max_f32 v69, v61, v65
    v_cndmask_b32 v160, v160, v161, s[52:53]
    v_cndmask_b32 v162, v162, v163, s[52:53]
    v_cndmask_b32 v164, v164, v165, s[52:53]
    v_cndmask_b32 v166, v166, v167, s[52:53]
    v_cndmask_b32 v62, v160, v164, s[54:55]
    v_cndmask_b32 v66, v162, v166, s[56:57]
    s_mul_i32 s63, s70, 7
    s_add_u32 s63, s63, s66
    s_lshl_b32 s63, s63, 10
    s_lshl_b32 s62, s66, 10
    s_add_u32 m0, s62, 0x24000
    s_add_u32 s63, s63, 0x500000
    buffer_load_dwordx4 v2, s[24:27], s63 offen sc1 lds
    s_cmp_eq_u32 s66, 3
    s_cselect_b32 s63, 0x80000000, s63
    v_max_f32 v70, v62, v66
    v_cndmask_b32 v168, v168, v169, s[52:53]
    v_cndmask_b32 v170, v170, v171, s[52:53]
    v_cndmask_b32 v172, v172, v173, s[52:53]
    v_cndmask_b32 v174, v174, v175, s[52:53]
    v_cndmask_b32 v63, v168, v172, s[54:55]
    v_cndmask_b32 v67, v170, v174, s[56:57]
    v_max_f32 v71, v63, v67
    v_mov_b32 v72, v68
    v_mov_b32 v73, v69
    v_mov_b32 v74, v70
    v_mov_b32 v75, v71
    v_permlane16_swap_b32 v68, v72
    s_add_u32 m0, s62, 0x25000
    s_add_u32 s63, s63, 4096
    buffer_load_dwordx4 v2, s[24:27], s63 offen sc1 lds
    v_permlane16_swap_b32 v69, v73
    v_permlane16_swap_b32 v70, v74
    v_permlane16_swap_b32 v71, v75
    v_max_f32 v68, v68, v72
    v_max_f32 v69, v69, v73
    v_max_f32 v70, v70, v74
    v_max_f32 v71, v71, v75
    v_mov_b32 v72, v68
    v_mov_b32 v73, v69
    v_mov_b32 v74, v70
    v_mov_b32 v75, v71
    v_permlane32_swap_b32 v68, v72
    v_permlane32_swap_b32 v69, v73
    buffer_load_dwordx4 a[188:191], v2, s[24:27], s64 offen offset:3072 sc1
    v_permlane32_swap_b32 v70, v74
    v_permlane32_swap_b32 v71, v75
    v_max_f32 v68, v68, v72
    v_max_f32 v69, v69, v73
    v_max_f32 v70, v70, v74
    v_max_f32 v71, v71, v75
    v_mul_f32 v68, v68, v56
    v_mul_f32 v69, v69, v57
    v_mul_f32 v70, v70, v58
    v_mul_f32 v71, v71, v59
    v_fma_f32 v60, v60, v56, -v68
    v_fma_f32 v64, v64, v56, -v68
    v_fma_f32 v61, v61, v57, -v69
    v_fma_f32 v65, v65, v57, -v69
    v_fma_f32 v62, v62, v58, -v70
    v_fma_f32 v66, v66, v58, -v70
    v_fma_f32 v63, v63, v59, -v71
    v_fma_f32 v67, v67, v59, -v71
    v_exp_f32 v60, v60
    v_exp_f32 v64, v64
    v_exp_f32 v61, v61
    v_exp_f32 v65, v65
    v_exp_f32 v62, v62
    v_exp_f32 v66, v66
    v_exp_f32 v63, v63
    v_exp_f32 v67, v67
    v_add_f32 v68, v60, v64
    v_add_f32 v69, v61, v65
    v_add_f32 v70, v62, v66
    v_add_f32 v71, v63, v67
    v_mov_b32 v72, v68
    v_mov_b32 v73, v69
    v_mov_b32 v74, v70
    v_mov_b32 v75, v71
    v_permlane16_swap_b32 v68, v72
    v_permlane16_swap_b32 v69, v73
    v_permlane16_swap_b32 v70, v74
    v_permlane16_swap_b32 v71, v75
    v_add_f32 v68, v68, v72
    v_add_f32 v69, v69, v73
    v_add_f32 v70, v70, v74
    v_add_f32 v71, v71, v75
    v_mov_b32 v72, v68
    v_mov_b32 v73, v69
    v_mov_b32 v74, v70
    v_mov_b32 v75, v71
    v_permlane32_swap_b32 v68, v72
    v_permlane32_swap_b32 v69, v73
    v_permlane32_swap_b32 v70, v74
    v_permlane32_swap_b32 v71, v75
    v_add_f32 v68, v68, v72
    v_add_f32 v69, v69, v73
    v_add_f32 v70, v70, v74
    v_add_f32 v71, v71, v75
    v_rcp_f32 v68, v68
    v_rcp_f32 v69, v69
    v_rcp_f32 v70, v70
    v_rcp_f32 v71, v71
    v_mul_f32 v60, v60, v68
    v_mul_f32 v64, v64, v68
    v_mul_f32 v61, v61, v69
    v_mul_f32 v65, v65, v69
    v_mul_f32 v62, v62, v70
    v_mul_f32 v66, v66, v70
    v_mul_f32 v63, v63, v71
    v_mul_f32 v67, v67, v71
    v_cvt_pk_bf16_f32 v60, v60, v60
    v_cvt_pk_bf16_f32 v64, v64, v64
    v_and_b32 v144, v60, v22
    v_and_b32 v145, v64, v24
    v_and_b32 v146, v60, v23
    v_and_b32 v147, v64, v25
    v_cvt_pk_bf16_f32 v61, v61, v61
    v_cvt_pk_bf16_f32 v65, v65, v65
    v_and_b32 v152, v61, v22
    v_and_b32 v153, v65, v24
    v_and_b32 v154, v61, v23
    v_and_b32 v155, v65, v25
    v_cvt_pk_bf16_f32 v62, v62, v62
    v_cvt_pk_bf16_f32 v66, v66, v66
    v_and_b32 v160, v62, v22
    v_and_b32 v161, v66, v24
    v_and_b32 v162, v62, v23
    v_and_b32 v163, v66, v25
    v_cvt_pk_bf16_f32 v63, v63, v63
    v_cvt_pk_bf16_f32 v67, v67, v67
    v_and_b32 v168, v63, v22
    v_and_b32 v169, v67, v24
    v_and_b32 v170, v63, v23
    v_and_b32 v171, v67, v25
    s_nop 1
    v_mfma_f32_16x16x32_bf16 v[148:151], v[134:137], v[144:147], 0
    v_mfma_f32_16x16x32_bf16 v[156:159], v[136:139], v[152:155], 0
    v_mfma_f32_16x16x32_bf16 v[164:167], v[138:141], v[160:163], 0
    v_mfma_f32_16x16x32_bf16 v[172:175], v[140:143], v[168:171], 0
    s_nop 3
    s_add_u32 s63, s92, 0x10000
    v_cvt_pk_bf16_f32 v76, v148, v149
    v_cvt_pk_bf16_f32 v77, v150, v151
    v_cvt_pk_bf16_f32 v78, v156, v157
    v_cvt_pk_bf16_f32 v79, v158, v159
    v_cvt_pk_bf16_f32 v80, v164, v165
    v_cvt_pk_bf16_f32 v81, v166, v167
    v_cvt_pk_bf16_f32 v82, v172, v173
    v_cvt_pk_bf16_f32 v83, v174, v175
    s_nop 1
    v_permlane16_swap_b32 v76, v78
    v_permlane16_swap_b32 v77, v79
    v_permlane16_swap_b32 v80, v82
    v_permlane16_swap_b32 v81, v83
    buffer_store_dwordx4 v[76:79], v3, s[24:27], s92 offen sc1
    buffer_store_dwordx4 v[80:83], v3, s[24:27], s63 offen sc1
    s_and_b32 s65, s67, 15
    s_lshl_b32 s65, s65, 1
    s_add_u32 s65, s65, s72
    s_lshl_b32 s65, s65, 2
    s_add_u32 s65, s65, s73
    s_lshl_b32 s65, s65, 14
    s_xor_b32 s64, s98, 0x2000
    s_add_u32 s64, s64, s65
    s_add_u32 s64, s64, 0xa00000
    s_add_u32 s65, s64, 4096
    s_waitcnt vmcnt(28)
    s_waitcnt vmcnt(0)
    s_barrier
    s_cmp_lg_u32 s66, 0
    s_cbranch_scc1 L_sig_111
    s_mov_b64 exec, 0xff
    v_mov_b32 v52, 0x40
    buffer_atomic_add v52, v6, s[24:27], 0 offen offset:0 sc1
    s_mov_b64 exec, -1
L_sig_111:
    s_getpc_b64 s[36:37]
L_pc_112:
    s_sub_u32 s36, s36, L_pc_112-interleave_layers__sliding_local_dilated__glu_gated_geglu__prompt_kernel
    s_subb_u32 s37, s37, 0
    s_and_b32 s37, s37, 0xffff
    s_mov_b32 s39, 0x20000
    s_mov_b32 s38, L_fin-interleave_layers__sliding_local_dilated__glu_gated_geglu__prompt_kernel
    s_lshr_b32 s62, s2, 3
    s_lshl_b32 s62, s62, 2
    s_add_u32 s62, s62, s66
    s_lshl_b32 s62, s62, 7
    s_add_u32 s62, s62, (L_c34b-interleave_layers__sliding_local_dilated__glu_gated_geglu__prompt_kernel)&0xffffff80
    v_min_u32 v9, 7, v1
    v_lshl_add_u32 v9, v9, 14, s62
    buffer_load_dword v255, v9, s[36:39], 0 offen
    s_add_u32 m0, s82, 98304
    s_add_u32 s63, s83, 32768
    buffer_load_dwordx4 v2, s[24:27], s63 offen offset:0 sc1 lds
    buffer_load_dwordx4 v2, s[24:27], s63 offen offset:1024 sc1 lds
    buffer_load_dwordx4 v2, s[24:27], s63 offen offset:2048 sc1 lds
    buffer_load_dwordx4 v2, s[24:27], s63 offen offset:3072 sc1 lds
    s_cmp_lg_u32 s66, 1
    s_cbranch_scc1 L_w1_113
    v_mov_b32 v51, s86
    s_mov_b64 exec, 1
    v_mov_b32 v52, 0
    buffer_atomic_add v52, v51, s[24:27], 0 offen sc0 sc1
    s_mov_b64 exec, -1
L_w1_113:
    ds_read_b64_tr_b16 v[120:121], v13 offset:0
    ds_read_b64_tr_b16 v[122:123], v13 offset:512
    ds_read_b64_tr_b16 v[124:125], v14 offset:0
    ds_read_b64_tr_b16 v[126:127], v14 offset:512
    ds_read_b64_tr_b16 v[128:129], v13 offset:2048
    ds_read_b64_tr_b16 v[130:131], v13 offset:2560
    ds_read_b64_tr_b16 v[132:133], v14 offset:2048
    ds_read_b64_tr_b16 v[134:135], v14 offset:2560
    ds_read_b64_tr_b16 v[136:137], v13 offset:4096
    ds_read_b64_tr_b16 v[138:139], v13 offset:4608
    ds_read_b64_tr_b16 v[140:141], v14 offset:4096
    ds_read_b64_tr_b16 v[142:143], v14 offset:4608
    v_lshlrev_b32 v88, 16, v26
    v_and_b32 v89, 0xffff0000, v26
    v_lshlrev_b32 v90, 16, v27
    v_and_b32 v91, 0xffff0000, v27
    v_lshlrev_b32 v92, 16, v28
    v_and_b32 v93, 0xffff0000, v28
    v_lshlrev_b32 v94, 16, v29
    v_and_b32 v95, 0xffff0000, v29
    v_lshlrev_b32 v96, 16, v30
    v_and_b32 v97, 0xffff0000, v30
    v_lshlrev_b32 v98, 16, v31
    v_and_b32 v99, 0xffff0000, v31
    v_lshlrev_b32 v100, 16, v32
    v_and_b32 v101, 0xffff0000, v32
    v_lshlrev_b32 v102, 16, v33
    v_and_b32 v103, 0xffff0000, v33
    s_cmp_lg_u32 s66, 1
    s_cbranch_scc1 L_w1_114
    s_mov_b64 exec, 1
    v_mov_b32 v5, 0
    buffer_atomic_add v5, v51, s[24:27], 0 offen sc0 sc1
    s_mov_b64 exec, -1
L_w1_114:
    s_lshl_b32 s62, s69, 2
    s_add_u32 s62, s62, s66
    s_and_b32 s62, s62, 31
    s_lshl_b32 s87, s62, 18
    s_lshr_b32 s63, s70, 1
    s_lshl_b32 s63, s63, 14
    s_add_u32 s87, s87, s63
    s_and_b32 s63, s70, 1
    s_lshl_b32 s63, s63, 12
    s_add_u32 s87, s87, s63
    s_lshl_b32 s63, s69, 12
    s_xor_b32 s63, s63, s98
    s_and_b32 s63, s63, 0x2000
    s_lshl_b32 s89, s71, 23
    s_add_u32 s89, s89, 0x1000000
    s_add_u32 s89, s89, s63
    s_add_u32 s87, s87, s89
    s_lshl_b32 s16, s62, 16
    s_lshl_b32 s63, s71, 22
    s_add_u32 s16, s16, s63
    s_add_u32 s16, s16, s98
    s_add_u32 s16, s16, 0x800000
    s_add_u32 s17, s16, 4096
    s_add_u32 s18, s16, 16384
    s_add_u32 s19, s16, 20480
    s_lshl_b32 s20, s62, 8
    s_lshl_b32 s63, s71, 18
    s_add_u32 s20, s20, s63
    s_add_u32 s20, s20, s98
    s_add_u32 s20, s20, 0x540000
    s_cmp_lg_u32 s66, 1
    s_cbranch_scc1 L_w1_115
    s_mov_b64 exec, 1
    v_mov_b32 v8, 0
    buffer_atomic_add v8, v51, s[24:27], 0 offen sc0 sc1
    s_mov_b64 exec, -1
L_w1_115:
    s_cmp_lg_u32 s66, 1
    s_cbranch_scc1 L_w1_116
    s_mov_b64 exec, 1
    s_mov_b32 s90, 0
    s_waitcnt vmcnt(2)
    v_bfe_u32 v52, v52, 6, 6
    v_cmp_ne_u32 vcc, 8, v52
    s_cbranch_vccz L_mpd_118
    s_waitcnt vmcnt(1)
    v_bfe_u32 v5, v5, 6, 6
    v_cmp_ne_u32 vcc, 8, v5
    s_cbranch_vccz L_mpd_118
L_mp_117:
    s_waitcnt vmcnt(0)
    v_bfe_u32 v8, v8, 6, 6
    v_cmp_ne_u32 vcc, 8, v8
    s_cbranch_vccz L_mpd_118
    v_mov_b32 v8, 0
    buffer_atomic_add v8, v51, s[24:27], 0 offen sc0 sc1
    s_add_u32 s90, s90, 1
    s_cmp_lt_u32 s90, 0x2000
    s_cbranch_scc1 L_mp_117
    v_mov_b32 v53, 257
    buffer_store_dword v53, v55, s[48:51], 0 offen offset:4
L_mpd_118:
    s_mov_b64 exec, -1
L_w1_116:
    s_barrier
    buffer_load_dwordx4 v[160:163], v3, s[24:27], s64 offen offset:0 sc1
    buffer_load_dwordx4 v[164:167], v3, s[24:27], s64 offen offset:512 sc1
    s_barrier
    buffer_load_dwordx4 v[168:171], v3, s[24:27], s64 offen offset:1024 sc1
    buffer_load_dwordx4 v[172:175], v3, s[24:27], s64 offen offset:1536 sc1
    buffer_load_dwordx4 v[176:179], v3, s[24:27], s64 offen offset:2048 sc1
    s_barrier
    buffer_load_dwordx4 v[180:183], v3, s[24:27], s64 offen offset:2560 sc1
    buffer_load_dwordx4 v[184:187], v3, s[24:27], s64 offen offset:3072 sc1
    buffer_load_dwordx4 v[188:191], v3, s[24:27], s64 offen offset:3584 sc1
    s_barrier
    buffer_load_dwordx4 v[192:195], v3, s[24:27], s65 offen offset:0 sc1
    buffer_load_dwordx4 v[196:199], v3, s[24:27], s65 offen offset:512 sc1
    s_mov_b32 s90, 0
    s_waitcnt vmcnt(9)
    s_waitcnt lgkmcnt(10)
    v_mfma_f32_32x32x16_bf16 v[88:103], v[120:123], v[160:163], v[88:103]
    ds_read_b64_tr_b16 v[144:145], v13 offset:6144
    ds_read_b64_tr_b16 v[146:147], v13 offset:6656
    buffer_load_dwordx4 v[200:203], v3, s[24:27], s65 offen offset:1024 sc1
    s_waitcnt lgkmcnt(10)
    v_mfma_f32_32x32x16_bf16 v[104:119], v[124:127], v[160:163], 0
    ds_read_b64_tr_b16 v[148:149], v14 offset:6144
    ds_read_b64_tr_b16 v[150:151], v14 offset:6656
    s_waitcnt vmcnt(9)
    s_waitcnt lgkmcnt(10)
    v_mfma_f32_32x32x16_bf16 v[88:103], v[128:131], v[164:167], v[88:103]
    ds_read_b64_tr_b16 v[120:121], v13 offset:8192
    ds_read_b64_tr_b16 v[122:123], v13 offset:8704
    buffer_load_dwordx4 v[204:207], v3, s[24:27], s65 offen offset:1536 sc1
    s_waitcnt lgkmcnt(10)
    v_mfma_f32_32x32x16_bf16 v[104:119], v[132:135], v[164:167], v[104:119]
    ds_read_b64_tr_b16 v[124:125], v14 offset:8192
    ds_read_b64_tr_b16 v[126:127], v14 offset:8704
    s_waitcnt vmcnt(9)
    s_waitcnt lgkmcnt(10)
    v_mfma_f32_32x32x16_bf16 v[88:103], v[136:139], v[168:171], v[88:103]
    ds_read_b64_tr_b16 v[128:129], v13 offset:10240
    ds_read_b64_tr_b16 v[130:131], v13 offset:10752
    buffer_load_dwordx4 v[208:211], v3, s[24:27], s65 offen offset:2048 sc1
    s_waitcnt lgkmcnt(10)
    v_mfma_f32_32x32x16_bf16 v[104:119], v[140:143], v[168:171], v[104:119]
    ds_read_b64_tr_b16 v[132:133], v14 offset:10240
    ds_read_b64_tr_b16 v[134:135], v14 offset:10752
    s_waitcnt vmcnt(9)
    s_waitcnt lgkmcnt(10)
    v_mfma_f32_32x32x16_bf16 v[88:103], v[144:147], v[172:175], v[88:103]
    ds_read_b64_tr_b16 v[136:137], v13 offset:12288
    ds_read_b64_tr_b16 v[138:139], v13 offset:12800
    buffer_load_dwordx4 v[212:215], v3, s[24:27], s65 offen offset:2560 sc1
    s_waitcnt lgkmcnt(10)
    v_mfma_f32_32x32x16_bf16 v[104:119], v[148:151], v[172:175], v[104:119]
    ds_read_b64_tr_b16 v[140:141], v14 offset:12288
    ds_read_b64_tr_b16 v[142:143], v14 offset:12800
    s_waitcnt vmcnt(9)
    s_waitcnt lgkmcnt(10)
    v_mfma_f32_32x32x16_bf16 v[88:103], v[120:123], v[176:179], v[88:103]
    ds_read_b64_tr_b16 v[144:145], v13 offset:14336
    ds_read_b64_tr_b16 v[146:147], v13 offset:14848
    buffer_load_dwordx4 v[216:219], v3, s[24:27], s65 offen offset:3072 sc1
    s_waitcnt lgkmcnt(10)
    v_mfma_f32_32x32x16_bf16 v[104:119], v[124:127], v[176:179], v[104:119]
    ds_read_b64_tr_b16 v[148:149], v14 offset:14336
    ds_read_b64_tr_b16 v[150:151], v14 offset:14848
    s_waitcnt vmcnt(9)
    s_waitcnt lgkmcnt(10)
    v_mfma_f32_32x32x16_bf16 v[88:103], v[128:131], v[180:183], v[88:103]
    ds_read_b64_tr_b16 v[120:121], v13 offset:32768
    ds_read_b64_tr_b16 v[122:123], v13 offset:33280
    buffer_load_dwordx4 v[220:223], v3, s[24:27], s65 offen offset:3584 sc1
    s_waitcnt lgkmcnt(10)
    v_mfma_f32_32x32x16_bf16 v[104:119], v[132:135], v[180:183], v[104:119]
    ds_read_b64_tr_b16 v[124:125], v14 offset:32768
    ds_read_b64_tr_b16 v[126:127], v14 offset:33280
    s_waitcnt vmcnt(9)
    s_waitcnt lgkmcnt(10)
    v_mfma_f32_32x32x16_bf16 v[88:103], v[136:139], v[184:187], v[88:103]
    ds_read_b64_tr_b16 v[128:129], v13 offset:34816
    ds_read_b64_tr_b16 v[130:131], v13 offset:35328
    s_add_u32 m0, s82, 102400
    s_add_u32 s63, s83, 36864
    buffer_load_dwordx4 v2, s[24:27], s63 offen offset:0 sc1 lds
    s_waitcnt lgkmcnt(10)
    v_mfma_f32_32x32x16_bf16 v[104:119], v[140:143], v[184:187], v[104:119]
    ds_read_b64_tr_b16 v[132:133], v14 offset:34816
    ds_read_b64_tr_b16 v[134:135], v14 offset:35328
    s_waitcnt vmcnt(9)
    buffer_load_dwordx4 v2, s[24:27], s63 offen offset:1024 sc1 lds
    s_waitcnt lgkmcnt(10)
    v_mfma_f32_32x32x16_bf16 v[88:103], v[144:147], v[188:191], v[88:103]
    ds_read_b64_tr_b16 v[136:137], v13 offset:36864
    ds_read_b64_tr_b16 v[138:139], v13 offset:37376
    buffer_load_dwordx4 v2, s[24:27], s63 offen offset:2048 sc1 lds
    s_waitcnt lgkmcnt(10)
    v_mfma_f32_32x32x16_bf16 v[104:119], v[148:151], v[188:191], v[104:119]
    ds_read_b64_tr_b16 v[140:141], v14 offset:36864
    ds_read_b64_tr_b16 v[142:143], v14 offset:37376
    s_waitcnt vmcnt(10)
    buffer_load_dwordx4 v2, s[24:27], s63 offen offset:3072 sc1 lds
    s_waitcnt lgkmcnt(10)
    v_mfma_f32_32x32x16_bf16 v[88:103], v[120:123], v[192:195], v[88:103]
    ds_read_b64_tr_b16 v[144:145], v13 offset:38912
    ds_read_b64_tr_b16 v[146:147], v13 offset:39424
    s_waitcnt lgkmcnt(10)
    v_mfma_f32_32x32x16_bf16 v[104:119], v[124:127], v[192:195], v[104:119]
    ds_read_b64_tr_b16 v[148:149], v14 offset:38912
    ds_read_b64_tr_b16 v[150:151], v14 offset:39424
    s_waitcnt vmcnt(10)
    s_barrier
    s_waitcnt lgkmcnt(10)
    v_mfma_f32_32x32x16_bf16 v[88:103], v[128:131], v[196:199], v[88:103]
    ds_read_b64_tr_b16 v[120:121], v13 offset:40960
    ds_read_b64_tr_b16 v[122:123], v13 offset:41472
    s_add_u32 m0, s82, 0
    s_add_u32 s63, s83, 65536
    buffer_load_dwordx4 v2, s[24:27], s63 offen offset:0 sc1 lds
    s_waitcnt lgkmcnt(10)
    v_mfma_f32_32x32x16_bf16 v[104:119], v[132:135], v[196:199], v[104:119]
    ds_read_b64_tr_b16 v[124:125], v14 offset:40960
    ds_read_b64_tr_b16 v[126:127], v14 offset:41472
    s_waitcnt vmcnt(10)
    buffer_load_dwordx4 v2, s[24:27], s63 offen offset:1024 sc1 lds
    s_waitcnt lgkmcnt(10)
    v_mfma_f32_32x32x16_bf16 v[88:103], v[136:139], v[200:203], v[88:103]
    ds_read_b64_tr_b16 v[128:129], v13 offset:43008
    ds_read_b64_tr_b16 v[130:131], v13 offset:43520
    buffer_load_dwordx4 v2, s[24:27], s63 offen offset:2048 sc1 lds
    s_waitcnt lgkmcnt(10)
    v_mfma_f32_32x32x16_bf16 v[104:119], v[140:143], v[200:203], v[104:119]
    ds_read_b64_tr_b16 v[132:133], v14 offset:43008
    ds_read_b64_tr_b16 v[134:135], v14 offset:43520
    s_waitcnt vmcnt(11)
    buffer_load_dwordx4 v2, s[24:27], s63 offen offset:3072 sc1 lds
    s_waitcnt lgkmcnt(10)
    v_mfma_f32_32x32x16_bf16 v[88:103], v[144:147], v[204:207], v[88:103]
    ds_read_b64_tr_b16 v[136:137], v13 offset:45056
    ds_read_b64_tr_b16 v[138:139], v13 offset:45568
    s_add_u32 m0, s82, 4096
    s_add_u32 s63, s83, 69632
    buffer_load_dwordx4 v2, s[24:27], s63 offen offset:0 sc1 lds
    s_waitcnt lgkmcnt(10)
    v_mfma_f32_32x32x16_bf16 v[104:119], v[148:151], v[204:207], v[104:119]
    ds_read_b64_tr_b16 v[140:141], v14 offset:45056
    ds_read_b64_tr_b16 v[142:143], v14 offset:45568
    s_waitcnt vmcnt(12)
    buffer_load_dwordx4 v2, s[24:27], s63 offen offset:1024 sc1 lds
    s_waitcnt lgkmcnt(10)
    v_mfma_f32_32x32x16_bf16 v[88:103], v[120:123], v[208:211], v[88:103]
    ds_read_b64_tr_b16 v[144:145], v13 offset:47104
    ds_read_b64_tr_b16 v[146:147], v13 offset:47616
    buffer_load_dwordx4 v2, s[24:27], s63 offen offset:2048 sc1 lds
    s_waitcnt lgkmcnt(10)
    v_mfma_f32_32x32x16_bf16 v[104:119], v[124:127], v[208:211], v[104:119]
    ds_read_b64_tr_b16 v[148:149], v14 offset:47104
    ds_read_b64_tr_b16 v[150:151], v14 offset:47616
    s_waitcnt vmcnt(13)
    buffer_load_dwordx4 v2, s[24:27], s63 offen offset:3072 sc1 lds
    s_waitcnt lgkmcnt(10)
    v_mfma_f32_32x32x16_bf16 v[88:103], v[128:131], v[212:215], v[88:103]
    s_waitcnt lgkmcnt(8)
    v_mfma_f32_32x32x16_bf16 v[104:119], v[132:135], v[212:215], v[104:119]
    s_waitcnt vmcnt(13)
    s_waitcnt lgkmcnt(6)
    v_mfma_f32_32x32x16_bf16 v[88:103], v[136:139], v[216:219], v[88:103]
    s_waitcnt lgkmcnt(4)
    v_mfma_f32_32x32x16_bf16 v[104:119], v[140:143], v[216:219], v[104:119]
    s_waitcnt vmcnt(12)
    s_waitcnt lgkmcnt(2)
    v_mfma_f32_32x32x16_bf16 v[88:103], v[144:147], v[220:223], v[88:103]
    s_waitcnt lgkmcnt(0)
    v_mfma_f32_32x32x16_bf16 v[104:119], v[148:151], v[220:223], v[104:119]
    s_lshl_b32 s62, s66, 12
    s_add_u32 s62, s62, 0x20000
    v_add_u32 v152, s62, v2
    s_xor_b32 s62, s62, 0x2000
    v_add_u32 v153, s62, v2
    v_mov_b32 v154, 0
    v_mov_b32 v155, 0
    v_mov_b32 v156, 0
    v_mov_b32 v157, 0
    s_nop 3
    ds_write_b128 v152, v[104:107] offset:0
    ds_write_b128 v152, v[108:111] offset:1024
    ds_write_b128 v152, v[112:115] offset:2048
    ds_write_b128 v152, v[116:119] offset:3072
    s_waitcnt lgkmcnt(0)
    s_barrier
    ds_read_b128 v[104:107], v153 offset:0
    ds_read_b128 v[108:111], v153 offset:1024
    ds_read_b128 v[112:115], v153 offset:2048
    ds_read_b128 v[116:119], v153 offset:3072
    s_waitcnt lgkmcnt(3)
    v_pk_add_f32 v[88:89], v[88:89], v[104:105]
    v_pk_add_f32 v[90:91], v[90:91], v[106:107]
    v_cvt_pk_bf16_f32 v26, v88, v89
    v_cvt_pk_bf16_f32 v27, v90, v91
    s_waitcnt lgkmcnt(2)
    v_pk_add_f32 v[92:93], v[92:93], v[108:109]
    v_pk_add_f32 v[94:95], v[94:95], v[110:111]
    v_cvt_pk_bf16_f32 v28, v92, v93
    v_cvt_pk_bf16_f32 v29, v94, v95
    buffer_store_dwordx4 v[26:29], v3, s[24:27], s93 offen sc1
    s_waitcnt lgkmcnt(1)
    v_pk_add_f32 v[96:97], v[96:97], v[112:113]
    v_pk_add_f32 v[98:99], v[98:99], v[114:115]
    v_cvt_pk_bf16_f32 v30, v96, v97
    v_cvt_pk_bf16_f32 v31, v98, v99
    s_waitcnt lgkmcnt(0)
    v_pk_add_f32 v[100:101], v[100:101], v[116:117]
    v_pk_add_f32 v[102:103], v[102:103], v[118:119]
    v_cvt_pk_bf16_f32 v32, v100, v101
    v_cvt_pk_bf16_f32 v33, v102, v103
    buffer_store_dwordx4 v[30:33], v3, s[24:27], s93 offen offset:512 sc1
    v_dot2c_f32_bf16 v154, v26, v46
    v_dot2c_f32_bf16 v155, v26, v26
    v_dot2c_f32_bf16 v156, v27, v46
    v_dot2c_f32_bf16 v157, v27, v27
    v_dot2c_f32_bf16 v154, v28, v46
    v_dot2c_f32_bf16 v155, v28, v28
    v_dot2c_f32_bf16 v156, v29, v46
    v_dot2c_f32_bf16 v157, v29, v29
    v_dot2c_f32_bf16 v154, v30, v46
    v_dot2c_f32_bf16 v155, v30, v30
    v_dot2c_f32_bf16 v156, v31, v46
    v_dot2c_f32_bf16 v157, v31, v31
    v_dot2c_f32_bf16 v154, v32, v46
    v_dot2c_f32_bf16 v155, v32, v32
    v_dot2c_f32_bf16 v156, v33, v46
    v_dot2c_f32_bf16 v157, v33, v33
    s_nop 2
    v_add_f32 v154, v154, v156
    v_add_f32 v155, v155, v157
    v_mov_b32 v156, v154
    v_mov_b32 v157, v155
    s_nop 1
    v_permlane32_swap_b32 v154, v156
    v_permlane32_swap_b32 v155, v157
    s_nop 0
    v_add_f32 v154, v154, v156
    v_add_f32 v155, v155, v157
    buffer_store_dwordx2 v[154:155], v19, s[24:27], s94 offen sc1
    s_waitcnt vmcnt(0)
    s_barrier
    s_cmp_lg_u32 s66, 0
    s_cbranch_scc1 L_sig_119
    s_mov_b64 exec, 0xffff
    v_mov_b32 v52, 0x40000
    buffer_atomic_add v52, v7, s[24:27], 0 offen offset:0 sc1
    s_mov_b64 exec, -1
L_sig_119:
L_c34b:
    s_cmp_lg_u32 s66, 1
    s_cbranch_scc1 L_w1_120
    v_mov_b32 v51, s86
    s_mov_b64 exec, 1
    v_mov_b32 v52, 0
    buffer_atomic_add v52, v51, s[24:27], 0 offen sc0 sc1
    s_mov_b64 exec, -1
L_w1_120:
    ds_read_b128 v[104:107], v15 offset:0
    ds_read_b128 v[108:111], v15 offset:32768
    ds_read_b128 v[112:115], v15 offset:1024
    ds_read_b128 v[116:119], v15 offset:33792
    ds_read_b128 v[120:123], v15 offset:2048
    ds_read_b128 v[124:127], v15 offset:34816
    s_lshl_b32 s62, s67, 1
    s_add_u32 s62, s62, s73
    s_and_b32 s62, s62, 31
    s_lshl_b32 s62, s62, 2
    s_add_u32 s62, s62, s72
    s_lshl_b32 s62, s62, 16
    s_add_u32 s8, s62, s89
    s_add_u32 s9, s8, 4096
    s_add_u32 s10, s8, 16384
    s_add_u32 s11, s8, 20480
    s_add_u32 s12, s8, 32768
    s_add_u32 s13, s8, 36864
    s_add_u32 s14, s8, 49152
    s_add_u32 s15, s8, 53248
    s_lshl_b32 s62, s72, 14
    s_lshl_b32 s63, s73, 10
    s_add_u32 s85, s62, s63
    s_mul_i32 s62, s72, 17408
    v_add_u32 v250, s62, v2
    v_xor_b32 v251, 0x400, v250
    v_add_u32 v252, 0x10000, v250
    v_add_u32 v253, 0x10000, v251
    s_lshl_b32 s62, s68, 2
    s_lshl_b32 s63, s73, 1
    s_add_u32 s62, s62, s63
    s_add_u32 s62, s62, s72
    s_mul_i32 s62, s62, 57344
    s_add_u32 s84, s62, 0x2200000
    s_add_u32 s44, s24, 0x2400000
    s_addc_u32 s45, s25, 0
    s_cmp_eq_u32 s71, 0
    s_cselect_b32 s46, 0x180000, 0
    s_lshl_b32 s89, s67, 1
    s_add_u32 s89, s89, s72
    s_lshl_b32 s89, s89, 15
    s_lshl_b32 s63, s68, 1
    s_add_u32 s63, s63, s73
    s_lshl_b32 s63, s63, 6
    s_add_u32 s89, s89, s63
    s_xor_b32 s88, s93, 0x2000
    s_add_u32 s88, s88, 0x600000
    s_cmp_lg_u32 s66, 1
    s_cbranch_scc1 L_w1_121
    s_mov_b64 exec, 1
    v_mov_b32 v5, 0
    buffer_atomic_add v5, v51, s[24:27], 0 offen sc0 sc1
    s_mov_b64 exec, -1
L_w1_121:
    s_cmp_lg_u32 s66, 1
    s_cbranch_scc1 L_w1_122
    s_mov_b64 exec, 1
    s_mov_b32 s90, 0
    s_waitcnt vmcnt(1)
    v_bfe_u32 v52, v52, 18, 6
    v_cmp_ne_u32 vcc, 16, v52
    s_cbranch_vccz L_mpd_124
L_mp_123:
    s_waitcnt vmcnt(0)
    v_bfe_u32 v5, v5, 18, 6
    v_cmp_ne_u32 vcc, 16, v5
    s_cbranch_vccz L_mpd_124
    v_mov_b32 v5, 0
    buffer_atomic_add v5, v51, s[24:27], 0 offen sc0 sc1
    s_add_u32 s90, s90, 1
    s_cmp_lt_u32 s90, 0x2000
    s_cbranch_scc1 L_mp_123
    v_mov_b32 v53, 259
    buffer_store_dword v53, v55, s[48:51], 0 offen offset:4
L_mpd_124:
    s_mov_b64 exec, -1
L_w1_122:
    s_barrier
    s_mov_b32 s90, 0
    buffer_load_dwordx4 a[0:3], v3, s[24:27], s16 offen offset:0 sc1
    buffer_load_dwordx4 a[4:7], v3, s[24:27], s16 offen offset:512 sc1
    s_barrier
    buffer_load_dwordx4 a[8:11], v3, s[24:27], s16 offen offset:1024 sc1
    buffer_load_dwordx4 a[12:15], v3, s[24:27], s16 offen offset:1536 sc1
    buffer_load_dwordx4 a[16:19], v3, s[24:27], s16 offen offset:2048 sc1
    s_barrier
    buffer_load_dwordx4 a[20:23], v3, s[24:27], s16 offen offset:2560 sc1
    buffer_load_dwordx4 a[24:27], v3, s[24:27], s16 offen offset:3072 sc1
    buffer_load_dwordx4 a[28:31], v3, s[24:27], s16 offen offset:3584 sc1
    s_barrier
    buffer_load_dwordx4 a[32:35], v3, s[24:27], s17 offen offset:0 sc1
    buffer_load_dwordx4 a[36:39], v3, s[24:27], s17 offen offset:512 sc1
    s_waitcnt lgkmcnt(4)
    s_waitcnt vmcnt(9)
    v_mfma_f32_32x32x16_bf16 v[56:71], v[104:107], a[0:3], 0
    buffer_load_dwordx4 a[40:43], v3, s[24:27], s17 offen offset:1024 sc1
    ds_read_b128 v[128:131], v15 offset:3072
    v_mfma_f32_32x32x16_bf16 v[72:87], v[108:111], a[0:3], 0
    ds_read_b128 v[132:135], v15 offset:35840
    s_waitcnt vmcnt(9)
    s_waitcnt lgkmcnt(4)
    v_mfma_f32_32x32x16_bf16 v[56:71], v[112:115], a[4:7], v[56:71]
    buffer_load_dwordx4 a[44:47], v3, s[24:27], s17 offen offset:1536 sc1
    ds_read_b128 v[104:107], v15 offset:4096
    v_mfma_f32_32x32x16_bf16 v[72:87], v[116:119], a[4:7], v[72:87]
    s_add_u32 s65, s20, 0
    buffer_load_dwordx2 v[88:89], v20, s[24:27], s65 offen sc1
    ds_read_b128 v[108:111], v15 offset:36864
    s_waitcnt vmcnt(10)
    s_waitcnt lgkmcnt(4)
    v_mfma_f32_32x32x16_bf16 v[56:71], v[120:123], a[8:11], v[56:71]
    buffer_load_dwordx4 a[48:51], v3, s[24:27], s17 offen offset:2048 sc1
    ds_read_b128 v[112:115], v15 offset:5120
    v_mfma_f32_32x32x16_bf16 v[72:87], v[124:127], a[8:11], v[72:87]
    s_add_u32 s65, s20, 16384
    buffer_load_dwordx2 v[90:91], v20, s[24:27], s65 offen sc1
    ds_read_b128 v[116:119], v15 offset:37888
    s_waitcnt vmcnt(11)
    s_waitcnt lgkmcnt(4)
    v_mfma_f32_32x32x16_bf16 v[56:71], v[128:131], a[12:15], v[56:71]
    buffer_load_dwordx4 a[52:55], v3, s[24:27], s17 offen offset:2560 sc1
    ds_read_b128 v[120:123], v15 offset:6144
    v_mfma_f32_32x32x16_bf16 v[72:87], v[132:135], a[12:15], v[72:87]
    s_add_u32 s65, s20, 32768
    buffer_load_dwordx2 v[92:93], v20, s[24:27], s65 offen sc1
    ds_read_b128 v[124:127], v15 offset:38912
    s_waitcnt vmcnt(12)
    s_waitcnt lgkmcnt(4)
    v_mfma_f32_32x32x16_bf16 v[56:71], v[104:107], a[16:19], v[56:71]
    buffer_load_dwordx4 a[56:59], v3, s[24:27], s17 offen offset:3072 sc1
    ds_read_b128 v[128:131], v15 offset:7168
    v_mfma_f32_32x32x16_bf16 v[72:87], v[108:111], a[16:19], v[72:87]
    s_add_u32 s65, s20, 49152
    buffer_load_dwordx2 v[94:95], v20, s[24:27], s65 offen sc1
    ds_read_b128 v[132:135], v15 offset:39936
    s_waitcnt vmcnt(13)
    s_waitcnt lgkmcnt(4)
    v_mfma_f32_32x32x16_bf16 v[56:71], v[112:115], a[20:23], v[56:71]
    buffer_load_dwordx4 a[60:63], v3, s[24:27], s17 offen offset:3584 sc1
    ds_read_b128 v[104:107], v15 offset:8192
    v_mfma_f32_32x32x16_bf16 v[72:87], v[116:119], a[20:23], v[72:87]
    s_add_u32 s65, s20, 65536
    buffer_load_dwordx2 v[96:97], v20, s[24:27], s65 offen sc1
    ds_read_b128 v[108:111], v15 offset:40960
    s_waitcnt vmcnt(14)
    s_waitcnt lgkmcnt(4)
    v_mfma_f32_32x32x16_bf16 v[56:71], v[120:123], a[24:27], v[56:71]
    buffer_load_dwordx4 a[64:67], v3, s[24:27], s18 offen offset:0 sc1
    ds_read_b128 v[112:115], v15 offset:9216
    v_mfma_f32_32x32x16_bf16 v[72:87], v[124:127], a[24:27], v[72:87]
    s_add_u32 s65, s20, 81920
    buffer_load_dwordx2 v[98:99], v20, s[24:27], s65 offen sc1
    ds_read_b128 v[116:119], v15 offset:41984
    s_waitcnt vmcnt(15)
    s_waitcnt lgkmcnt(4)
    v_mfma_f32_32x32x16_bf16 v[56:71], v[128:131], a[28:31], v[56:71]
    buffer_load_dwordx4 a[68:71], v3, s[24:27], s18 offen offset:512 sc1
    ds_read_b128 v[120:123], v15 offset:10240
    v_mfma_f32_32x32x16_bf16 v[72:87], v[132:135], a[28:31], v[72:87]
    s_add_u32 s65, s20, 98304
    buffer_load_dwordx2 v[100:101], v20, s[24:27], s65 offen sc1
    ds_read_b128 v[124:127], v15 offset:43008
    s_waitcnt vmcnt(16)
    s_waitcnt lgkmcnt(4)
    v_mfma_f32_32x32x16_bf16 v[56:71], v[104:107], a[32:35], v[56:71]
    buffer_load_dwordx4 a[72:75], v3, s[24:27], s18 offen offset:1024 sc1
    ds_read_b128 v[128:131], v15 offset:11264
    v_mfma_f32_32x32x16_bf16 v[72:87], v[108:111], a[32:35], v[72:87]
    s_add_u32 s65, s20, 114688
    buffer_load_dwordx2 v[102:103], v20, s[24:27], s65 offen sc1
    ds_read_b128 v[132:135], v15 offset:44032
    s_waitcnt vmcnt(17)
    s_waitcnt lgkmcnt(4)
    v_mfma_f32_32x32x16_bf16 v[56:71], v[112:115], a[36:39], v[56:71]
    buffer_load_dwordx4 a[76:79], v3, s[24:27], s18 offen offset:1536 sc1
    ds_read_b128 v[104:107], v15 offset:12288
    v_mfma_f32_32x32x16_bf16 v[72:87], v[116:119], a[36:39], v[72:87]
    ds_read_b128 v[108:111], v15 offset:45056
    s_waitcnt vmcnt(17)
    s_waitcnt lgkmcnt(4)
    v_mfma_f32_32x32x16_bf16 v[56:71], v[120:123], a[40:43], v[56:71]
    buffer_load_dwordx4 a[80:83], v3, s[24:27], s18 offen offset:2048 sc1
    ds_read_b128 v[112:115], v15 offset:13312
    v_mfma_f32_32x32x16_bf16 v[72:87], v[124:127], a[40:43], v[72:87]
    ds_read_b128 v[116:119], v15 offset:46080
    s_waitcnt vmcnt(17)
    s_waitcnt lgkmcnt(4)
    v_mfma_f32_32x32x16_bf16 v[56:71], v[128:131], a[44:47], v[56:71]
    buffer_load_dwordx4 a[84:87], v3, s[24:27], s18 offen offset:2560 sc1
    ds_read_b128 v[120:123], v15 offset:14336
    v_mfma_f32_32x32x16_bf16 v[72:87], v[132:135], a[44:47], v[72:87]
    ds_read_b128 v[124:127], v15 offset:47104
    s_waitcnt vmcnt(16)
    s_waitcnt lgkmcnt(4)
    v_mfma_f32_32x32x16_bf16 v[56:71], v[104:107], a[48:51], v[56:71]
    buffer_load_dwordx4 a[88:91], v3, s[24:27], s18 offen offset:3072 sc1
    ds_read_b128 v[128:131], v15 offset:15360
    v_mfma_f32_32x32x16_bf16 v[72:87], v[108:111], a[48:51], v[72:87]
    ds_read_b128 v[132:135], v15 offset:48128
    s_waitcnt vmcnt(15)
    s_waitcnt lgkmcnt(4)
    v_mfma_f32_32x32x16_bf16 v[56:71], v[112:115], a[52:55], v[56:71]
    buffer_load_dwordx4 a[92:95], v3, s[24:27], s18 offen offset:3584 sc1
    ds_read_b128 v[104:107], v15 offset:16384
    v_mfma_f32_32x32x16_bf16 v[72:87], v[116:119], a[52:55], v[72:87]
    ds_read_b128 v[108:111], v15 offset:49152
    s_waitcnt vmcnt(14)
    s_waitcnt lgkmcnt(4)
    v_mfma_f32_32x32x16_bf16 v[56:71], v[120:123], a[56:59], v[56:71]
    buffer_load_dwordx4 a[96:99], v3, s[24:27], s19 offen offset:0 sc1
    ds_read_b128 v[112:115], v15 offset:17408
    v_mfma_f32_32x32x16_bf16 v[72:87], v[124:127], a[56:59], v[72:87]
    ds_read_b128 v[116:119], v15 offset:50176
    s_waitcnt vmcnt(13)
    s_waitcnt lgkmcnt(4)
    v_mfma_f32_32x32x16_bf16 v[56:71], v[128:131], a[60:63], v[56:71]
    buffer_load_dwordx4 a[100:103], v3, s[24:27], s19 offen offset:512 sc1
    ds_read_b128 v[120:123], v15 offset:18432
    v_mfma_f32_32x32x16_bf16 v[72:87], v[132:135], a[60:63], v[72:87]
    ds_read_b128 v[124:127], v15 offset:51200
    s_waitcnt vmcnt(12)
    s_waitcnt lgkmcnt(4)
    v_mfma_f32_32x32x16_bf16 v[56:71], v[104:107], a[64:67], v[56:71]
    buffer_load_dwordx4 a[104:107], v3, s[24:27], s19 offen offset:1024 sc1
    ds_read_b128 v[128:131], v15 offset:19456
    v_mfma_f32_32x32x16_bf16 v[72:87], v[108:111], a[64:67], v[72:87]
    ds_read_b128 v[132:135], v15 offset:52224
    s_waitcnt vmcnt(11)
    s_waitcnt lgkmcnt(4)
    v_mfma_f32_32x32x16_bf16 v[56:71], v[112:115], a[68:71], v[56:71]
    buffer_load_dwordx4 a[108:111], v3, s[24:27], s19 offen offset:1536 sc1
    ds_read_b128 v[104:107], v15 offset:20480
    v_mfma_f32_32x32x16_bf16 v[72:87], v[116:119], a[68:71], v[72:87]
    ds_read_b128 v[108:111], v15 offset:53248
    s_waitcnt vmcnt(10)
    s_waitcnt lgkmcnt(4)
    v_mfma_f32_32x32x16_bf16 v[56:71], v[120:123], a[72:75], v[56:71]
    buffer_load_dwordx4 a[112:115], v3, s[24:27], s19 offen offset:2048 sc1
    ds_read_b128 v[112:115], v15 offset:21504
    v_mfma_f32_32x32x16_bf16 v[72:87], v[124:127], a[72:75], v[72:87]
    ds_read_b128 v[116:119], v15 offset:54272
    s_waitcnt vmcnt(9)
    s_waitcnt lgkmcnt(4)
    v_mfma_f32_32x32x16_bf16 v[56:71], v[128:131], a[76:79], v[56:71]
    buffer_load_dwordx4 a[116:119], v3, s[24:27], s19 offen offset:2560 sc1
    ds_read_b128 v[120:123], v15 offset:22528
    v_add_f32 v88, v88, v90
    v_add_f32 v88, v88, v92
    v_mfma_f32_32x32x16_bf16 v[72:87], v[132:135], a[76:79], v[72:87]
    ds_read_b128 v[124:127], v15 offset:55296
    s_waitcnt vmcnt(9)
    v_add_f32 v88, v88, v94
    v_add_f32 v88, v88, v96
    v_add_f32 v88, v88, v98
    v_add_f32 v88, v88, v100
    s_waitcnt lgkmcnt(4)
    v_mfma_f32_32x32x16_bf16 v[56:71], v[104:107], a[80:83], v[56:71]
    buffer_load_dwordx4 a[120:123], v3, s[24:27], s19 offen offset:3072 sc1
    ds_read_b128 v[128:131], v15 offset:23552
    v_add_f32 v88, v88, v102
    v_add_f32 v89, v89, v91
    v_mfma_f32_32x32x16_bf16 v[72:87], v[108:111], a[80:83], v[72:87]
    ds_read_b128 v[132:135], v15 offset:56320
    s_waitcnt vmcnt(9)
    v_add_f32 v89, v89, v93
    v_add_f32 v89, v89, v95
    v_add_f32 v89, v89, v97
    v_add_f32 v89, v89, v99
    s_waitcnt lgkmcnt(4)
    v_mfma_f32_32x32x16_bf16 v[56:71], v[112:115], a[84:87], v[56:71]
    buffer_load_dwordx4 a[124:127], v3, s[24:27], s19 offen offset:3584 sc1
    ds_read_b128 v[104:107], v15 offset:24576
    v_add_f32 v89, v89, v101
    v_add_f32 v89, v89, v103
    v_mfma_f32_32x32x16_bf16 v[72:87], v[116:119], a[84:87], v[72:87]
    ds_read_b128 v[108:111], v15 offset:57344
    s_waitcnt vmcnt(9)
    v_mov_b32 v90, v88
    v_mov_b32 v91, v89
    s_nop 1
    v_permlane32_swap_b32 v88, v90
    s_waitcnt lgkmcnt(4)
    v_mfma_f32_32x32x16_bf16 v[56:71], v[120:123], a[88:91], v[56:71]
    ds_read_b128 v[112:115], v15 offset:25600
    v_permlane32_swap_b32 v89, v91
    s_nop 0
    v_add_f32 v88, v88, v90
    v_add_f32 v89, v89, v91
    v_mfma_f32_32x32x16_bf16 v[72:87], v[124:127], a[88:91], v[72:87]
    ds_read_b128 v[116:119], v15 offset:58368
    s_waitcnt vmcnt(8)
    v_mul_f32 v92, 0xbb000000, v88
    v_mul_f32 v142, v92, v92
    v_mov_b32 v93, 0x3b000000
    v_fma_f32 v142, v89, v93, -v142
    s_waitcnt lgkmcnt(4)
    v_mfma_f32_32x32x16_bf16 v[56:71], v[128:131], a[92:95], v[56:71]
    s_add_u32 m0, s82, 32768
    s_add_u32 s63, s83, 98304
    buffer_load_dwordx4 v2, s[24:27], s63 offen offset:0 sc1 lds
    ds_read_b128 v[120:123], v15 offset:26624
    v_mfma_f32_32x32x16_bf16 v[72:87], v[132:135], a[92:95], v[72:87]
    ds_read_b128 v[124:127], v15 offset:59392
    s_waitcnt vmcnt(8)
    v_max_f32 v142, 0, v142
    v_add_f32 v142, 0x3727c5ac, v142
    v_rsq_f32 v93, v142
    s_waitcnt lgkmcnt(4)
    v_mfma_f32_32x32x16_bf16 v[56:71], v[104:107], a[96:99], v[56:71]
    buffer_load_dwordx4 v2, s[24:27], s63 offen offset:1024 sc1 lds
    ds_read_b128 v[128:131], v15 offset:27648
    v_cvt_pk_bf16_f32 v136, v92, v92
    v_and_b32 v94, 0xffff0000, v136
    v_mfma_f32_32x32x16_bf16 v[72:87], v[108:111], a[96:99], v[72:87]
    ds_read_b128 v[132:135], v15 offset:60416
    s_waitcnt vmcnt(8)
    v_mul_f32 v140, 0xc0135761, v93
    v_sub_f32 v94, v92, v94
    v_mul_f32 v95, v93, v93
    v_cvt_pk_bf16_f32 v137, v94, v55
    s_waitcnt lgkmcnt(4)
    v_mfma_f32_32x32x16_bf16 v[56:71], v[112:115], a[100:103], v[56:71]
    buffer_load_dwordx4 v2, s[24:27], s63 offen offset:2048 sc1 lds
    ds_read_b128 v[104:107], v15 offset:28672
    v_mul_f32 v95, 0x3d372713, v95
    v_mov_b32 v138, v136
    v_mfma_f32_32x32x16_bf16 v[72:87], v[116:119], a[100:103], v[72:87]
    ds_read_b128 v[108:111], v15 offset:61440
    s_waitcnt vmcnt(8)
    v_mul_f32 v141, v140, v95
    v_mov_b32 v139, v137
    s_waitcnt lgkmcnt(4)
    v_mfma_f32_32x32x16_bf16 v[56:71], v[120:123], a[104:107], v[56:71]
    buffer_load_dwordx4 v2, s[24:27], s63 offen offset:3072 sc1 lds
    ds_read_b128 v[112:115], v15 offset:29696
    v_mfma_f32_32x32x16_bf16 v[72:87], v[124:127], a[104:107], v[72:87]
    ds_read_b128 v[116:119], v15 offset:62464
    s_waitcnt vmcnt(8)
    s_waitcnt lgkmcnt(4)
    v_mfma_f32_32x32x16_bf16 v[56:71], v[128:131], a[108:111], v[56:71]
    s_add_u32 m0, s82, 36864
    s_add_u32 s63, s83, 102400
    buffer_load_dwordx4 v2, s[24:27], s63 offen offset:0 sc1 lds
    ds_read_b128 v[120:123], v15 offset:30720
    v_mfma_f32_32x32x16_bf16 v[72:87], v[132:135], a[108:111], v[72:87]
    ds_read_b128 v[124:127], v15 offset:63488
    s_waitcnt vmcnt(8)
    s_waitcnt lgkmcnt(4)
    v_mfma_f32_32x32x16_bf16 v[56:71], v[104:107], a[112:115], v[56:71]
    buffer_load_dwordx4 v2, s[24:27], s63 offen offset:1024 sc1 lds
    ds_read_b128 v[128:131], v15 offset:31744
    v_mfma_f32_32x32x16_bf16 v[72:87], v[108:111], a[112:115], v[72:87]
    ds_read_b128 v[132:135], v15 offset:64512
    s_waitcnt vmcnt(8)
    s_waitcnt lgkmcnt(4)
    v_mfma_f32_32x32x16_bf16 v[56:71], v[112:115], a[116:119], v[56:71]
    buffer_load_dwordx4 v2, s[24:27], s63 offen offset:2048 sc1 lds
    ds_read_b128 v[104:107], v18 offset:0
    v_mfma_f32_32x32x16_bf16 v[72:87], v[116:119], a[116:119], v[72:87]
    ds_read_b128 v[108:111], v18 offset:1024
    s_waitcnt vmcnt(8)
    s_waitcnt lgkmcnt(4)
    v_mfma_f32_32x32x16_bf16 v[56:71], v[120:123], a[120:123], v[56:71]
    buffer_load_dwordx4 v2, s[24:27], s63 offen offset:3072 sc1 lds
    ds_read_b128 v[112:115], v2 offset:0
    v_mfma_f32_32x32x16_bf16 v[72:87], v[124:127], a[120:123], v[72:87]
    ds_read_b128 v[116:119], v2 offset:1024
    s_waitcnt vmcnt(8)
    s_waitcnt lgkmcnt(4)
    v_mfma_f32_32x32x16_bf16 v[56:71], v[128:131], a[124:127], v[56:71]
    ds_read_b128 v[120:123], v2 offset:2048
    v_mfma_f32_32x32x16_bf16 v[72:87], v[132:135], a[124:127], v[72:87]
    ds_read_b128 v[124:127], v2 offset:3072
    s_waitcnt lgkmcnt(4)
    v_mfma_f32_32x32x16_bf16 v[56:71], v[104:107], v[136:139], v[56:71]
    ds_read_b128 v[128:131], v2 offset:4096
    v_mfma_f32_32x32x16_bf16 v[72:87], v[108:111], v[136:139], v[72:87]
    ds_read_b128 v[132:135], v2 offset:5120
    s_waitcnt lgkmcnt(4)
    v_mfma_f32_32x32x16_bf16 v[88:103], v[112:115], a[0:3], 0
    ds_read_b128 v[104:107], v2 offset:6144
    v_mfma_f32_32x32x16_bf16 v[88:103], v[116:119], a[4:7], v[88:103]
    ds_read_b128 v[108:111], v2 offset:7168
    s_barrier
    s_waitcnt lgkmcnt(4)
    v_mfma_f32_32x32x16_bf16 v[88:103], v[120:123], a[8:11], v[88:103]
    s_add_u32 m0, s82, 65536
    s_add_u32 s63, s83, 131072
    buffer_load_dwordx4 v2, s[24:27], s63 offen offset:0 sc1 lds
    ds_read_b128 v[112:115], v2 offset:8192
    v_mfma_f32_32x32x16_bf16 v[88:103], v[124:127], a[12:15], v[88:103]
    ds_read_b128 v[116:119], v2 offset:9216
    v_mul_f32 v144, v56, v56
    v_mul_f32 v145, v57, v57
    v_mul_f32 v146, v58, v58
    v_mul_f32 v147, v59, v59
    v_fma_f32 v144, v144, v141, v140
    s_waitcnt lgkmcnt(4)
    v_mfma_f32_32x32x16_bf16 v[88:103], v[128:131], a[16:19], v[88:103]
    s_add_u32 s64, s84, 0
    buffer_load_dwordx4 v[156:159], v16, s[24:27], s64 offen offset:0 sc1
    ds_read_b128 v[120:123], v2 offset:10240
    v_fma_f32 v145, v145, v141, v140
    v_mfma_f32_32x32x16_bf16 v[88:103], v[132:135], a[20:23], v[88:103]
    ds_read_b128 v[124:127], v2 offset:11264
    v_fma_f32 v146, v146, v141, v140
    v_fma_f32 v147, v147, v141, v140
    v_mul_f32 v144, v144, v56
    v_mul_f32 v145, v145, v57
    v_mul_f32 v146, v146, v58
    s_waitcnt lgkmcnt(4)
    v_mfma_f32_32x32x16_bf16 v[88:103], v[104:107], a[24:27], v[88:103]
    buffer_load_dwordx4 v2, s[24:27], s63 offen offset:1024 sc1 lds
    ds_read_b128 v[128:131], v2 offset:12288
    v_mul_f32 v147, v147, v59
    v_exp_f32 v144, v144
    v_mfma_f32_32x32x16_bf16 v[88:103], v[108:111], a[28:31], v[88:103]
    ds_read_b128 v[132:135], v2 offset:13312
    v_mul_f32 v56, v56, v64
    v_exp_f32 v145, v145
    v_mul_f32 v57, v57, v65
    v_exp_f32 v146, v146
    s_waitcnt lgkmcnt(4)
    v_mfma_f32_32x32x16_bf16 v[88:103], v[112:115], a[32:35], v[88:103]
    s_add_u32 s64, s84, 7168
    buffer_load_dwordx4 v[160:163], v16, s[24:27], s64 offen offset:0 sc1
    ds_read_b128 v[104:107], v2 offset:14336
    v_mul_f32 v58, v58, v66
    v_mfma_f32_32x32x16_bf16 v[88:103], v[116:119], a[36:39], v[88:103]
    ds_read_b128 v[108:111], v2 offset:15360
    v_exp_f32 v147, v147
    v_mul_f32 v59, v59, v67
    v_fma_f32 v144, v144, v142, v142
    v_fma_f32 v145, v145, v142, v142
    s_waitcnt lgkmcnt(4)
    v_mfma_f32_32x32x16_bf16 v[88:103], v[120:123], a[40:43], v[88:103]
    buffer_load_dwordx4 v2, s[24:27], s63 offen offset:2048 sc1 lds
    ds_read_b128 v[112:115], v2 offset:16384
    v_fma_f32 v146, v146, v142, v142
    v_fma_f32 v147, v147, v142, v142
    v_mfma_f32_32x32x16_bf16 v[88:103], v[124:127], a[44:47], v[88:103]
    ds_read_b128 v[116:119], v2 offset:17408
    v_rcp_f32 v144, v144
    v_rcp_f32 v145, v145
    v_rcp_f32 v146, v146
    s_waitcnt lgkmcnt(4)
    v_mfma_f32_32x32x16_bf16 v[88:103], v[128:131], a[48:51], v[88:103]
    s_add_u32 s64, s84, 14336
    buffer_load_dwordx4 v[164:167], v16, s[24:27], s64 offen offset:0 sc1
    ds_read_b128 v[120:123], v2 offset:18432
    v_rcp_f32 v147, v147
    v_mfma_f32_32x32x16_bf16 v[88:103], v[132:135], a[52:55], v[88:103]
    ds_read_b128 v[124:127], v2 offset:19456
    v_mul_f32 v56, v56, v144
    v_mul_f32 v57, v57, v145
    v_mul_f32 v58, v58, v146
    v_mul_f32 v59, v59, v147
    v_cvt_pk_bf16_f32 v152, v56, v57
    s_waitcnt lgkmcnt(4)
    v_mfma_f32_32x32x16_bf16 v[88:103], v[104:107], a[56:59], v[88:103]
    buffer_load_dwordx4 v2, s[24:27], s63 offen offset:3072 sc1 lds
    ds_read_b128 v[128:131], v2 offset:20480
    v_cvt_pk_bf16_f32 v153, v58, v59
    v_mul_f32 v148, v60, v60
    v_mfma_f32_32x32x16_bf16 v[88:103], v[108:111], a[60:63], v[88:103]
    ds_read_b128 v[132:135], v2 offset:21504
    v_mul_f32 v149, v61, v61
    v_mul_f32 v150, v62, v62
    v_mul_f32 v151, v63, v63
    v_fma_f32 v148, v148, v141, v140
    v_fma_f32 v149, v149, v141, v140
    s_waitcnt lgkmcnt(4)
    v_mfma_f32_32x32x16_bf16 v[88:103], v[112:115], a[64:67], v[88:103]
    s_add_u32 s64, s84, 21504
    buffer_load_dwordx4 v[168:171], v16, s[24:27], s64 offen offset:0 sc1
    ds_read_b128 v[104:107], v2 offset:22528
    v_fma_f32 v150, v150, v141, v140
    v_mfma_f32_32x32x16_bf16 v[88:103], v[116:119], a[68:71], v[88:103]
    ds_read_b128 v[108:111], v2 offset:23552
    v_fma_f32 v151, v151, v141, v140
    v_mul_f32 v148, v148, v60
    v_mul_f32 v149, v149, v61
    v_mul_f32 v150, v150, v62
    v_mul_f32 v151, v151, v63
    s_waitcnt lgkmcnt(4)
    v_mfma_f32_32x32x16_bf16 v[88:103], v[120:123], a[72:75], v[88:103]
    s_add_u32 m0, s82, 69632
    s_add_u32 s63, s83, 135168
    buffer_load_dwordx4 v2, s[24:27], s63 offen offset:0 sc1 lds
    ds_read_b128 v[112:115], v2 offset:24576
    v_exp_f32 v148, v148
    v_mfma_f32_32x32x16_bf16 v[88:103], v[124:127], a[76:79], v[88:103]
    ds_read_b128 v[116:119], v2 offset:25600
    v_mul_f32 v60, v60, v68
    v_exp_f32 v149, v149
    v_mul_f32 v61, v61, v69
    v_exp_f32 v150, v150
    s_waitcnt lgkmcnt(4)
    v_mfma_f32_32x32x16_bf16 v[88:103], v[128:131], a[80:83], v[88:103]
    s_add_u32 s64, s84, 28672
    buffer_load_dwordx4 a[192:195], v2, s[24:27], s64 offen offset:0 sc1
    ds_read_b128 v[120:123], v2 offset:26624
    v_mul_f32 v62, v62, v70
    v_exp_f32 v151, v151
    v_mfma_f32_32x32x16_bf16 v[88:103], v[132:135], a[84:87], v[88:103]
    ds_read_b128 v[124:127], v2 offset:27648
    v_mul_f32 v63, v63, v71
    v_fma_f32 v148, v148, v142, v142
    v_fma_f32 v149, v149, v142, v142
    v_fma_f32 v150, v150, v142, v142
    v_fma_f32 v151, v151, v142, v142
    s_waitcnt lgkmcnt(4)
    v_mfma_f32_32x32x16_bf16 v[88:103], v[104:107], a[88:91], v[88:103]
    buffer_load_dwordx4 v2, s[24:27], s63 offen offset:1024 sc1 lds
    ds_read_b128 v[128:131], v2 offset:28672
    v_rcp_f32 v148, v148
    v_mfma_f32_32x32x16_bf16 v[88:103], v[108:111], a[92:95], v[88:103]
    ds_read_b128 v[132:135], v2 offset:29696
    v_rcp_f32 v149, v149
    v_rcp_f32 v150, v150
    v_rcp_f32 v151, v151
    s_waitcnt vmcnt(11)
    s_barrier
    s_waitcnt lgkmcnt(4)
    v_mfma_f32_32x32x16_bf16 v[88:103], v[112:115], a[96:99], v[88:103]
    buffer_load_dwordx4 a[196:199], v2, s[24:27], s64 offen offset:1024 sc1
    ds_read_b128 v[104:107], v2 offset:30720
    v_mul_f32 v60, v60, v148
    v_mul_f32 v61, v61, v149
    v_mul_f32 v62, v62, v150
    v_mfma_f32_32x32x16_bf16 v[88:103], v[116:119], a[100:103], v[88:103]
    ds_read_b128 v[108:111], v2 offset:31744
    v_mul_f32 v63, v63, v151
    v_cvt_pk_bf16_f32 v154, v60, v61
    v_cvt_pk_bf16_f32 v155, v62, v63
    buffer_store_dwordx4 v[152:155], v4, s[24:27], s87 offen offset:0 sc1
    s_waitcnt lgkmcnt(4)
    v_mfma_f32_32x32x16_bf16 v[88:103], v[120:123], a[104:107], v[88:103]
    buffer_load_dwordx4 v2, s[24:27], s63 offen offset:2048 sc1 lds
    ds_read_b128 v[112:115], v18 offset:2048
    v_mul_f32 v144, v72, v72
    v_mul_f32 v145, v73, v73
    v_mfma_f32_32x32x16_bf16 v[88:103], v[124:127], a[108:111], v[88:103]
    ds_read_b128 v[116:119], v2 offset:32768
    v_mul_f32 v146, v74, v74
    v_mul_f32 v147, v75, v75
    v_fma_f32 v144, v144, v141, v140
    v_fma_f32 v145, v145, v141, v140
    v_fma_f32 v146, v146, v141, v140
    s_waitcnt lgkmcnt(4)
    v_mfma_f32_32x32x16_bf16 v[88:103], v[128:131], a[112:115], v[88:103]
    buffer_load_dwordx4 a[200:203], v2, s[24:27], s64 offen offset:2048 sc1
    ds_read_b128 v[120:123], v2 offset:33792
    v_fma_f32 v147, v147, v141, v140
    v_mul_f32 v144, v144, v72
    v_mfma_f32_32x32x16_bf16 v[88:103], v[132:135], a[116:119], v[88:103]
    ds_read_b128 v[124:127], v2 offset:34816
    v_mul_f32 v145, v145, v73
    v_mul_f32 v146, v146, v74
    v_mul_f32 v147, v147, v75
    v_exp_f32 v144, v144
    s_waitcnt lgkmcnt(4)
    v_mfma_f32_32x32x16_bf16 v[88:103], v[104:107], a[120:123], v[88:103]
    buffer_load_dwordx4 v2, s[24:27], s63 offen offset:3072 sc1 lds
    ds_read_b128 v[128:131], v2 offset:35840
    v_mul_f32 v72, v72, v80
    v_exp_f32 v145, v145
    v_mfma_f32_32x32x16_bf16 v[88:103], v[108:111], a[124:127], v[88:103]
    ds_read_b128 v[132:135], v2 offset:36864
    v_mul_f32 v73, v73, v81
    v_exp_f32 v146, v146
    v_mul_f32 v74, v74, v82
    v_exp_f32 v147, v147
    s_waitcnt lgkmcnt(4)
    v_mfma_f32_32x32x16_bf16 v[88:103], v[112:115], v[136:139], v[88:103]
    buffer_load_dwordx4 a[204:207], v2, s[24:27], s64 offen offset:3072 sc1
    ds_read_b128 v[104:107], v2 offset:37888
    v_mul_f32 v75, v75, v83
    v_fma_f32 v144, v144, v142, v142
    v_mfma_f32_32x32x16_bf16 v[56:71], v[116:119], a[0:3], 0
    ds_read_b128 v[108:111], v2 offset:38912
    v_fma_f32 v145, v145, v142, v142
    v_fma_f32 v146, v146, v142, v142
    v_fma_f32 v147, v147, v142, v142
    v_rcp_f32 v144, v144
    s_waitcnt lgkmcnt(4)
    v_mfma_f32_32x32x16_bf16 v[56:71], v[120:123], a[4:7], v[56:71]
    buffer_load_dwordx4 v[172:175], v16, s[24:27], s64 offen offset:0 sc1
    ds_read_b128 v[112:115], v2 offset:39936
    v_rcp_f32 v145, v145
    v_mfma_f32_32x32x16_bf16 v[56:71], v[124:127], a[8:11], v[56:71]
    ds_read_b128 v[116:119], v2 offset:40960
    v_rcp_f32 v146, v146
    v_rcp_f32 v147, v147
    v_mul_f32 v72, v72, v144
    s_waitcnt lgkmcnt(4)
    v_mfma_f32_32x32x16_bf16 v[56:71], v[128:131], a[12:15], v[56:71]
    s_add_u32 s64, s84, 35840
    buffer_load_dwordx4 a[208:211], v2, s[24:27], s64 offen offset:0 sc1
    ds_read_b128 v[120:123], v2 offset:41984
    v_mul_f32 v73, v73, v145
    v_mfma_f32_32x32x16_bf16 v[56:71], v[132:135], a[16:19], v[56:71]
    ds_read_b128 v[124:127], v2 offset:43008
    v_mul_f32 v74, v74, v146
    v_mul_f32 v75, v75, v147
    v_cvt_pk_bf16_f32 v152, v72, v73
    v_cvt_pk_bf16_f32 v153, v74, v75
    v_mul_f32 v148, v76, v76
    s_waitcnt lgkmcnt(4)
    v_mfma_f32_32x32x16_bf16 v[56:71], v[104:107], a[20:23], v[56:71]
    s_add_u32 m0, s82, 98304
    s_add_u32 s63, s83, 163840
    buffer_load_dwordx4 v2, s[24:27], s63 offen offset:0 sc1 lds
    ds_read_b128 v[128:131], v2 offset:44032
    v_mfma_f32_32x32x16_bf16 v[56:71], v[108:111], a[24:27], v[56:71]
    ds_read_b128 v[132:135], v2 offset:45056
    v_mul_f32 v149, v77, v77
    v_mul_f32 v150, v78, v78
    v_mul_f32 v151, v79, v79
    v_fma_f32 v148, v148, v141, v140
    v_fma_f32 v149, v149, v141, v140
    s_waitcnt lgkmcnt(4)
    v_mfma_f32_32x32x16_bf16 v[56:71], v[112:115], a[28:31], v[56:71]
    buffer_load_dwordx4 a[212:215], v2, s[24:27], s64 offen offset:1024 sc1
    ds_read_b128 v[104:107], v2 offset:46080
    v_fma_f32 v150, v150, v141, v140
    v_fma_f32 v151, v151, v141, v140
    v_mfma_f32_32x32x16_bf16 v[56:71], v[116:119], a[32:35], v[56:71]
    ds_read_b128 v[108:111], v2 offset:47104
    v_mul_f32 v148, v148, v76
    v_mul_f32 v149, v149, v77
    v_mul_f32 v150, v150, v78
    v_mul_f32 v151, v151, v79
    v_exp_f32 v148, v148
    s_waitcnt lgkmcnt(4)
    v_mfma_f32_32x32x16_bf16 v[56:71], v[120:123], a[36:39], v[56:71]
    buffer_load_dwordx4 v2, s[24:27], s63 offen offset:1024 sc1 lds
    ds_read_b128 v[112:115], v2 offset:48128
    v_mul_f32 v76, v76, v84
    v_exp_f32 v149, v149
    v_mfma_f32_32x32x16_bf16 v[56:71], v[124:127], a[40:43], v[56:71]
    ds_read_b128 v[116:119], v2 offset:49152
    v_mul_f32 v77, v77, v85
    v_exp_f32 v150, v150
    v_mul_f32 v78, v78, v86
    v_exp_f32 v151, v151
    s_waitcnt lgkmcnt(4)
    v_mfma_f32_32x32x16_bf16 v[56:71], v[128:131], a[44:47], v[56:71]
    buffer_load_dwordx4 a[216:219], v2, s[24:27], s64 offen offset:2048 sc1
    ds_read_b128 v[120:123], v2 offset:50176
    v_mul_f32 v79, v79, v87
    v_fma_f32 v148, v148, v142, v142
    v_mfma_f32_32x32x16_bf16 v[56:71], v[132:135], a[48:51], v[56:71]
    ds_read_b128 v[124:127], v2 offset:51200
    v_fma_f32 v149, v149, v142, v142
    v_fma_f32 v150, v150, v142, v142
    v_fma_f32 v151, v151, v142, v142
    v_rcp_f32 v148, v148
    s_waitcnt lgkmcnt(4)
    v_mfma_f32_32x32x16_bf16 v[56:71], v[104:107], a[52:55], v[56:71]
    buffer_load_dwordx4 v2, s[24:27], s63 offen offset:2048 sc1 lds
    ds_read_b128 v[128:131], v2 offset:52224
    v_rcp_f32 v149, v149
    v_mfma_f32_32x32x16_bf16 v[56:71], v[108:111], a[56:59], v[56:71]
    ds_read_b128 v[132:135], v2 offset:53248
    v_rcp_f32 v150, v150
    v_rcp_f32 v151, v151
    v_mul_f32 v76, v76, v148
    s_waitcnt lgkmcnt(4)
    v_mfma_f32_32x32x16_bf16 v[56:71], v[112:115], a[60:63], v[56:71]
    buffer_load_dwordx4 a[220:223], v2, s[24:27], s64 offen offset:3072 sc1
    ds_read_b128 v[104:107], v2 offset:54272
    v_mul_f32 v77, v77, v149
    v_mul_f32 v78, v78, v150
    v_mfma_f32_32x32x16_bf16 v[56:71], v[116:119], a[64:67], v[56:71]
    ds_read_b128 v[108:111], v2 offset:55296
    v_mul_f32 v79, v79, v151
    v_cvt_pk_bf16_f32 v154, v76, v77
    v_cvt_pk_bf16_f32 v155, v78, v79
    buffer_store_dwordx4 v[152:155], v4, s[24:27], s87 offen offset:512 sc1
    s_waitcnt lgkmcnt(4)
    v_mfma_f32_32x32x16_bf16 v[56:71], v[120:123], a[68:71], v[56:71]
    buffer_load_dwordx4 v2, s[24:27], s63 offen offset:3072 sc1 lds
    ds_read_b128 v[112:115], v2 offset:56320
    v_mul_f32 v144, v88, v88
    v_mul_f32 v145, v89, v89
    v_mfma_f32_32x32x16_bf16 v[56:71], v[124:127], a[72:75], v[56:71]
    ds_read_b128 v[116:119], v2 offset:57344
    v_mul_f32 v146, v90, v90
    v_mul_f32 v147, v91, v91
    v_fma_f32 v144, v144, v141, v140
    v_fma_f32 v145, v145, v141, v140
    v_fma_f32 v146, v146, v141, v140
    s_waitcnt lgkmcnt(4)
    v_mfma_f32_32x32x16_bf16 v[56:71], v[128:131], a[76:79], v[56:71]
    buffer_load_dwordx4 v[176:179], v16, s[24:27], s64 offen offset:0 sc1
    ds_read_b128 v[120:123], v2 offset:58368
    v_fma_f32 v147, v147, v141, v140
    v_mul_f32 v144, v144, v88
    v_mfma_f32_32x32x16_bf16 v[56:71], v[132:135], a[80:83], v[56:71]
    ds_read_b128 v[124:127], v2 offset:59392
    v_mul_f32 v145, v145, v89
    v_mul_f32 v146, v146, v90
    v_mul_f32 v147, v147, v91
    v_exp_f32 v144, v144
    s_waitcnt lgkmcnt(4)
    v_mfma_f32_32x32x16_bf16 v[56:71], v[104:107], a[84:87], v[56:71]
    s_add_u32 m0, s82, 102400
    s_add_u32 s63, s83, 167936
    buffer_load_dwordx4 v2, s[24:27], s63 offen offset:0 sc1 lds
    ds_read_b128 v[128:131], v2 offset:60416
    v_mfma_f32_32x32x16_bf16 v[56:71], v[108:111], a[88:91], v[56:71]
    ds_read_b128 v[132:135], v2 offset:61440
    v_mul_f32 v88, v88, v96
    v_exp_f32 v145, v145
    v_mul_f32 v89, v89, v97
    v_exp_f32 v146, v146
    s_waitcnt lgkmcnt(4)
    v_mfma_f32_32x32x16_bf16 v[56:71], v[112:115], a[92:95], v[56:71]
    s_add_u32 s64, s84, 43008
    buffer_load_dwordx4 a[224:227], v2, s[24:27], s64 offen offset:0 sc1
    ds_read_b128 v[104:107], v2 offset:62464
    v_mul_f32 v90, v90, v98
    s_waitcnt vmcnt(14)
    s_barrier
    v_mfma_f32_32x32x16_bf16 v[56:71], v[116:119], a[96:99], v[56:71]
    ds_read_b128 v[108:111], v2 offset:63488
    v_exp_f32 v147, v147
    v_mul_f32 v91, v91, v99
    v_fma_f32 v144, v144, v142, v142
    v_fma_f32 v145, v145, v142, v142
    s_waitcnt lgkmcnt(4)
    v_mfma_f32_32x32x16_bf16 v[56:71], v[120:123], a[100:103], v[56:71]
    buffer_load_dwordx4 v2, s[24:27], s63 offen offset:1024 sc1 lds
    ds_read_b128 v[112:115], v2 offset:64512
    v_fma_f32 v146, v146, v142, v142
    v_fma_f32 v147, v147, v142, v142
    v_mfma_f32_32x32x16_bf16 v[56:71], v[124:127], a[104:107], v[56:71]
    ds_read_b128 v[116:119], v18 offset:3072
    v_rcp_f32 v144, v144
    v_rcp_f32 v145, v145
    v_rcp_f32 v146, v146
    s_waitcnt lgkmcnt(4)
    v_mfma_f32_32x32x16_bf16 v[56:71], v[128:131], a[108:111], v[56:71]
    buffer_load_dwordx4 a[228:231], v2, s[24:27], s64 offen offset:1024 sc1
    ds_read_b128 v[120:123], v15 offset:0
    v_rcp_f32 v147, v147
    v_mfma_f32_32x32x16_bf16 v[56:71], v[132:135], a[112:115], v[56:71]
    ds_read_b128 v[124:127], v15 offset:1024
    v_mul_f32 v88, v88, v144
    v_mul_f32 v89, v89, v145
    v_mul_f32 v90, v90, v146
    v_mul_f32 v91, v91, v147
    v_cvt_pk_bf16_f32 v152, v88, v89
    s_waitcnt lgkmcnt(4)
    v_mfma_f32_32x32x16_bf16 v[56:71], v[104:107], a[116:119], v[56:71]
    buffer_load_dwordx4 v2, s[24:27], s63 offen offset:2048 sc1 lds
    ds_read_b128 v[128:131], v15 offset:2048
    v_cvt_pk_bf16_f32 v153, v90, v91
    v_mul_f32 v148, v92, v92
    v_mfma_f32_32x32x16_bf16 v[56:71], v[108:111], a[120:123], v[56:71]
    ds_read_b128 v[132:135], v15 offset:3072
    v_mul_f32 v149, v93, v93
    v_mul_f32 v150, v94, v94
    v_mul_f32 v151, v95, v95
    v_fma_f32 v148, v148, v141, v140
    v_fma_f32 v149, v149, v141, v140
    s_waitcnt lgkmcnt(4)
    v_mfma_f32_32x32x16_bf16 v[56:71], v[112:115], a[124:127], v[56:71]
    buffer_load_dwordx4 a[232:235], v2, s[24:27], s64 offen offset:2048 sc1
    ds_read_b128 v[104:107], v15 offset:4096
    v_fma_f32 v150, v150, v141, v140
    v_fma_f32 v151, v151, v141, v140
    v_mfma_f32_32x32x16_bf16 v[56:71], v[116:119], v[136:139], v[56:71]
    ds_read_b128 v[108:111], v15 offset:5120
    v_mul_f32 v148, v148, v92
    v_mul_f32 v149, v149, v93
    v_mul_f32 v150, v150, v94
    v_mul_f32 v151, v151, v95
    v_exp_f32 v148, v148
    s_waitcnt lgkmcnt(4)
    v_mfma_f32_32x32x16_bf16 v[72:87], v[120:123], a[0:3], 0
    buffer_load_dwordx4 v2, s[24:27], s63 offen offset:3072 sc1 lds
    ds_read_b128 v[112:115], v15 offset:6144
    v_mul_f32 v92, v92, v100
    v_exp_f32 v149, v149
    v_mfma_f32_32x32x16_bf16 v[72:87], v[124:127], a[4:7], v[72:87]
    ds_read_b128 v[116:119], v15 offset:7168
    v_mul_f32 v93, v93, v101
    v_exp_f32 v150, v150
    v_mul_f32 v94, v94, v102
    v_exp_f32 v151, v151
    s_waitcnt lgkmcnt(4)
    v_mfma_f32_32x32x16_bf16 v[72:87], v[128:131], a[8:11], v[72:87]
    buffer_load_dwordx4 a[236:239], v2, s[24:27], s64 offen offset:3072 sc1
    ds_read_b128 v[120:123], v15 offset:8192
    v_mul_f32 v95, v95, v103
    v_fma_f32 v148, v148, v142, v142
    v_mfma_f32_32x32x16_bf16 v[72:87], v[132:135], a[12:15], v[72:87]
    ds_read_b128 v[124:127], v15 offset:9216
    v_fma_f32 v149, v149, v142, v142
    v_fma_f32 v150, v150, v142, v142
    v_fma_f32 v151, v151, v142, v142
    v_rcp_f32 v148, v148
    s_waitcnt lgkmcnt(4)
    v_mfma_f32_32x32x16_bf16 v[72:87], v[104:107], a[16:19], v[72:87]
    s_add_u32 m0, s82, 0
    s_add_u32 s63, s83, 196608
    buffer_load_dwordx4 v2, s[24:27], s63 offen offset:0 sc1 lds
    ds_read_b128 v[128:131], v15 offset:10240
    v_mfma_f32_32x32x16_bf16 v[72:87], v[108:111], a[20:23], v[72:87]
    ds_read_b128 v[132:135], v15 offset:11264
    v_rcp_f32 v149, v149
    v_rcp_f32 v150, v150
    v_rcp_f32 v151, v151
    s_waitcnt vmcnt(11)
    s_barrier
    s_cmp_lg_u32 s66, 0
    s_cbranch_scc1 L_sig_125
    s_mov_b64 exec, 0xffff
    v_mov_b32 v52, 0x1
    buffer_atomic_add v52, v7, s[24:27], 0 offen offset:8 sc1
    s_mov_b64 exec, -1
L_sig_125:
    s_waitcnt lgkmcnt(4)
    v_mfma_f32_32x32x16_bf16 v[72:87], v[112:115], a[24:27], v[72:87]
    buffer_load_dwordx4 v[180:183], v16, s[24:27], s64 offen offset:0 sc1
    ds_read_b128 v[104:107], v15 offset:12288
    v_mul_f32 v92, v92, v148
    v_mul_f32 v93, v93, v149
    v_mfma_f32_32x32x16_bf16 v[72:87], v[116:119], a[28:31], v[72:87]
    ds_read_b128 v[108:111], v15 offset:13312
    v_mul_f32 v94, v94, v150
    v_mul_f32 v95, v95, v151
    v_cvt_pk_bf16_f32 v154, v92, v93
    v_cvt_pk_bf16_f32 v155, v94, v95
    buffer_store_dwordx4 v[152:155], v4, s[24:27], s87 offen offset:1024 sc1
    s_waitcnt lgkmcnt(4)
    v_mfma_f32_32x32x16_bf16 v[72:87], v[120:123], a[32:35], v[72:87]
    buffer_load_dwordx4 v2, s[24:27], s63 offen offset:1024 sc1 lds
    ds_read_b128 v[112:115], v15 offset:14336
    v_mul_f32 v144, v56, v56
    v_mul_f32 v145, v57, v57
    v_mfma_f32_32x32x16_bf16 v[72:87], v[124:127], a[36:39], v[72:87]
    ds_read_b128 v[116:119], v15 offset:15360
    v_mul_f32 v146, v58, v58
    v_mul_f32 v147, v59, v59
    v_fma_f32 v144, v144, v141, v140
    v_fma_f32 v145, v145, v141, v140
    v_fma_f32 v146, v146, v141, v140
    s_waitcnt lgkmcnt(4)
    v_mfma_f32_32x32x16_bf16 v[72:87], v[128:131], a[40:43], v[72:87]
    s_add_u32 s64, s84, 50176
    buffer_load_dwordx4 a[240:243], v2, s[24:27], s64 offen offset:0 sc1
    ds_read_b128 v[120:123], v15 offset:16384
    v_fma_f32 v147, v147, v141, v140
    v_mfma_f32_32x32x16_bf16 v[72:87], v[132:135], a[44:47], v[72:87]
    ds_read_b128 v[124:127], v15 offset:17408
    v_mul_f32 v144, v144, v56
    v_mul_f32 v145, v145, v57
    v_mul_f32 v146, v146, v58
    v_mul_f32 v147, v147, v59
    v_exp_f32 v144, v144
    s_waitcnt lgkmcnt(4)
    v_mfma_f32_32x32x16_bf16 v[72:87], v[104:107], a[48:51], v[72:87]
    buffer_load_dwordx4 v2, s[24:27], s63 offen offset:2048 sc1 lds
    ds_read_b128 v[128:131], v15 offset:18432
    v_mul_f32 v56, v56, v64
    v_exp_f32 v145, v145
    v_mfma_f32_32x32x16_bf16 v[72:87], v[108:111], a[52:55], v[72:87]
    ds_read_b128 v[132:135], v15 offset:19456
    v_mul_f32 v57, v57, v65
    v_exp_f32 v146, v146
    v_mul_f32 v58, v58, v66
    v_exp_f32 v147, v147
    s_waitcnt lgkmcnt(4)
    v_mfma_f32_32x32x16_bf16 v[72:87], v[112:115], a[56:59], v[72:87]
    buffer_load_dwordx4 a[244:247], v2, s[24:27], s64 offen offset:1024 sc1
    ds_read_b128 v[104:107], v15 offset:20480
    v_mul_f32 v59, v59, v67
    v_fma_f32 v144, v144, v142, v142
    v_mfma_f32_32x32x16_bf16 v[72:87], v[116:119], a[60:63], v[72:87]
    ds_read_b128 v[108:111], v15 offset:21504
    v_fma_f32 v145, v145, v142, v142
    v_fma_f32 v146, v146, v142, v142
    v_fma_f32 v147, v147, v142, v142
    v_rcp_f32 v144, v144
    s_waitcnt lgkmcnt(4)
    v_mfma_f32_32x32x16_bf16 v[72:87], v[120:123], a[64:67], v[72:87]
    buffer_load_dwordx4 v2, s[24:27], s63 offen offset:3072 sc1 lds
    ds_read_b128 v[112:115], v15 offset:22528
    v_rcp_f32 v145, v145
    v_mfma_f32_32x32x16_bf16 v[72:87], v[124:127], a[68:71], v[72:87]
    ds_read_b128 v[116:119], v15 offset:23552
    v_rcp_f32 v146, v146
    v_rcp_f32 v147, v147
    v_mul_f32 v56, v56, v144
    s_waitcnt lgkmcnt(4)
    v_mfma_f32_32x32x16_bf16 v[72:87], v[128:131], a[72:75], v[72:87]
    buffer_load_dwordx4 a[248:251], v2, s[24:27], s64 offen offset:2048 sc1
    ds_read_b128 v[120:123], v15 offset:24576
    v_mul_f32 v57, v57, v145
    v_mul_f32 v58, v58, v146
    v_mfma_f32_32x32x16_bf16 v[72:87], v[132:135], a[76:79], v[72:87]
    ds_read_b128 v[124:127], v15 offset:25600
    v_mul_f32 v59, v59, v147
    v_cvt_pk_bf16_f32 v152, v56, v57
    v_cvt_pk_bf16_f32 v153, v58, v59
    v_mul_f32 v148, v60, v60
    v_mul_f32 v149, v61, v61
    s_waitcnt lgkmcnt(4)
    v_mfma_f32_32x32x16_bf16 v[72:87], v[104:107], a[80:83], v[72:87]
    s_add_u32 m0, s82, 4096
    s_add_u32 s63, s83, 200704
    buffer_load_dwordx4 v2, s[24:27], s63 offen offset:0 sc1 lds
    ds_read_b128 v[128:131], v15 offset:26624
    v_mfma_f32_32x32x16_bf16 v[72:87], v[108:111], a[84:87], v[72:87]
    ds_read_b128 v[132:135], v15 offset:27648
    v_mul_f32 v150, v62, v62
    v_mul_f32 v151, v63, v63
    v_fma_f32 v148, v148, v141, v140
    v_fma_f32 v149, v149, v141, v140
    v_fma_f32 v150, v150, v141, v140
    s_waitcnt lgkmcnt(4)
    v_mfma_f32_32x32x16_bf16 v[72:87], v[112:115], a[88:91], v[72:87]
    buffer_load_dwordx4 a[252:255], v2, s[24:27], s64 offen offset:3072 sc1
    ds_read_b128 v[104:107], v15 offset:28672
    v_fma_f32 v151, v151, v141, v140
    v_mul_f32 v148, v148, v60
    v_mfma_f32_32x32x16_bf16 v[72:87], v[116:119], a[92:95], v[72:87]
    ds_read_b128 v[108:111], v15 offset:29696
    v_mul_f32 v149, v149, v61
    v_mul_f32 v150, v150, v62
    v_mul_f32 v151, v151, v63
    v_exp_f32 v148, v148
    s_waitcnt vmcnt(12)
    s_barrier
    s_waitcnt lgkmcnt(4)
    v_mfma_f32_32x32x16_bf16 v[72:87], v[120:123], a[96:99], v[72:87]
    buffer_load_dwordx4 v2, s[24:27], s63 offen offset:1024 sc1 lds
    ds_read_b128 v[112:115], v15 offset:30720
    v_mul_f32 v60, v60, v68
    v_exp_f32 v149, v149
    v_mfma_f32_32x32x16_bf16 v[72:87], v[124:127], a[100:103], v[72:87]
    ds_read_b128 v[116:119], v15 offset:31744
    v_mul_f32 v61, v61, v69
    v_exp_f32 v150, v150
    v_mul_f32 v62, v62, v70
    v_exp_f32 v151, v151
    s_waitcnt lgkmcnt(4)
    v_mfma_f32_32x32x16_bf16 v[72:87], v[128:131], a[104:107], v[72:87]
    buffer_load_dwordx4 v[184:187], v16, s[24:27], s64 offen offset:0 sc1
    ds_read_b128 v[120:123], v18 offset:4096
    v_mul_f32 v63, v63, v71
    v_fma_f32 v148, v148, v142, v142
    v_mfma_f32_32x32x16_bf16 v[72:87], v[132:135], a[108:111], v[72:87]
    ds_read_b128 v[124:127], v15 offset:32768
    v_fma_f32 v149, v149, v142, v142
    v_fma_f32 v150, v150, v142, v142
    v_fma_f32 v151, v151, v142, v142
    v_rcp_f32 v148, v148
    s_waitcnt lgkmcnt(4)
    v_mfma_f32_32x32x16_bf16 v[72:87], v[104:107], a[112:115], v[72:87]
    buffer_load_dwordx4 v2, s[24:27], s63 offen offset:2048 sc1 lds
    ds_read_b128 v[128:131], v15 offset:33792
    v_rcp_f32 v149, v149
    v_mfma_f32_32x32x16_bf16 v[72:87], v[108:111], a[116:119], v[72:87]
    ds_read_b128 v[132:135], v15 offset:34816
    v_rcp_f32 v150, v150
    v_rcp_f32 v151, v151
    v_mul_f32 v60, v60, v148
    s_waitcnt lgkmcnt(4)
    v_mfma_f32_32x32x16_bf16 v[72:87], v[112:115], a[120:123], v[72:87]
    buffer_load_dwordx4 v2, s[24:27], s63 offen offset:3072 sc1 lds
    ds_read_b128 v[104:107], v15 offset:35840
    v_mul_f32 v61, v61, v149
    v_mul_f32 v62, v62, v150
    v_mfma_f32_32x32x16_bf16 v[72:87], v[116:119], a[124:127], v[72:87]
    ds_read_b128 v[108:111], v15 offset:36864
    v_mul_f32 v63, v63, v151
    v_cvt_pk_bf16_f32 v154, v60, v61
    v_cvt_pk_bf16_f32 v155, v62, v63
    buffer_store_dwordx4 v[152:155], v4, s[24:27], s87 offen offset:1536 sc1
    s_waitcnt lgkmcnt(4)
    v_mfma_f32_32x32x16_bf16 v[72:87], v[120:123], v[136:139], v[72:87]
    ds_read_b128 v[112:115], v15 offset:37888
    v_mfma_f32_32x32x16_bf16 v[88:103], v[124:127], a[0:3], 0
    ds_read_b128 v[116:119], v15 offset:38912
    s_waitcnt lgkmcnt(4)
    v_mfma_f32_32x32x16_bf16 v[88:103], v[128:131], a[4:7], v[88:103]
    ds_read_b128 v[120:123], v15 offset:39936
    s_cmp_lg_u32 s66, 1
    s_cbranch_scc1 L_w1_126
    s_add_u32 s62, s86, 8
    v_mov_b32 v51, s62
    s_mov_b64 exec, 1
    v_mov_b32 v52, 0
    buffer_atomic_add v52, v51, s[24:27], 0 offen sc0 sc1
    s_mov_b64 exec, -1
L_w1_126:
    v_mfma_f32_32x32x16_bf16 v[88:103], v[132:135], a[8:11], v[88:103]
    ds_read_b128 v[124:127], v15 offset:40960
    s_waitcnt lgkmcnt(4)
    v_mfma_f32_32x32x16_bf16 v[88:103], v[104:107], a[12:15], v[88:103]
    ds_read_b128 v[128:131], v15 offset:41984
    v_mfma_f32_32x32x16_bf16 v[88:103], v[108:111], a[16:19], v[88:103]
    ds_read_b128 v[132:135], v15 offset:43008
    v_mul_f32 v144, v72, v72
    v_mul_f32 v145, v73, v73
    v_mul_f32 v146, v74, v74
    v_mul_f32 v147, v75, v75
    v_fma_f32 v144, v144, v141, v140
    s_waitcnt lgkmcnt(4)
    v_mfma_f32_32x32x16_bf16 v[88:103], v[112:115], a[20:23], v[88:103]
    ds_read_b128 v[104:107], v15 offset:44032
    v_fma_f32 v145, v145, v141, v140
    v_fma_f32 v146, v146, v141, v140
    v_fma_f32 v147, v147, v141, v140
    v_mul_f32 v144, v144, v72
    v_mfma_f32_32x32x16_bf16 v[88:103], v[116:119], a[24:27], v[88:103]
    ds_read_b128 v[108:111], v15 offset:45056
    v_mul_f32 v145, v145, v73
    v_mul_f32 v146, v146, v74
    v_mul_f32 v147, v147, v75
    v_exp_f32 v144, v144
    s_waitcnt lgkmcnt(4)
    v_mfma_f32_32x32x16_bf16 v[88:103], v[120:123], a[28:31], v[88:103]
    ds_read_b128 v[112:115], v15 offset:46080
    v_mul_f32 v72, v72, v80
    v_exp_f32 v145, v145
    v_mul_f32 v73, v73, v81
    v_mfma_f32_32x32x16_bf16 v[88:103], v[124:127], a[32:35], v[88:103]
    ds_read_b128 v[116:119], v15 offset:47104
    v_exp_f32 v146, v146
    v_mul_f32 v74, v74, v82
    v_exp_f32 v147, v147
    s_waitcnt lgkmcnt(4)
    v_mfma_f32_32x32x16_bf16 v[88:103], v[128:131], a[36:39], v[88:103]
    ds_read_b128 v[120:123], v15 offset:48128
    v_mul_f32 v75, v75, v83
    v_fma_f32 v144, v144, v142, v142
    v_fma_f32 v145, v145, v142, v142
    v_fma_f32 v146, v146, v142, v142
    v_mfma_f32_32x32x16_bf16 v[88:103], v[132:135], a[40:43], v[88:103]
    ds_read_b128 v[124:127], v15 offset:49152
    v_fma_f32 v147, v147, v142, v142
    v_rcp_f32 v144, v144
    v_rcp_f32 v145, v145
    s_waitcnt lgkmcnt(4)
    v_mfma_f32_32x32x16_bf16 v[88:103], v[104:107], a[44:47], v[88:103]
    ds_read_b128 v[128:131], v15 offset:50176
    v_rcp_f32 v146, v146
    v_rcp_f32 v147, v147
    v_mfma_f32_32x32x16_bf16 v[88:103], v[108:111], a[48:51], v[88:103]
    ds_read_b128 v[132:135], v15 offset:51200
    v_mul_f32 v72, v72, v144
    v_mul_f32 v73, v73, v145
    v_mul_f32 v74, v74, v146
    v_mul_f32 v75, v75, v147
    v_cvt_pk_bf16_f32 v152, v72, v73
    s_waitcnt lgkmcnt(4)
    v_mfma_f32_32x32x16_bf16 v[88:103], v[112:115], a[52:55], v[88:103]
    ds_read_b128 v[104:107], v15 offset:52224
    v_cvt_pk_bf16_f32 v153, v74, v75
    v_mul_f32 v148, v76, v76
    v_mul_f32 v149, v77, v77
    v_mul_f32 v150, v78, v78
    v_mfma_f32_32x32x16_bf16 v[88:103], v[116:119], a[56:59], v[88:103]
    ds_read_b128 v[108:111], v15 offset:53248
    v_mul_f32 v151, v79, v79
    v_fma_f32 v148, v148, v141, v140
    v_fma_f32 v149, v149, v141, v140
    v_fma_f32 v150, v150, v141, v140
    v_fma_f32 v151, v151, v141, v140
    s_waitcnt lgkmcnt(4)
    v_mfma_f32_32x32x16_bf16 v[88:103], v[120:123], a[60:63], v[88:103]
    ds_read_b128 v[112:115], v15 offset:54272
    v_mul_f32 v148, v148, v76
    v_mul_f32 v149, v149, v77
    v_mul_f32 v150, v150, v78
    v_mul_f32 v151, v151, v79
    v_mfma_f32_32x32x16_bf16 v[88:103], v[124:127], a[64:67], v[88:103]
    ds_read_b128 v[116:119], v15 offset:55296
    v_exp_f32 v148, v148
    v_mul_f32 v76, v76, v84
    v_exp_f32 v149, v149
    s_waitcnt lgkmcnt(4)
    v_mfma_f32_32x32x16_bf16 v[88:103], v[128:131], a[68:71], v[88:103]
    ds_read_b128 v[120:123], v15 offset:56320
    v_mul_f32 v77, v77, v85
    v_exp_f32 v150, v150
    v_mul_f32 v78, v78, v86
    v_mfma_f32_32x32x16_bf16 v[88:103], v[132:135], a[72:75], v[88:103]
    ds_read_b128 v[124:127], v15 offset:57344
    v_exp_f32 v151, v151
    v_mul_f32 v79, v79, v87
    v_fma_f32 v148, v148, v142, v142
    v_fma_f32 v149, v149, v142, v142
    s_waitcnt lgkmcnt(4)
    v_mfma_f32_32x32x16_bf16 v[88:103], v[104:107], a[76:79], v[88:103]
    ds_read_b128 v[128:131], v15 offset:58368
    v_fma_f32 v150, v150, v142, v142
    v_fma_f32 v151, v151, v142, v142
    v_rcp_f32 v148, v148
    v_mfma_f32_32x32x16_bf16 v[88:103], v[108:111], a[80:83], v[88:103]
    ds_read_b128 v[132:135], v15 offset:59392
    v_rcp_f32 v149, v149
    v_rcp_f32 v150, v150
    v_rcp_f32 v151, v151
    s_waitcnt lgkmcnt(4)
    v_mfma_f32_32x32x16_bf16 v[88:103], v[112:115], a[84:87], v[88:103]
    ds_read_b128 v[104:107], v15 offset:60416
    v_mul_f32 v76, v76, v148
    v_mul_f32 v77, v77, v149
    v_mul_f32 v78, v78, v150
    v_mul_f32 v79, v79, v151
    v_mfma_f32_32x32x16_bf16 v[88:103], v[116:119], a[88:91], v[88:103]
    ds_read_b128 v[108:111], v15 offset:61440
    v_cvt_pk_bf16_f32 v154, v76, v77
    v_cvt_pk_bf16_f32 v155, v78, v79
    buffer_store_dwordx4 v[152:155], v4, s[24:27], s87 offen offset:2048 sc1
    s_waitcnt lgkmcnt(4)
    v_mfma_f32_32x32x16_bf16 v[88:103], v[120:123], a[92:95], v[88:103]
    ds_read_b128 v[112:115], v15 offset:62464
    s_waitcnt vmcnt(1)
    s_cmp_lg_u32 s66, 1
    s_cbranch_scc1 L_w1_127
    s_mov_b64 exec, 1
    s_mov_b32 s90, 0
    s_waitcnt vmcnt(1)
    s_branch L_pollc_130
L_poll_128:
    v_mov_b32 v52, 0
    buffer_atomic_add v52, v51, s[24:27], 0 offen sc0 sc1
    s_waitcnt vmcnt(0)
L_pollc_130:
    v_bfe_u32 v52, v52, 0, 6
    v_cmp_ne_u32 vcc, 16, v52
    s_cbranch_vccz L_polld_129
    s_add_u32 s90, s90, 1
    s_cmp_lt_u32 s90, 0x4000
    s_cbranch_scc1 L_poll_128
    v_mov_b32 v52, 272
    buffer_store_dword v52, v55, s[48:51], 0 offen offset:4
L_polld_129:
    s_mov_b64 exec, -1
L_w1_127:
    s_barrier
    s_cmp_lg_u32 s66, 0
    s_cbranch_scc1 L_sig_131
    s_mov_b64 exec, 0xffff
    v_mov_b32 v52, 0x40
    buffer_atomic_add v52, v7, s[24:27], 0 offen offset:8 sc1
    s_mov_b64 exec, -1
L_sig_131:
    v_mfma_f32_32x32x16_bf16 v[88:103], v[124:127], a[96:99], v[88:103]
    v_add_u32 v254, 0, v4
    s_add_u32 m0, s85, 32768
    ds_read_b128 v[116:119], v15 offset:63488
    buffer_load_dwordx4 v254, s[24:27], s8 offen sc1 lds
    s_waitcnt lgkmcnt(4)
    v_mfma_f32_32x32x16_bf16 v[88:103], v[128:131], a[100:103], v[88:103]
    ds_read_b128 v[120:123], v15 offset:64512
    v_mfma_f32_32x32x16_bf16 v[88:103], v[132:135], a[104:107], v[88:103]
    s_add_u32 m0, s85, 34816
    ds_read_b128 v[124:127], v18 offset:5120
    buffer_load_dwordx4 v254, s[24:27], s9 offen sc1 lds
    s_waitcnt lgkmcnt(4)
    v_mfma_f32_32x32x16_bf16 v[88:103], v[104:107], a[108:111], v[88:103]
    ds_read_b128 v[128:131], v2 offset:0
    v_mfma_f32_32x32x16_bf16 v[88:103], v[108:111], a[112:115], v[88:103]
    s_add_u32 m0, s85, 36864
    ds_read_b128 v[132:135], v2 offset:1024
    buffer_load_dwordx4 v254, s[24:27], s10 offen sc1 lds
    s_waitcnt lgkmcnt(4)
    v_mfma_f32_32x32x16_bf16 v[88:103], v[112:115], a[116:119], v[88:103]
    ds_read_b128 v[104:107], v2 offset:2048
    v_mfma_f32_32x32x16_bf16 v[88:103], v[116:119], a[120:123], v[88:103]
    s_add_u32 m0, s85, 38912
    ds_read_b128 v[108:111], v2 offset:3072
    buffer_load_dwordx4 v254, s[24:27], s11 offen sc1 lds
    s_waitcnt lgkmcnt(4)
    v_mfma_f32_32x32x16_bf16 v[88:103], v[120:123], a[124:127], v[88:103]
    ds_read_b128 v[112:115], v2 offset:4096
    v_mfma_f32_32x32x16_bf16 v[88:103], v[124:127], v[136:139], v[88:103]
    s_add_u32 m0, s85, 40960
    ds_read_b128 v[116:119], v2 offset:5120
    buffer_load_dwordx4 v254, s[24:27], s12 offen sc1 lds
    s_waitcnt lgkmcnt(4)
    v_mfma_f32_32x32x16_bf16 v[56:71], v[128:131], a[0:3], 0
    ds_read_b128 v[120:123], v2 offset:6144
    v_mfma_f32_32x32x16_bf16 v[56:71], v[132:135], a[4:7], v[56:71]
    s_add_u32 m0, s85, 43008
    ds_read_b128 v[124:127], v2 offset:7168
    buffer_load_dwordx4 v254, s[24:27], s13 offen sc1 lds
    s_waitcnt lgkmcnt(4)
    v_mfma_f32_32x32x16_bf16 v[56:71], v[104:107], a[8:11], v[56:71]
    ds_read_b128 v[128:131], v2 offset:8192
    v_mfma_f32_32x32x16_bf16 v[56:71], v[108:111], a[12:15], v[56:71]
    s_add_u32 m0, s85, 45056
    ds_read_b128 v[132:135], v2 offset:9216
    buffer_load_dwordx4 v254, s[24:27], s14 offen sc1 lds
    s_waitcnt lgkmcnt(4)
    v_mfma_f32_32x32x16_bf16 v[56:71], v[112:115], a[16:19], v[56:71]
    ds_read_b128 v[104:107], v2 offset:10240
    v_mul_f32 v144, v88, v88
    v_mul_f32 v145, v89, v89
    v_mul_f32 v146, v90, v90
    v_mul_f32 v147, v91, v91
    v_mfma_f32_32x32x16_bf16 v[56:71], v[116:119], a[20:23], v[56:71]
    s_add_u32 m0, s85, 47104
    ds_read_b128 v[108:111], v2 offset:11264
    buffer_load_dwordx4 v254, s[24:27], s15 offen sc1 lds
    v_fma_f32 v144, v144, v141, v140
    v_fma_f32 v145, v145, v141, v140
    s_waitcnt lgkmcnt(4)
    v_mfma_f32_32x32x16_bf16 v[56:71], v[120:123], a[24:27], v[56:71]
    ds_read_b128 v[112:115], v2 offset:12288
    v_fma_f32 v146, v146, v141, v140
    v_fma_f32 v147, v147, v141, v140
    v_mul_f32 v144, v144, v88
    v_mul_f32 v145, v145, v89
    v_mfma_f32_32x32x16_bf16 v[56:71], v[124:127], a[28:31], v[56:71]
    v_add_u32 v254, 512, v4
    s_add_u32 m0, s85, 65536
    ds_read_b128 v[116:119], v2 offset:13312
    buffer_load_dwordx4 v254, s[24:27], s8 offen sc1 lds
    v_mul_f32 v146, v146, v90
    v_mul_f32 v147, v147, v91
    v_exp_f32 v144, v144
    v_mul_f32 v88, v88, v96
    s_waitcnt lgkmcnt(4)
    v_mfma_f32_32x32x16_bf16 v[56:71], v[128:131], a[32:35], v[56:71]
    ds_read_b128 v[120:123], v2 offset:14336
    v_exp_f32 v145, v145
    v_mul_f32 v89, v89, v97
    v_exp_f32 v146, v146
    v_mul_f32 v90, v90, v98
    v_exp_f32 v147, v147
    v_mfma_f32_32x32x16_bf16 v[56:71], v[132:135], a[36:39], v[56:71]
    s_add_u32 m0, s85, 67584
    ds_read_b128 v[124:127], v2 offset:15360
    buffer_load_dwordx4 v254, s[24:27], s9 offen sc1 lds
    v_mul_f32 v91, v91, v99
    v_fma_f32 v144, v144, v142, v142
    v_fma_f32 v145, v145, v142, v142
    v_fma_f32 v146, v146, v142, v142
    v_fma_f32 v147, v147, v142, v142
    s_waitcnt vmcnt(10)
    s_barrier
    s_cmp_lg_u32 s66, 0
    s_cbranch_scc1 L_sig_132
    s_mov_b64 exec, 0xffff
    v_mov_b32 v52, 0x1000
    buffer_atomic_add v52, v7, s[24:27], 0 offen offset:8 sc1
    s_mov_b64 exec, -1
L_sig_132:
    s_cmp_lg_u32 s66, 1
    s_cbranch_scc1 L_w1_133
    s_add_u32 s62, s86, 8
    v_mov_b32 v51, s62
    s_mov_b64 exec, 1
    v_mov_b32 v52, 0
    buffer_atomic_add v52, v51, s[24:27], 0 offen sc0 sc1
    s_mov_b64 exec, -1
L_w1_133:
    s_waitcnt lgkmcnt(4)
    v_mfma_f32_32x32x16_bf16 v[56:71], v[104:107], a[40:43], v[56:71]
    ds_read_b128 v[128:131], v2 offset:16384
    v_rcp_f32 v144, v144
    v_rcp_f32 v145, v145
    v_rcp_f32 v146, v146
    v_rcp_f32 v147, v147
    v_mul_f32 v88, v88, v144
    v_mfma_f32_32x32x16_bf16 v[56:71], v[108:111], a[44:47], v[56:71]
    s_add_u32 m0, s85, 69632
    ds_read_b128 v[132:135], v2 offset:17408
    buffer_load_dwordx4 v254, s[24:27], s10 offen sc1 lds
    v_mul_f32 v89, v89, v145
    v_mul_f32 v90, v90, v146
    v_mul_f32 v91, v91, v147
    v_cvt_pk_bf16_f32 v152, v88, v89
    v_cvt_pk_bf16_f32 v153, v90, v91
    s_waitcnt lgkmcnt(4)
    v_mfma_f32_32x32x16_bf16 v[56:71], v[112:115], a[48:51], v[56:71]
    ds_read_b128 v[104:107], v2 offset:18432
    v_mul_f32 v148, v92, v92
    v_mul_f32 v149, v93, v93
    v_mul_f32 v150, v94, v94
    v_mul_f32 v151, v95, v95
    v_fma_f32 v148, v148, v141, v140
    v_mfma_f32_32x32x16_bf16 v[56:71], v[116:119], a[52:55], v[56:71]
    s_add_u32 m0, s85, 71680
    ds_read_b128 v[108:111], v2 offset:19456
    buffer_load_dwordx4 v254, s[24:27], s11 offen sc1 lds
    v_fma_f32 v149, v149, v141, v140
    v_fma_f32 v150, v150, v141, v140
    v_fma_f32 v151, v151, v141, v140
    v_mul_f32 v148, v148, v92
    v_mul_f32 v149, v149, v93
    s_waitcnt lgkmcnt(4)
    v_mfma_f32_32x32x16_bf16 v[56:71], v[120:123], a[56:59], v[56:71]
    ds_read_b128 v[112:115], v2 offset:20480
    v_mul_f32 v150, v150, v94
    v_mul_f32 v151, v151, v95
    v_exp_f32 v148, v148
    v_mul_f32 v92, v92, v100
    v_exp_f32 v149, v149
    v_mfma_f32_32x32x16_bf16 v[56:71], v[124:127], a[60:63], v[56:71]
    s_add_u32 m0, s85, 73728
    ds_read_b128 v[116:119], v2 offset:21504
    buffer_load_dwordx4 v254, s[24:27], s12 offen sc1 lds
    v_mul_f32 v93, v93, v101
    v_exp_f32 v150, v150
    v_mul_f32 v94, v94, v102
    v_exp_f32 v151, v151
    v_mul_f32 v95, v95, v103
    s_waitcnt lgkmcnt(4)
    v_mfma_f32_32x32x16_bf16 v[56:71], v[128:131], a[64:67], v[56:71]
    ds_read_b128 v[120:123], v2 offset:22528
    v_fma_f32 v148, v148, v142, v142
    v_fma_f32 v149, v149, v142, v142
    v_fma_f32 v150, v150, v142, v142
    v_fma_f32 v151, v151, v142, v142
    v_rcp_f32 v148, v148
    v_mfma_f32_32x32x16_bf16 v[56:71], v[132:135], a[68:71], v[56:71]
    s_add_u32 m0, s85, 75776
    ds_read_b128 v[124:127], v2 offset:23552
    buffer_load_dwordx4 v254, s[24:27], s13 offen sc1 lds
    v_rcp_f32 v149, v149
    v_rcp_f32 v150, v150
    v_rcp_f32 v151, v151
    v_mul_f32 v92, v92, v148
    v_mul_f32 v93, v93, v149
    s_waitcnt lgkmcnt(4)
    v_mfma_f32_32x32x16_bf16 v[56:71], v[104:107], a[72:75], v[56:71]
    ds_read_b128 v[128:131], v2 offset:24576
    v_mul_f32 v94, v94, v150
    v_mul_f32 v95, v95, v151
    v_cvt_pk_bf16_f32 v154, v92, v93
    v_cvt_pk_bf16_f32 v155, v94, v95
    buffer_store_dwordx4 v[152:155], v4, s[24:27], s87 offen offset:2560 sc1
    v_mfma_f32_32x32x16_bf16 v[56:71], v[108:111], a[76:79], v[56:71]
    s_add_u32 m0, s85, 77824
    ds_read_b128 v[132:135], v2 offset:25600
    buffer_load_dwordx4 v254, s[24:27], s14 offen sc1 lds
    v_lshlrev_b32 v72, 16, v26
    v_and_b32 v73, 0xffff0000, v26
    s_waitcnt lgkmcnt(4)
    v_mfma_f32_32x32x16_bf16 v[56:71], v[112:115], a[80:83], v[56:71]
    ds_read_b128 v[104:107], v2 offset:26624
    v_lshlrev_b32 v74, 16, v27
    v_and_b32 v75, 0xffff0000, v27
    v_lshlrev_b32 v76, 16, v28
    v_and_b32 v77, 0xffff0000, v28
    v_mfma_f32_32x32x16_bf16 v[56:71], v[116:119], a[84:87], v[56:71]
    s_add_u32 m0, s85, 79872
    ds_read_b128 v[108:111], v2 offset:27648
    buffer_load_dwordx4 v254, s[24:27], s15 offen sc1 lds
    v_lshlrev_b32 v78, 16, v29
    v_and_b32 v79, 0xffff0000, v29
    s_waitcnt lgkmcnt(4)
    v_mfma_f32_32x32x16_bf16 v[56:71], v[120:123], a[88:91], v[56:71]
    ds_read_b128 v[112:115], v2 offset:28672
    v_lshlrev_b32 v80, 16, v30
    v_and_b32 v81, 0xffff0000, v30
    v_lshlrev_b32 v82, 16, v31
    v_and_b32 v83, 0xffff0000, v31
    v_mfma_f32_32x32x16_bf16 v[56:71], v[124:127], a[92:95], v[56:71]
    ds_read_b128 v[116:119], v2 offset:29696
    v_lshlrev_b32 v84, 16, v32
    v_and_b32 v85, 0xffff0000, v32
    v_lshlrev_b32 v86, 16, v33
    v_and_b32 v87, 0xffff0000, v33
    s_waitcnt lgkmcnt(4)
    v_mfma_f32_32x32x16_bf16 v[56:71], v[128:131], a[96:99], v[56:71]
    ds_read_b128 v[120:123], v2 offset:30720
    v_mfma_f32_32x32x16_bf16 v[56:71], v[132:135], a[100:103], v[56:71]
    ds_read_b128 v[124:127], v2 offset:31744
    s_waitcnt vmcnt(9)
    s_cmp_lg_u32 s66, 1
    s_cbranch_scc1 L_w1_134
    s_mov_b64 exec, 1
    s_mov_b32 s90, 0
    s_waitcnt vmcnt(7)
    s_branch L_pollc_137
L_poll_135:
    v_mov_b32 v52, 0
    buffer_atomic_add v52, v51, s[24:27], 0 offen sc0 sc1
    s_waitcnt vmcnt(0)
L_pollc_137:
    v_bfe_u32 v52, v52, 6, 6
    v_cmp_ne_u32 vcc, 16, v52
    s_cbranch_vccz L_polld_136
    s_add_u32 s90, s90, 1
    s_cmp_lt_u32 s90, 0x4000
    s_cbranch_scc1 L_poll_135
    v_mov_b32 v52, 273
    buffer_store_dword v52, v55, s[48:51], 0 offen offset:4
L_polld_136:
    s_mov_b64 exec, -1
L_w1_134:
    s_barrier
    s_waitcnt lgkmcnt(4)
    v_mfma_f32_32x32x16_bf16 v[56:71], v[104:107], a[104:107], v[56:71]
    v_add_u32 v254, 1024, v4
    s_add_u32 m0, s85, 98304
    ds_read_b128 v[128:131], v18 offset:6144
    buffer_load_dwordx4 v254, s[24:27], s8 offen sc1 lds
    v_mfma_f32_32x32x16_bf16 v[56:71], v[108:111], a[108:111], v[56:71]
    ds_read_b128 v[132:135], v250 offset:32768
    s_waitcnt lgkmcnt(4)
    v_mfma_f32_32x32x16_bf16 v[56:71], v[112:115], a[112:115], v[56:71]
    s_add_u32 m0, s85, 100352
    ds_read_b128 v[104:107], v251 offset:32768
    buffer_load_dwordx4 v254, s[24:27], s9 offen sc1 lds
    v_mfma_f32_32x32x16_bf16 v[56:71], v[116:119], a[116:119], v[56:71]
    ds_read_b128 v[108:111], v250 offset:34816
    s_waitcnt lgkmcnt(4)
    v_mfma_f32_32x32x16_bf16 v[56:71], v[120:123], a[120:123], v[56:71]
    s_add_u32 m0, s85, 102400
    ds_read_b128 v[112:115], v251 offset:34816
    buffer_load_dwordx4 v254, s[24:27], s10 offen sc1 lds
    v_mfma_f32_32x32x16_bf16 v[56:71], v[124:127], a[124:127], v[56:71]
    ds_read_b128 v[116:119], v250 offset:36864
    s_waitcnt lgkmcnt(4)
    v_mfma_f32_32x32x16_bf16 v[56:71], v[128:131], v[136:139], v[56:71]
    s_add_u32 m0, s85, 104448
    ds_read_b128 v[120:123], v251 offset:36864
    buffer_load_dwordx4 v254, s[24:27], s11 offen sc1 lds
    v_mfma_f32_32x32x16_bf16 v[72:87], a[128:131], v[132:135], v[72:87]
    s_add_u32 m0, s85, 106496
    ds_read_b128 v[124:127], v250 offset:38912
    buffer_load_dwordx4 v254, s[24:27], s12 offen sc1 lds
    s_waitcnt lgkmcnt(4)
    v_mfma_f32_32x32x16_bf16 v[88:103], a[128:131], v[104:107], 0
    s_add_u32 m0, s85, 108544
    ds_read_b128 v[128:131], v251 offset:38912
    buffer_load_dwordx4 v254, s[24:27], s13 offen sc1 lds
    v_mfma_f32_32x32x16_bf16 v[72:87], a[144:147], v[108:111], v[72:87]
    s_add_u32 m0, s85, 110592
    ds_read_b128 v[132:135], v250 offset:40960
    buffer_load_dwordx4 v254, s[24:27], s14 offen sc1 lds
    s_waitcnt lgkmcnt(4)
    v_mfma_f32_32x32x16_bf16 v[88:103], a[144:147], v[112:115], v[88:103]
    s_add_u32 m0, s85, 112640
    ds_read_b128 v[104:107], v251 offset:40960
    buffer_load_dwordx4 v254, s[24:27], s15 offen sc1 lds
    v_mfma_f32_32x32x16_bf16 v[72:87], a[160:163], v[116:119], v[72:87]
    ds_read_b128 v[108:111], v250 offset:43008
    v_mul_f32 v144, v56, v56
    v_mul_f32 v145, v57, v57
    v_mul_f32 v146, v58, v58
    v_mul_f32 v147, v59, v59
    v_fma_f32 v144, v144, v141, v140
    s_waitcnt lgkmcnt(4)
    v_mfma_f32_32x32x16_bf16 v[88:103], a[160:163], v[120:123], v[88:103]
    s_add_u32 s64, s84, 0
    buffer_load_dwordx4 a[0:3], v16, s[24:27], s64 offen offset:1024 sc1
    ds_read_b128 v[112:115], v251 offset:43008
    v_fma_f32 v145, v145, v141, v140
    v_fma_f32 v146, v146, v141, v140
    v_fma_f32 v147, v147, v141, v140
    s_cmp_lg_u32 s66, 1
    s_cbranch_scc1 L_w1_138
    s_add_u32 s62, s86, 8
    v_mov_b32 v51, s62
    s_mov_b64 exec, 1
    v_mov_b32 v52, 0
    buffer_atomic_add v52, v51, s[24:27], 0 offen sc0 sc1
    s_mov_b64 exec, -1
L_w1_138:
    v_mfma_f32_32x32x16_bf16 v[72:87], a[176:179], v[124:127], v[72:87]
    ds_read_b128 v[116:119], v250 offset:45056
    v_mul_f32 v144, v144, v56
    v_mul_f32 v145, v145, v57
    v_mul_f32 v146, v146, v58
    v_mul_f32 v147, v147, v59
    v_exp_f32 v144, v144
    v_mul_f32 v56, v56, v64
    v_exp_f32 v145, v145
    v_mul_f32 v57, v57, v65
    v_exp_f32 v146, v146
    s_waitcnt lgkmcnt(4)
    v_mfma_f32_32x32x16_bf16 v[88:103], a[176:179], v[128:131], v[88:103]
    s_add_u32 s64, s84, 7168
    buffer_load_dwordx4 a[4:7], v16, s[24:27], s64 offen offset:1024 sc1
    ds_read_b128 v[120:123], v251 offset:45056
    v_mul_f32 v58, v58, v66
    v_exp_f32 v147, v147
    v_mul_f32 v59, v59, v67
    v_fma_f32 v144, v144, v142, v142
    v_fma_f32 v145, v145, v142, v142
    v_fma_f32 v146, v146, v142, v142
    v_fma_f32 v147, v147, v142, v142
    v_rcp_f32 v144, v144
    v_mfma_f32_32x32x16_bf16 v[72:87], a[192:195], v[132:135], v[72:87]
    ds_read_b128 v[124:127], v250 offset:47104
    v_rcp_f32 v145, v145
    v_rcp_f32 v146, v146
    v_rcp_f32 v147, v147
    v_mul_f32 v56, v56, v144
    v_mul_f32 v57, v57, v145
    v_mul_f32 v58, v58, v146
    v_mul_f32 v59, v59, v147
    v_cvt_pk_bf16_f32 v152, v56, v57
    v_cvt_pk_bf16_f32 v153, v58, v59
    s_waitcnt vmcnt(10)
    s_barrier
    s_cmp_lg_u32 s66, 0
    s_cbranch_scc1 L_sig_139
    s_mov_b64 exec, 0xffff
    v_mov_b32 v52, 0x40000
    buffer_atomic_add v52, v7, s[24:27], 0 offen offset:8 sc1
    s_mov_b64 exec, -1
L_sig_139:
    s_waitcnt lgkmcnt(4)
    v_mfma_f32_32x32x16_bf16 v[88:103], a[192:195], v[104:107], v[88:103]
    v_add_u32 v254, 1536, v4
    s_add_u32 m0, s85, 0
    ds_read_b128 v[128:131], v251 offset:47104
    buffer_load_dwordx4 v254, s[24:27], s8 offen sc1 lds
    v_mul_f32 v148, v60, v60
    v_mul_f32 v149, v61, v61
    v_mul_f32 v150, v62, v62
    v_mul_f32 v151, v63, v63
    v_fma_f32 v148, v148, v141, v140
    v_fma_f32 v149, v149, v141, v140
    v_fma_f32 v150, v150, v141, v140
    v_fma_f32 v151, v151, v141, v140
    v_mul_f32 v148, v148, v60
    v_mfma_f32_32x32x16_bf16 v[72:87], a[208:211], v[108:111], v[72:87]
    s_add_u32 m0, s85, 2048
    ds_read_b128 v[132:135], v252 offset:0
    buffer_load_dwordx4 v254, s[24:27], s9 offen sc1 lds
    v_mul_f32 v149, v149, v61
    v_mul_f32 v150, v150, v62
    v_mul_f32 v151, v151, v63
    v_exp_f32 v148, v148
    v_mul_f32 v60, v60, v68
    v_exp_f32 v149, v149
    v_mul_f32 v61, v61, v69
    v_exp_f32 v150, v150
    s_waitcnt lgkmcnt(4)
    v_mfma_f32_32x32x16_bf16 v[88:103], a[208:211], v[112:115], v[88:103]
    s_add_u32 m0, s85, 4096
    ds_read_b128 v[104:107], v253 offset:0
    buffer_load_dwordx4 v254, s[24:27], s10 offen sc1 lds
    v_mul_f32 v62, v62, v70
    v_exp_f32 v151, v151
    v_mul_f32 v63, v63, v71
    v_fma_f32 v148, v148, v142, v142
    v_fma_f32 v149, v149, v142, v142
    v_fma_f32 v150, v150, v142, v142
    v_fma_f32 v151, v151, v142, v142
    v_rcp_f32 v148, v148
    v_rcp_f32 v149, v149
    v_mfma_f32_32x32x16_bf16 v[72:87], a[224:227], v[116:119], v[72:87]
    s_add_u32 m0, s85, 6144
    ds_read_b128 v[108:111], v252 offset:2048
    buffer_load_dwordx4 v254, s[24:27], s11 offen sc1 lds
    v_rcp_f32 v150, v150
    v_rcp_f32 v151, v151
    v_mul_f32 v60, v60, v148
    v_mul_f32 v61, v61, v149
    v_mul_f32 v62, v62, v150
    v_mul_f32 v63, v63, v151
    v_cvt_pk_bf16_f32 v154, v60, v61
    v_cvt_pk_bf16_f32 v155, v62, v63
    buffer_store_dwordx4 v[152:155], v4, s[24:27], s87 offen offset:3072 sc1
    s_waitcnt lgkmcnt(4)
    v_mfma_f32_32x32x16_bf16 v[88:103], a[224:227], v[120:123], v[88:103]
    s_add_u32 m0, s85, 8192
    ds_read_b128 v[112:115], v253 offset:2048
    buffer_load_dwordx4 v254, s[24:27], s12 offen sc1 lds
    v_mfma_f32_32x32x16_bf16 v[72:87], a[240:243], v[124:127], v[72:87]
    s_add_u32 m0, s85, 10240
    ds_read_b128 v[116:119], v252 offset:4096
    buffer_load_dwordx4 v254, s[24:27], s13 offen sc1 lds
    s_waitcnt lgkmcnt(4)
    v_mfma_f32_32x32x16_bf16 v[88:103], a[240:243], v[128:131], v[88:103]
    s_add_u32 m0, s85, 12288
    ds_read_b128 v[120:123], v253 offset:4096
    buffer_load_dwordx4 v254, s[24:27], s14 offen sc1 lds
    v_mfma_f32_32x32x16_bf16 v[72:87], a[132:135], v[132:135], v[72:87]
    s_add_u32 m0, s85, 14336
    ds_read_b128 v[124:127], v252 offset:6144
    buffer_load_dwordx4 v254, s[24:27], s15 offen sc1 lds
    s_waitcnt lgkmcnt(4)
    v_mfma_f32_32x32x16_bf16 v[88:103], a[132:135], v[104:107], v[88:103]
    ds_read_b128 v[128:131], v253 offset:6144
    v_mfma_f32_32x32x16_bf16 v[72:87], a[148:151], v[108:111], v[72:87]
    s_add_u32 s64, s84, 14336
    buffer_load_dwordx4 a[8:11], v16, s[24:27], s64 offen offset:1024 sc1
    ds_read_b128 v[132:135], v252 offset:8192
    s_waitcnt lgkmcnt(4)
    v_mfma_f32_32x32x16_bf16 v[88:103], a[148:151], v[112:115], v[88:103]
    ds_read_b128 v[104:107], v253 offset:8192
    v_mfma_f32_32x32x16_bf16 v[72:87], a[164:167], v[116:119], v[72:87]
    s_add_u32 s64, s84, 21504
    buffer_load_dwordx4 a[12:15], v16, s[24:27], s64 offen offset:1024 sc1
    ds_read_b128 v[108:111], v252 offset:10240
    s_waitcnt lgkmcnt(4)
    v_mfma_f32_32x32x16_bf16 v[88:103], a[164:167], v[120:123], v[88:103]
    ds_read_b128 v[112:115], v253 offset:10240
    v_mfma_f32_32x32x16_bf16 v[72:87], a[180:183], v[124:127], v[72:87]
    s_add_u32 s64, s84, 28672
    buffer_load_dwordx4 a[16:19], v16, s[24:27], s64 offen offset:1024 sc1
    ds_read_b128 v[116:119], v252 offset:12288
    s_waitcnt lgkmcnt(4)
    v_mfma_f32_32x32x16_bf16 v[88:103], a[180:183], v[128:131], v[88:103]
    ds_read_b128 v[120:123], v253 offset:12288
    v_mfma_f32_32x32x16_bf16 v[72:87], a[196:199], v[132:135], v[72:87]
    s_add_u32 s64, s84, 35840
    buffer_load_dwordx4 a[20:23], v16, s[24:27], s64 offen offset:1024 sc1
    ds_read_b128 v[124:127], v252 offset:14336
    s_waitcnt vmcnt(15)
    s_cmp_lg_u32 s66, 1
    s_cbranch_scc1 L_w1_140
    s_mov_b64 exec, 1
    s_mov_b32 s90, 0
    s_waitcnt vmcnt(14)
    s_branch L_pollc_143
L_poll_141:
    v_mov_b32 v52, 0
    buffer_atomic_add v52, v51, s[24:27], 0 offen sc0 sc1
    s_waitcnt vmcnt(0)
L_pollc_143:
    v_bfe_u32 v52, v52, 12, 6
    v_cmp_ne_u32 vcc, 16, v52
    s_cbranch_vccz L_polld_142
    s_add_u32 s90, s90, 1
    s_cmp_lt_u32 s90, 0x4000
    s_cbranch_scc1 L_poll_141
    v_mov_b32 v52, 274
    buffer_store_dword v52, v55, s[48:51], 0 offen offset:4
L_polld_142:
    s_mov_b64 exec, -1
L_w1_140:
    s_barrier
    s_waitcnt lgkmcnt(4)
    v_mfma_f32_32x32x16_bf16 v[88:103], a[196:199], v[104:107], v[88:103]
    v_add_u32 v254, 2048, v4
    s_add_u32 m0, s85, 32768
    ds_read_b128 v[128:131], v253 offset:14336
    buffer_load_dwordx4 v254, s[24:27], s8 offen sc1 lds
    v_mfma_f32_32x32x16_bf16 v[72:87], a[212:215], v[108:111], v[72:87]
    s_add_u32 m0, s85, 34816
    ds_read_b128 v[132:135], v252 offset:32768
    buffer_load_dwordx4 v254, s[24:27], s9 offen sc1 lds
    s_waitcnt lgkmcnt(4)
    v_mfma_f32_32x32x16_bf16 v[88:103], a[212:215], v[112:115], v[88:103]
    s_add_u32 m0, s85, 36864
    ds_read_b128 v[104:107], v253 offset:32768
    buffer_load_dwordx4 v254, s[24:27], s10 offen sc1 lds
    v_mfma_f32_32x32x16_bf16 v[72:87], a[228:231], v[116:119], v[72:87]
    s_add_u32 m0, s85, 38912
    ds_read_b128 v[108:111], v252 offset:34816
    buffer_load_dwordx4 v254, s[24:27], s11 offen sc1 lds
    s_cmp_lg_u32 s66, 1
    s_cbranch_scc1 L_w1_144
    s_add_u32 s62, s86, 8
    v_mov_b32 v51, s62
    s_mov_b64 exec, 1
    v_mov_b32 v52, 0
    buffer_atomic_add v52, v51, s[24:27], 0 offen sc0 sc1
    s_mov_b64 exec, -1
L_w1_144:
    s_waitcnt lgkmcnt(4)
    v_mfma_f32_32x32x16_bf16 v[88:103], a[228:231], v[120:123], v[88:103]
    s_add_u32 m0, s85, 40960
    ds_read_b128 v[112:115], v253 offset:34816
    buffer_load_dwordx4 v254, s[24:27], s12 offen sc1 lds
    v_mfma_f32_32x32x16_bf16 v[72:87], a[244:247], v[124:127], v[72:87]
    s_add_u32 m0, s85, 43008
    ds_read_b128 v[116:119], v252 offset:36864
    buffer_load_dwordx4 v254, s[24:27], s13 offen sc1 lds
    s_waitcnt lgkmcnt(4)
    v_mfma_f32_32x32x16_bf16 v[88:103], a[244:247], v[128:131], v[88:103]
    s_add_u32 m0, s85, 45056
    ds_read_b128 v[120:123], v253 offset:36864
    buffer_load_dwordx4 v254, s[24:27], s14 offen sc1 lds
    v_mfma_f32_32x32x16_bf16 v[72:87], a[136:139], v[132:135], v[72:87]
    s_add_u32 m0, s85, 47104
    ds_read_b128 v[124:127], v252 offset:38912
    buffer_load_dwordx4 v254, s[24:27], s15 offen sc1 lds
    s_waitcnt vmcnt(16)
    s_barrier
    s_cmp_lg_u32 s66, 0
    s_cbranch_scc1 L_sig_145
    s_mov_b64 exec, 0xffff
    v_mov_b32 v52, 0x1000000
    buffer_atomic_add v52, v7, s[24:27], 0 offen offset:8 sc1
    s_mov_b64 exec, -1
L_sig_145:
    s_waitcnt lgkmcnt(4)
    v_mfma_f32_32x32x16_bf16 v[88:103], a[136:139], v[104:107], v[88:103]
    ds_read_b128 v[128:131], v253 offset:38912
    v_mfma_f32_32x32x16_bf16 v[72:87], a[152:155], v[108:111], v[72:87]
    s_add_u32 s64, s84, 43008
    buffer_load_dwordx4 a[24:27], v16, s[24:27], s64 offen offset:1024 sc1
    ds_read_b128 v[132:135], v252 offset:40960
    s_waitcnt lgkmcnt(4)
    v_mfma_f32_32x32x16_bf16 v[88:103], a[152:155], v[112:115], v[88:103]
    ds_read_b128 v[104:107], v253 offset:40960
    v_mfma_f32_32x32x16_bf16 v[72:87], a[168:171], v[116:119], v[72:87]
    s_add_u32 s64, s84, 50176
    buffer_load_dwordx4 a[28:31], v16, s[24:27], s64 offen offset:1024 sc1
    ds_read_b128 v[108:111], v252 offset:43008
    s_waitcnt lgkmcnt(4)
    v_mfma_f32_32x32x16_bf16 v[88:103], a[168:171], v[120:123], v[88:103]
    ds_read_b128 v[112:115], v253 offset:43008
    v_mfma_f32_32x32x16_bf16 v[72:87], a[184:187], v[124:127], v[72:87]
    s_add_u32 s64, s84, 0
    buffer_load_dwordx4 a[32:35], v16, s[24:27], s64 offen offset:2048 sc1
    ds_read_b128 v[116:119], v252 offset:45056
    s_waitcnt lgkmcnt(4)
    v_mfma_f32_32x32x16_bf16 v[88:103], a[184:187], v[128:131], v[88:103]
    ds_read_b128 v[120:123], v253 offset:45056
    v_mfma_f32_32x32x16_bf16 v[72:87], a[200:203], v[132:135], v[72:87]
    s_add_u32 s64, s84, 7168
    buffer_load_dwordx4 a[36:39], v16, s[24:27], s64 offen offset:2048 sc1
    ds_read_b128 v[124:127], v252 offset:47104
    s_waitcnt vmcnt(16)
    s_barrier
    s_waitcnt lgkmcnt(4)
    v_mfma_f32_32x32x16_bf16 v[88:103], a[200:203], v[104:107], v[88:103]
    ds_read_b128 v[128:131], v253 offset:47104
    v_mfma_f32_32x32x16_bf16 v[72:87], a[216:219], v[108:111], v[72:87]
    s_add_u32 s64, s84, 14336
    buffer_load_dwordx4 a[40:43], v16, s[24:27], s64 offen offset:2048 sc1
    ds_read_b128 v[132:135], v250 offset:0
    s_waitcnt lgkmcnt(4)
    v_mfma_f32_32x32x16_bf16 v[88:103], a[216:219], v[112:115], v[88:103]
    ds_read_b128 v[104:107], v251 offset:0
    v_mfma_f32_32x32x16_bf16 v[72:87], a[232:235], v[116:119], v[72:87]
    s_add_u32 s64, s84, 21504
    buffer_load_dwordx4 a[44:47], v16, s[24:27], s64 offen offset:2048 sc1
    ds_read_b128 v[108:111], v250 offset:2048
    s_waitcnt lgkmcnt(4)
    v_mfma_f32_32x32x16_bf16 v[88:103], a[232:235], v[120:123], v[88:103]
    ds_read_b128 v[112:115], v251 offset:2048
    v_mfma_f32_32x32x16_bf16 v[72:87], a[248:251], v[124:127], v[72:87]
    s_add_u32 s64, s84, 28672
    buffer_load_dwordx4 a[48:51], v16, s[24:27], s64 offen offset:2048 sc1
    ds_read_b128 v[116:119], v250 offset:4096
    s_cmp_lg_u32 s66, 1
    s_cbranch_scc1 L_w1_146
    s_mov_b64 exec, 1
    s_mov_b32 s90, 0
    s_waitcnt vmcnt(11)
    s_branch L_pollc_149
L_poll_147:
    v_mov_b32 v52, 0
    buffer_atomic_add v52, v51, s[24:27], 0 offen sc0 sc1
    s_waitcnt vmcnt(0)
L_pollc_149:
    v_bfe_u32 v52, v52, 18, 6
    v_cmp_ne_u32 vcc, 16, v52
    s_cbranch_vccz L_polld_148
    s_add_u32 s90, s90, 1
    s_cmp_lt_u32 s90, 0x4000
    s_cbranch_scc1 L_poll_147
    v_mov_b32 v52, 275
    buffer_store_dword v52, v55, s[48:51], 0 offen offset:4
L_polld_148:
    s_mov_b64 exec, -1
L_w1_146:
    s_barrier
    s_waitcnt lgkmcnt(4)
    v_mfma_f32_32x32x16_bf16 v[88:103], a[248:251], v[128:131], v[88:103]
    v_add_u32 v254, 2560, v4
    s_add_u32 m0, s85, 65536
    ds_read_b128 v[120:123], v251 offset:4096
    buffer_load_dwordx4 v254, s[24:27], s8 offen sc1 lds
    v_mfma_f32_32x32x16_bf16 v[72:87], a[140:143], v[132:135], v[72:87]
    s_add_u32 m0, s85, 67584
    ds_read_b128 v[124:127], v250 offset:6144
    buffer_load_dwordx4 v254, s[24:27], s9 offen sc1 lds
    s_waitcnt lgkmcnt(4)
    v_mfma_f32_32x32x16_bf16 v[88:103], a[140:143], v[104:107], v[88:103]
    s_add_u32 m0, s85, 69632
    ds_read_b128 v[128:131], v251 offset:6144
    buffer_load_dwordx4 v254, s[24:27], s10 offen sc1 lds
    v_mfma_f32_32x32x16_bf16 v[72:87], a[156:159], v[108:111], v[72:87]
    s_add_u32 m0, s85, 71680
    ds_read_b128 v[132:135], v250 offset:8192
    buffer_load_dwordx4 v254, s[24:27], s11 offen sc1 lds
    s_cmp_lg_u32 s66, 1
    s_cbranch_scc1 L_w1_150
    s_add_u32 s62, s86, 8
    v_mov_b32 v51, s62
    s_mov_b64 exec, 1
    v_mov_b32 v52, 0
    buffer_atomic_add v52, v51, s[24:27], 0 offen sc0 sc1
    s_mov_b64 exec, -1
L_w1_150:
    s_waitcnt lgkmcnt(4)
    v_mfma_f32_32x32x16_bf16 v[88:103], a[156:159], v[112:115], v[88:103]
    s_add_u32 m0, s85, 73728
    ds_read_b128 v[104:107], v251 offset:8192
    buffer_load_dwordx4 v254, s[24:27], s12 offen sc1 lds
    v_mfma_f32_32x32x16_bf16 v[72:87], a[172:175], v[116:119], v[72:87]
    s_add_u32 m0, s85, 75776
    ds_read_b128 v[108:111], v250 offset:10240
    buffer_load_dwordx4 v254, s[24:27], s13 offen sc1 lds
    s_waitcnt lgkmcnt(4)
    v_mfma_f32_32x32x16_bf16 v[88:103], a[172:175], v[120:123], v[88:103]
    s_add_u32 m0, s85, 77824
    ds_read_b128 v[112:115], v251 offset:10240
    buffer_load_dwordx4 v254, s[24:27], s14 offen sc1 lds
    v_mfma_f32_32x32x16_bf16 v[72:87], a[188:191], v[124:127], v[72:87]
    s_add_u32 m0, s85, 79872
    ds_read_b128 v[116:119], v250 offset:12288
    buffer_load_dwordx4 v254, s[24:27], s15 offen sc1 lds
    s_waitcnt lgkmcnt(4)
    v_mfma_f32_32x32x16_bf16 v[88:103], a[188:191], v[128:131], v[88:103]
    ds_read_b128 v[120:123], v251 offset:12288
    v_mfma_f32_32x32x16_bf16 v[72:87], a[204:207], v[132:135], v[72:87]
    s_add_u32 s64, s84, 35840
    buffer_load_dwordx4 a[52:55], v16, s[24:27], s64 offen offset:2048 sc1
    ds_read_b128 v[124:127], v250 offset:14336
    s_waitcnt vmcnt(16)
    s_barrier
    s_waitcnt lgkmcnt(4)
    v_mfma_f32_32x32x16_bf16 v[88:103], a[204:207], v[104:107], v[88:103]
    ds_read_b128 v[128:131], v251 offset:14336
    v_mfma_f32_32x32x16_bf16 v[72:87], a[220:223], v[108:111], v[72:87]
    s_add_u32 s64, s84, 43008
    buffer_load_dwordx4 a[56:59], v16, s[24:27], s64 offen offset:2048 sc1
    ds_read_b128 v[132:135], v250 offset:32768
    s_waitcnt lgkmcnt(4)
    v_mfma_f32_32x32x16_bf16 v[88:103], a[220:223], v[112:115], v[88:103]
    ds_read_b128 v[104:107], v251 offset:32768
    v_mfma_f32_32x32x16_bf16 v[72:87], a[236:239], v[116:119], v[72:87]
    s_add_u32 s64, s84, 50176
    buffer_load_dwordx4 a[60:63], v16, s[24:27], s64 offen offset:2048 sc1
    ds_read_b128 v[108:111], v250 offset:34816
    s_waitcnt lgkmcnt(4)
    v_mfma_f32_32x32x16_bf16 v[88:103], a[236:239], v[120:123], v[88:103]
    ds_read_b128 v[112:115], v251 offset:34816
    v_mfma_f32_32x32x16_bf16 v[72:87], a[252:255], v[124:127], v[72:87]
    ds_read_b128 v[116:119], v250 offset:36864
    s_waitcnt lgkmcnt(4)
    v_mfma_f32_32x32x16_bf16 v[88:103], a[252:255], v[128:131], v[88:103]
    ds_read_b128 v[120:123], v251 offset:36864
    v_mfma_f32_32x32x16_bf16 v[72:87], v[156:159], v[132:135], v[72:87]
    ds_read_b128 v[124:127], v250 offset:38912
    s_waitcnt lgkmcnt(4)
    v_mfma_f32_32x32x16_bf16 v[88:103], v[156:159], v[104:107], v[88:103]
    ds_read_b128 v[128:131], v251 offset:38912
    v_mfma_f32_32x32x16_bf16 v[72:87], v[160:163], v[108:111], v[72:87]
    ds_read_b128 v[132:135], v250 offset:40960
    s_waitcnt lgkmcnt(4)
    v_mfma_f32_32x32x16_bf16 v[88:103], v[160:163], v[112:115], v[88:103]
    ds_read_b128 v[104:107], v251 offset:40960
    v_mfma_f32_32x32x16_bf16 v[72:87], v[164:167], v[116:119], v[72:87]
    ds_read_b128 v[108:111], v250 offset:43008
    s_cmp_lg_u32 s66, 1
    s_cbranch_scc1 L_w1_151
    s_mov_b64 exec, 1
    s_mov_b32 s90, 0
    s_waitcnt vmcnt(7)
    s_branch L_pollc_154
L_poll_152:
    v_mov_b32 v52, 0
    buffer_atomic_add v52, v51, s[24:27], 0 offen sc0 sc1
    s_waitcnt vmcnt(0)
L_pollc_154:
    v_bfe_u32 v52, v52, 24, 6
    v_cmp_ne_u32 vcc, 16, v52
    s_cbranch_vccz L_polld_153
    s_add_u32 s90, s90, 1
    s_cmp_lt_u32 s90, 0x4000
    s_cbranch_scc1 L_poll_152
    v_mov_b32 v52, 276
    buffer_store_dword v52, v55, s[48:51], 0 offen offset:4
L_polld_153:
    s_mov_b64 exec, -1
L_w1_151:
    s_barrier
    s_waitcnt lgkmcnt(4)
    v_mfma_f32_32x32x16_bf16 v[88:103], v[164:167], v[120:123], v[88:103]
    v_add_u32 v254, 3072, v4
    s_add_u32 m0, s85, 98304
    ds_read_b128 v[112:115], v251 offset:43008
    buffer_load_dwordx4 v254, s[24:27], s8 offen sc1 lds
    v_mfma_f32_32x32x16_bf16 v[72:87], v[168:171], v[124:127], v[72:87]
    s_add_u32 m0, s85, 100352
    ds_read_b128 v[116:119], v250 offset:45056
    buffer_load_dwordx4 v254, s[24:27], s9 offen sc1 lds
    s_waitcnt lgkmcnt(4)
    v_mfma_f32_32x32x16_bf16 v[88:103], v[168:171], v[128:131], v[88:103]
    s_add_u32 m0, s85, 102400
    ds_read_b128 v[120:123], v251 offset:45056
    buffer_load_dwordx4 v254, s[24:27], s10 offen sc1 lds
    v_mfma_f32_32x32x16_bf16 v[72:87], v[172:175], v[132:135], v[72:87]
    s_add_u32 m0, s85, 104448
    ds_read_b128 v[124:127], v250 offset:47104
    buffer_load_dwordx4 v254, s[24:27], s11 offen sc1 lds
    s_waitcnt vmcnt(7)
    s_barrier
    s_waitcnt lgkmcnt(4)
    v_mfma_f32_32x32x16_bf16 v[88:103], v[172:175], v[104:107], v[88:103]
    s_add_u32 m0, s85, 106496
    ds_read_b128 v[128:131], v251 offset:47104
    buffer_load_dwordx4 v254, s[24:27], s12 offen sc1 lds
    v_mfma_f32_32x32x16_bf16 v[72:87], v[176:179], v[108:111], v[72:87]
    s_add_u32 m0, s85, 108544
    ds_read_b128 v[132:135], v252 offset:0
    buffer_load_dwordx4 v254, s[24:27], s13 offen sc1 lds
    s_waitcnt lgkmcnt(4)
    v_mfma_f32_32x32x16_bf16 v[88:103], v[176:179], v[112:115], v[88:103]
    s_add_u32 m0, s85, 110592
    ds_read_b128 v[104:107], v253 offset:0
    buffer_load_dwordx4 v254, s[24:27], s14 offen sc1 lds
    v_mfma_f32_32x32x16_bf16 v[72:87], v[180:183], v[116:119], v[72:87]
    s_add_u32 m0, s85, 112640
    ds_read_b128 v[108:111], v252 offset:2048
    buffer_load_dwordx4 v254, s[24:27], s15 offen sc1 lds
    s_waitcnt lgkmcnt(4)
    v_mfma_f32_32x32x16_bf16 v[88:103], v[180:183], v[120:123], v[88:103]
    ds_read_b128 v[112:115], v253 offset:2048
    v_mfma_f32_32x32x16_bf16 v[72:87], v[184:187], v[124:127], v[72:87]
    ds_read_b128 v[116:119], v252 offset:4096
    s_waitcnt lgkmcnt(4)
    v_mfma_f32_32x32x16_bf16 v[88:103], v[184:187], v[128:131], v[88:103]
    ds_read_b128 v[120:123], v253 offset:4096
    v_mfma_f32_32x32x16_bf16 v[72:87], a[0:3], v[132:135], v[72:87]
    ds_read_b128 v[124:127], v252 offset:6144
    s_waitcnt lgkmcnt(4)
    v_mfma_f32_32x32x16_bf16 v[88:103], a[0:3], v[104:107], v[88:103]
    ds_read_b128 v[128:131], v253 offset:6144
    v_mfma_f32_32x32x16_bf16 v[72:87], a[4:7], v[108:111], v[72:87]
    ds_read_b128 v[132:135], v252 offset:8192
    s_waitcnt lgkmcnt(4)
    v_mfma_f32_32x32x16_bf16 v[88:103], a[4:7], v[112:115], v[88:103]
    ds_read_b128 v[104:107], v253 offset:8192
    v_mfma_f32_32x32x16_bf16 v[72:87], a[8:11], v[116:119], v[72:87]
    ds_read_b128 v[108:111], v252 offset:10240
    s_waitcnt lgkmcnt(4)
    v_mfma_f32_32x32x16_bf16 v[88:103], a[8:11], v[120:123], v[88:103]
    ds_read_b128 v[112:115], v253 offset:10240
    v_mfma_f32_32x32x16_bf16 v[72:87], a[12:15], v[124:127], v[72:87]
    ds_read_b128 v[116:119], v252 offset:12288
    s_waitcnt lgkmcnt(4)
    v_mfma_f32_32x32x16_bf16 v[88:103], a[12:15], v[128:131], v[88:103]
    ds_read_b128 v[120:123], v253 offset:12288
    v_mfma_f32_32x32x16_bf16 v[72:87], a[16:19], v[132:135], v[72:87]
    ds_read_b128 v[124:127], v252 offset:14336
    s_waitcnt vmcnt(0)
    s_barrier
    s_waitcnt lgkmcnt(4)
    v_mfma_f32_32x32x16_bf16 v[88:103], a[16:19], v[104:107], v[88:103]
    ds_read_b128 v[128:131], v253 offset:14336
    v_mfma_f32_32x32x16_bf16 v[72:87], a[20:23], v[108:111], v[72:87]
    ds_read_b128 v[132:135], v252 offset:32768
    s_waitcnt lgkmcnt(4)
    v_mfma_f32_32x32x16_bf16 v[88:103], a[20:23], v[112:115], v[88:103]
    ds_read_b128 v[104:107], v253 offset:32768
    v_mfma_f32_32x32x16_bf16 v[72:87], a[24:27], v[116:119], v[72:87]
    ds_read_b128 v[108:111], v252 offset:34816
    s_waitcnt lgkmcnt(4)
    v_mfma_f32_32x32x16_bf16 v[88:103], a[24:27], v[120:123], v[88:103]
    ds_read_b128 v[112:115], v253 offset:34816
    v_mfma_f32_32x32x16_bf16 v[72:87], a[28:31], v[124:127], v[72:87]
    ds_read_b128 v[116:119], v252 offset:36864
    s_waitcnt lgkmcnt(4)
    v_mfma_f32_32x32x16_bf16 v[88:103], a[28:31], v[128:131], v[88:103]
    ds_read_b128 v[120:123], v253 offset:36864
    v_mfma_f32_32x32x16_bf16 v[72:87], a[32:35], v[132:135], v[72:87]
    ds_read_b128 v[124:127], v252 offset:38912
    s_waitcnt lgkmcnt(4)
    v_mfma_f32_32x32x16_bf16 v[88:103], a[32:35], v[104:107], v[88:103]
    ds_read_b128 v[128:131], v253 offset:38912
    v_mfma_f32_32x32x16_bf16 v[72:87], a[36:39], v[108:111], v[72:87]
    ds_read_b128 v[132:135], v252 offset:40960
    s_waitcnt lgkmcnt(4)
    v_mfma_f32_32x32x16_bf16 v[88:103], a[36:39], v[112:115], v[88:103]
    ds_read_b128 v[104:107], v253 offset:40960
    v_mfma_f32_32x32x16_bf16 v[72:87], a[40:43], v[116:119], v[72:87]
    ds_read_b128 v[108:111], v252 offset:43008
    s_waitcnt lgkmcnt(4)
    v_mfma_f32_32x32x16_bf16 v[88:103], a[40:43], v[120:123], v[88:103]
    ds_read_b128 v[112:115], v253 offset:43008
    v_mfma_f32_32x32x16_bf16 v[72:87], a[44:47], v[124:127], v[72:87]
    ds_read_b128 v[116:119], v252 offset:45056
    s_waitcnt lgkmcnt(4)
    v_mfma_f32_32x32x16_bf16 v[88:103], a[44:47], v[128:131], v[88:103]
    ds_read_b128 v[120:123], v253 offset:45056
    v_mfma_f32_32x32x16_bf16 v[72:87], a[48:51], v[132:135], v[72:87]
    ds_read_b128 v[124:127], v252 offset:47104
    s_waitcnt lgkmcnt(4)
    v_mfma_f32_32x32x16_bf16 v[88:103], a[48:51], v[104:107], v[88:103]
    ds_read_b128 v[128:131], v253 offset:47104
    v_mfma_f32_32x32x16_bf16 v[72:87], a[52:55], v[108:111], v[72:87]
    s_waitcnt lgkmcnt(3)
    v_mfma_f32_32x32x16_bf16 v[88:103], a[52:55], v[112:115], v[88:103]
    v_mfma_f32_32x32x16_bf16 v[72:87], a[56:59], v[116:119], v[72:87]
    s_waitcnt lgkmcnt(1)
    v_mfma_f32_32x32x16_bf16 v[88:103], a[56:59], v[120:123], v[88:103]
    v_mfma_f32_32x32x16_bf16 v[72:87], a[60:63], v[124:127], v[72:87]
    s_waitcnt lgkmcnt(0)
    v_mfma_f32_32x32x16_bf16 v[88:103], a[60:63], v[128:131], v[88:103]
    s_add_u32 s65, s94, 0x80000
    s_lshl_b32 s62, s66, 12
    s_add_u32 s62, s62, 0x20000
    v_add_u32 v144, s62, v2
    s_xor_b32 s62, s62, 0x1000
    v_add_u32 v145, s62, v2
    v_mov_b32 v146, 0
    v_mov_b32 v147, 0
    v_mov_b32 v148, 0
    v_mov_b32 v149, 0
    s_nop 3
    ds_write_b128 v144, v[88:91] offset:0
    ds_write_b128 v144, v[92:95] offset:1024
    ds_write_b128 v144, v[96:99] offset:2048
    ds_write_b128 v144, v[100:103] offset:3072
    s_waitcnt lgkmcnt(0)
    s_barrier
    ds_read_b128 v[88:91], v145 offset:0
    ds_read_b128 v[92:95], v145 offset:1024
    ds_read_b128 v[96:99], v145 offset:2048
    ds_read_b128 v[100:103], v145 offset:3072
    s_waitcnt lgkmcnt(3)
    v_pk_add_f32 v[72:73], v[72:73], v[88:89]
    v_pk_add_f32 v[74:75], v[74:75], v[90:91]
    v_cvt_pk_bf16_f32 v26, v72, v73
    v_cvt_pk_bf16_f32 v27, v74, v75
    s_waitcnt lgkmcnt(2)
    v_pk_add_f32 v[76:77], v[76:77], v[92:93]
    v_pk_add_f32 v[78:79], v[78:79], v[94:95]
    v_cvt_pk_bf16_f32 v28, v76, v77
    v_cvt_pk_bf16_f32 v29, v78, v79
    buffer_store_dwordx4 v[26:29], v17, s[40:43], s89 offen offset:0
    s_waitcnt lgkmcnt(1)
    v_pk_add_f32 v[80:81], v[80:81], v[96:97]
    v_pk_add_f32 v[82:83], v[82:83], v[98:99]
    v_cvt_pk_bf16_f32 v30, v80, v81
    v_cvt_pk_bf16_f32 v31, v82, v83
    s_waitcnt lgkmcnt(0)
    v_pk_add_f32 v[84:85], v[84:85], v[100:101]
    v_pk_add_f32 v[86:87], v[86:87], v[102:103]
    v_cvt_pk_bf16_f32 v32, v84, v85
    v_cvt_pk_bf16_f32 v33, v86, v87
    buffer_store_dwordx4 v[30:33], v17, s[40:43], s89 offen offset:32
L_fin:
L_end:
    s_endpgm
L_im_4:
    s_lshl_b32 s65, s68, 1
    s_add_u32 s65, s65, 0
    s_and_b32 s65, s65, 15
    s_mul_i32 s65, s65, 3072
    s_add_u32 s65, s65, s95
    s_add_u32 s65, s65, 0x2400000
    buffer_store_dwordx4 v[152:155], v2, s[24:27], s65 offen offset:0 sc1
    buffer_store_dwordx4 v[156:159], v2, s[24:27], s65 offen offset:1024 sc1
    buffer_store_dwordx4 v[160:163], v2, s[24:27], s65 offen offset:2048 sc1
    s_nop 1
    s_branch L_imb_5
L_pub_6:
    v_mov_b32 v51, 0x27e00
    ds_read_b128 v[176:179], v51
    s_waitcnt lgkmcnt(0)
    v_add_u32 v176, v176, v177
    v_add3_u32 v176, v176, v178, v179
    v_cmp_lt_i32 vcc, 0, v176
    s_nop 1
    v_cndmask_b32 v53, 1, 2, vcc
    buffer_store_dword v53, v55, s[48:51], 0 offen sc1
    s_branch L_pubb_7
L_im_8:
    s_lshl_b32 s65, s68, 1
    s_add_u32 s65, s65, 1
    s_and_b32 s65, s65, 15
    s_mul_i32 s65, s65, 3072
    s_add_u32 s65, s65, s95
    s_add_u32 s65, s65, 0x2400000
    buffer_store_dwordx4 v[164:167], v2, s[24:27], s65 offen offset:0 sc1
    buffer_store_dwordx4 v[168:171], v2, s[24:27], s65 offen offset:1024 sc1
    buffer_store_dwordx4 v[172:175], v2, s[24:27], s65 offen offset:2048 sc1
    s_nop 1
    s_branch L_imb_9
L_im_10:
    s_lshl_b32 s65, s68, 1
    s_add_u32 s65, s65, 2
    s_and_b32 s65, s65, 15
    s_mul_i32 s65, s65, 3072
    s_add_u32 s65, s65, s95
    s_add_u32 s65, s65, 0x2400000
    buffer_store_dwordx4 v[152:155], v2, s[24:27], s65 offen offset:0 sc1
    buffer_store_dwordx4 v[156:159], v2, s[24:27], s65 offen offset:1024 sc1
    buffer_store_dwordx4 v[160:163], v2, s[24:27], s65 offen offset:2048 sc1
    s_nop 1
    s_branch L_imb_11
L_im_12:
    s_lshl_b32 s65, s68, 1
    s_add_u32 s65, s65, 3
    s_and_b32 s65, s65, 15
    s_mul_i32 s65, s65, 3072
    s_add_u32 s65, s65, s95
    s_add_u32 s65, s65, 0x2400000
    buffer_store_dwordx4 v[164:167], v2, s[24:27], s65 offen offset:0 sc1
    buffer_store_dwordx4 v[168:171], v2, s[24:27], s65 offen offset:1024 sc1
    buffer_store_dwordx4 v[172:175], v2, s[24:27], s65 offen offset:2048 sc1
    s_nop 1
    s_branch L_imb_13
L_im_14:
    s_lshl_b32 s65, s68, 1
    s_add_u32 s65, s65, 4
    s_and_b32 s65, s65, 15
    s_mul_i32 s65, s65, 3072
    s_add_u32 s65, s65, s95
    s_add_u32 s65, s65, 0x2400000
    buffer_store_dwordx4 v[152:155], v2, s[24:27], s65 offen offset:0 sc1
    buffer_store_dwordx4 v[156:159], v2, s[24:27], s65 offen offset:1024 sc1
    buffer_store_dwordx4 v[160:163], v2, s[24:27], s65 offen offset:2048 sc1
    s_nop 1
    s_branch L_imb_15
L_im_16:
    s_lshl_b32 s65, s68, 1
    s_add_u32 s65, s65, 5
    s_and_b32 s65, s65, 15
    s_mul_i32 s65, s65, 3072
    s_add_u32 s65, s65, s95
    s_add_u32 s65, s65, 0x2400000
    buffer_store_dwordx4 v[164:167], v2, s[24:27], s65 offen offset:0 sc1
    buffer_store_dwordx4 v[168:171], v2, s[24:27], s65 offen offset:1024 sc1
    buffer_store_dwordx4 v[172:175], v2, s[24:27], s65 offen offset:2048 sc1
    s_nop 1
    s_branch L_imb_17
L_im_18:
    s_lshl_b32 s65, s68, 1
    s_add_u32 s65, s65, 6
    s_and_b32 s65, s65, 15
    s_mul_i32 s65, s65, 3072
    s_add_u32 s65, s65, s95
    s_add_u32 s65, s65, 0x2400000
    buffer_store_dwordx4 v[152:155], v2, s[24:27], s65 offen offset:0 sc1
    buffer_store_dwordx4 v[156:159], v2, s[24:27], s65 offen offset:1024 sc1
    buffer_store_dwordx4 v[160:163], v2, s[24:27], s65 offen offset:2048 sc1
    s_nop 1
    s_branch L_imb_19
L_im_20:
    s_lshl_b32 s65, s68, 1
    s_add_u32 s65, s65, 7
    s_and_b32 s65, s65, 15
    s_mul_i32 s65, s65, 3072
    s_add_u32 s65, s65, s95
    s_add_u32 s65, s65, 0x2400000
    buffer_store_dwordx4 v[164:167], v2, s[24:27], s65 offen offset:0 sc1
    buffer_store_dwordx4 v[168:171], v2, s[24:27], s65 offen offset:1024 sc1
    buffer_store_dwordx4 v[172:175], v2, s[24:27], s65 offen offset:2048 sc1
    s_nop 1
    s_branch L_imb_21
L_im_22:
    s_lshl_b32 s65, s68, 1
    s_add_u32 s65, s65, 8
    s_and_b32 s65, s65, 15
    s_mul_i32 s65, s65, 3072
    s_add_u32 s65, s65, s95
    s_add_u32 s65, s65, 0x2400000
    buffer_store_dwordx4 v[152:155], v2, s[24:27], s65 offen offset:0 sc1
    buffer_store_dwordx4 v[156:159], v2, s[24:27], s65 offen offset:1024 sc1
    buffer_store_dwordx4 v[160:163], v2, s[24:27], s65 offen offset:2048 sc1
    s_nop 1
    s_branch L_imb_23
L_im_24:
    s_lshl_b32 s65, s68, 1
    s_add_u32 s65, s65, 9
    s_and_b32 s65, s65, 15
    s_mul_i32 s65, s65, 3072
    s_add_u32 s65, s65, s95
    s_add_u32 s65, s65, 0x2400000
    buffer_store_dwordx4 v[164:167], v2, s[24:27], s65 offen offset:0 sc1
    buffer_store_dwordx4 v[168:171], v2, s[24:27], s65 offen offset:1024 sc1
    buffer_store_dwordx4 v[172:175], v2, s[24:27], s65 offen offset:2048 sc1
    s_nop 1
    s_branch L_imb_25
L_im_26:
    s_lshl_b32 s65, s68, 1
    s_add_u32 s65, s65, 10
    s_and_b32 s65, s65, 15
    s_mul_i32 s65, s65, 3072
    s_add_u32 s65, s65, s95
    s_add_u32 s65, s65, 0x2400000
    buffer_store_dwordx4 v[152:155], v2, s[24:27], s65 offen offset:0 sc1
    buffer_store_dwordx4 v[156:159], v2, s[24:27], s65 offen offset:1024 sc1
    buffer_store_dwordx4 v[160:163], v2, s[24:27], s65 offen offset:2048 sc1
    s_nop 1
    s_branch L_imb_27
L_im_28:
    s_lshl_b32 s65, s68, 1
    s_add_u32 s65, s65, 11
    s_and_b32 s65, s65, 15
    s_mul_i32 s65, s65, 3072
    s_add_u32 s65, s65, s95
    s_add_u32 s65, s65, 0x2400000
    buffer_store_dwordx4 v[164:167], v2, s[24:27], s65 offen offset:0 sc1
    buffer_store_dwordx4 v[168:171], v2, s[24:27], s65 offen offset:1024 sc1
    buffer_store_dwordx4 v[172:175], v2, s[24:27], s65 offen offset:2048 sc1
    s_nop 1
    s_branch L_imb_29
L_im_30:
    s_lshl_b32 s65, s68, 1
    s_add_u32 s65, s65, 12
    s_and_b32 s65, s65, 15
    s_mul_i32 s65, s65, 3072
    s_add_u32 s65, s65, s95
    s_add_u32 s65, s65, 0x2400000
    buffer_store_dwordx4 v[152:155], v2, s[24:27], s65 offen offset:0 sc1
    buffer_store_dwordx4 v[156:159], v2, s[24:27], s65 offen offset:1024 sc1
    buffer_store_dwordx4 v[160:163], v2, s[24:27], s65 offen offset:2048 sc1
    s_nop 1
    s_branch L_imb_31
L_im_32:
    s_lshl_b32 s65, s68, 1
    s_add_u32 s65, s65, 13
    s_and_b32 s65, s65, 15
    s_mul_i32 s65, s65, 3072
    s_add_u32 s65, s65, s95
    s_add_u32 s65, s65, 0x2400000
    buffer_store_dwordx4 v[164:167], v2, s[24:27], s65 offen offset:0 sc1
    buffer_store_dwordx4 v[168:171], v2, s[24:27], s65 offen offset:1024 sc1
    buffer_store_dwordx4 v[172:175], v2, s[24:27], s65 offen offset:2048 sc1
    s_nop 1
    s_branch L_imb_33
L_im_34:
    s_lshl_b32 s65, s68, 1
    s_add_u32 s65, s65, 14
    s_and_b32 s65, s65, 15
    s_mul_i32 s65, s65, 3072
    s_add_u32 s65, s65, s95
    s_add_u32 s65, s65, 0x2400000
    buffer_store_dwordx4 v[152:155], v2, s[24:27], s65 offen offset:0 sc1
    buffer_store_dwordx4 v[156:159], v2, s[24:27], s65 offen offset:1024 sc1
    buffer_store_dwordx4 v[160:163], v2, s[24:27], s65 offen offset:2048 sc1
    s_nop 1
    s_branch L_imb_35
L_crl_37:
    s_mov_b32 s90, 0
L_crl_37b:
    buffer_load_dword v52, v55, s[48:51], 0 offen sc1
    s_waitcnt vmcnt(0)
    v_readfirstlane_b32 s62, v52
    s_add_u32 s90, s90, 1
    s_cmp_lg_u32 s62, 0
    s_cbranch_scc1 L_crg_38
    s_cmp_lt_u32 s90, 0x4000
    s_cbranch_scc1 L_crl_37b
    s_branch L_crg_38
L_im_40:
    s_lshl_b32 s65, s68, 1
    s_add_u32 s65, s65, 15
    s_and_b32 s65, s65, 15
    s_mul_i32 s65, s65, 3072
    s_add_u32 s65, s65, s95
    s_add_u32 s65, s65, 0x2400000
    buffer_store_dwordx4 v[164:167], v2, s[24:27], s65 offen offset:0 sc1
    buffer_store_dwordx4 v[168:171], v2, s[24:27], s65 offen offset:1024 sc1
    buffer_store_dwordx4 v[172:175], v2, s[24:27], s65 offen offset:2048 sc1
    s_nop 1
    s_branch L_imb_41
L_codeend:
.section .rodata,"a"
.p2align 6
.amdhsa_kernel interleave_layers__sliding_local_dilated__glu_gated_geglu__prompt_kernel
  .amdhsa_next_free_vgpr 512
  .amdhsa_next_free_sgpr 102
  .amdhsa_accum_offset 256
  .amdhsa_group_segment_fixed_size 0
  .amdhsa_kernarg_size 80
  .amdhsa_user_sgpr_count 2
  .amdhsa_user_sgpr_kernarg_segment_ptr 1
  .amdhsa_system_sgpr_workgroup_id_x 1
.end_amdhsa_kernel
```
